```python
import torch

def _softmax(x, axis=-1):
    return torch.softmax(x, dim=axis)
def _gelu(x):
    return torch.nn.functional.gelu(x, approximate="tanh")
def _silu(x):
    return torch.nn.functional.silu(x)
def _sigmoid(x):
    return torch.sigmoid(x)
def _layernorm(x, axis=-1, eps=1e-5):
    m = x.mean(dim=axis, keepdim=True)
    v = x.var(dim=axis, keepdim=True, unbiased=False)
    return (x - m) / torch.sqrt(v + eps)
def _scatter_add(tgt, idx, src, axis=0):
    return tgt.clone().index_add_(axis, idx, src)
def _segment_sum(src, seg, n):
    out = torch.zeros((n,) + src.shape[1:], dtype=src.dtype)
    return out.index_add_(0, seg, src)
def _pad(x, pw):
    flat = tuple(v for pair in reversed(pw) for v in pair)
    return torch.nn.functional.pad(x, flat)

kernel_name = 'standalone__edge_featured_mpnn_mpnn__graph'

def setup_inputs():

    _w = (lambda a: (lambda t: t.to(torch.bfloat16) if t.is_floating_point() else t)(torch.as_tensor(a)))
    N, deg, D, De = 25000, 32, 64, max(4, 1)
    E = N * deg
    H = 2 * D
    return {
        "x": _w((lambda *s: torch.randn(*s, dtype=torch.bfloat16) * 0.05)(N, D)),
        "e_attr": _w((lambda *s: torch.randn(*s, dtype=torch.bfloat16) * 1.6)(E, De)),
        "src": _w((lambda lo, hi, *s: torch.randint(lo, hi, s))(0, N, E).to(torch.int64)),
        "dst": _w((lambda lo, hi, *s: torch.randint(lo, hi, s))(0, N, E).to(torch.int64)),
        "w1": _w((lambda *s: torch.randn(*s, dtype=torch.bfloat16) * 1.6)(2 * D + De, H) * (1.0 / (2 * D + De) ** 0.5)),
        "b1": _w((lambda *s: torch.randn(*s, dtype=torch.bfloat16) * 3.2)(H) * 0.01),
        "w2": _w((lambda *s: torch.randn(*s, dtype=torch.bfloat16) * 0.05)(H, D) * (1.0 / H ** 0.5)),
        "b2": _w((lambda *s: torch.randn(*s, dtype=torch.bfloat16) * 0.1)(D) * 0.01),
    }

def reference(x, e_attr, src, dst, w1, b1, w2, b2):
    N, D = x.shape
    h_src = x[src]
    h_dst = x[dst]
    m_in = torch.concatenate([h_src, h_dst, e_attr], axis=-1)
    h = _silu(m_in @ w1 + b1)
    msg = h @ w2 + b2
    return _segment_sum(msg, dst, N)
```

```asm
; @launch grid=(256,1,1) block=(512,1,1) lds=160320
.amdgcn_target "amdgcn-amd-amdhsa--gfx950"
.text
.globl standalone__edge_featured_mpnn_mpnn__graph_kernel
.p2align 8
.type standalone__edge_featured_mpnn_mpnn__graph_kernel,@function
standalone__edge_featured_mpnn_mpnn__graph_kernel:
    s_cmp_ge_u32 s2, 256
    s_cbranch_scc1 M_END
    s_load_dwordx16 s[4:19], s[0:1], 0
    s_load_dwordx4 s[20:23], s[0:1], 64
    s_load_dwordx2 s[24:25], s[0:1], 80
    v_and_b32 v1, 63, v0
    v_lshrrev_b32 v2, 6, v0
    s_getpc_b64 s[66:67]
CPF_PC:
    s_lshr_b32 s68, s2, 3
    s_lshl_b32 s68, s68, 11
    v_lshl_add_u32 v3, v0, 7, s68
    v_min_u32 v3, M_END-CPF_PC, v3
    v_cmpx_gt_u32 vcc, 16, v0
    s_cbranch_execz CPF_SKIP
    global_load_dword v75, v3, s[66:67]
CPF_SKIP:
    s_mov_b64 exec, -1
    s_bfe_u32 s97, s2, 0x20001
    s_lshr_b32 s27, s2, 3
    s_lshl_b32 s97, s97, 5
    s_add_u32 s27, s27, s97
    v_readfirstlane_b32 s3, v2
    s_movk_i32 s89, 96
    s_bitcmp1_b32 s2, 0
    s_cselect_b32 s89, s89, 100
    s_cselect_b32 s97, 12800, 0
    s_cselect_b32 s98, 128, 0
    s_mul_i32 s26, s27, s89
    s_add_u32 s26, s26, s97
    s_add_u32 s27, s27, s98
    s_add_u32 s90, s89, 3
    s_lshr_b32 s90, s90, 2
    s_mov_b32 s93, 0x100000
    v_lshlrev_b32 v124, 4, v0
    v_lshlrev_b32 v125, 5, v0
    s_mul_i32 s97, s2, 3128
    s_sub_u32 s98, 800000, s97
    s_min_u32 s98, s98, 3128
    s_lshr_b32 s98, s98, 2
    s_sub_u32 s99, s98, 448
    v_cmp_gt_u32 s[94:95], s99, v0
    s_lshl_b32 s60, s97, 2
    s_add_u32 s61, s60, 7168
    s_lshl_b32 s62, s97, 3
    s_add_u32 s63, s62, 14336
    v_bfrev_b32 v66, 2
    v_cndmask_b32 v154, v66, v124, s[94:95]
    v_lshlrev_b32 v155, 1, v154
    v_lshlrev_b32 v66, 2, v0
    v_add_u32 v67, 158208, v66
    v_mov_b32 v68, 0
    ds_write_b32 v67, v68
    v_mov_b32 v69, 0
    v_mov_b32 v67, 160256
    ds_write_b64 v67, v[68:69]
    v_lshlrev_b32 v126, 4, v1
    v_bfe_u32 v127, v1, 4, 2
    v_lshlrev_b32 v127, 6, v127
    v_xor_b32 v127, v127, v126
    s_lshl_b32 s69, s3, 12
    s_mov_b32 s68, 19712
    s_cmp_lt_u32 s3, 4
    s_cselect_b32 s68, s68, 125440
    s_add_u32 m0, s68, s69
    s_waitcnt lgkmcnt(0)
    s_cmp_lg_u32 s3, 7
    s_cbranch_scc1 EDGE0
    s_mov_b32 s72, s22
    s_mov_b32 s73, s23
    s_mov_b32 s74, 0x100
    s_mov_b32 s75, 0x20000
    s_cmp_lg_u32 s2, 0
    s_cbranch_scc1 SVC_MID
    s_memrealtime s[64:65]
    s_waitcnt lgkmcnt(0)
    s_or_b32 s64, s64, 1
    v_mov_b32 v67, s64
    s_mov_b64 exec, 1
    buffer_store_dword v67, off, s[72:75], 0 sc1
    s_mov_b64 exec, -1
    s_branch SVC_MID
EDGE0:
    s_setprio 2
    s_mov_b32 s48, s10
    s_mov_b32 s49, s11
    s_mov_b32 s50, 0x30d400
    s_mov_b32 s51, 0x20000
    buffer_load_dwordx4 v[76:79], v124, s[48:51], s60 offen
    buffer_load_dwordx4 v[80:83], v154, s[48:51], s61 offen
    s_mov_b32 s52, s8
    s_mov_b32 s53, s9
    s_mov_b32 s54, 0x30d400
    s_mov_b32 s55, 0x20000
    s_mov_b32 s56, s6
    s_mov_b32 s57, s7
    s_mov_b32 s58, 0x61a800
    s_mov_b32 s59, 0x20000
    s_barrier
    s_mov_b32 s76, s12
    s_mov_b32 s77, s13
    s_mov_b32 s78, 0x8400
    s_mov_b32 s79, 0x20000
    buffer_load_dwordx4 v127, s[76:79], s69 offen offset:0 lds
    buffer_load_dwordx4 v127, s[76:79], s69 offen offset:1024 lds
    buffer_load_dwordx4 v127, s[76:79], s69 offen offset:2048 lds
    buffer_load_dwordx4 v127, s[76:79], s69 offen offset:3072 lds
    buffer_load_dwordx4 v[84:87], v124, s[52:55], s60 offen
    buffer_load_dwordx4 v[88:91], v154, s[52:55], s61 offen
    s_mov_b32 s28, s4
    s_mov_b32 s29, s5
    s_mov_b32 s30, 0x30d400
    s_mov_b32 s31, 0x20000
    s_mov_b32 s32, s20
    s_mov_b32 s33, s21
    s_mov_b32 s34, 0x30d400
    s_mov_b32 s35, 0x20000
    s_mov_b32 s36, s24
    s_mov_b32 s37, s25
    s_mov_b32 s38, 0x310000
    s_mov_b32 s39, 0x20000
    s_add_u32 s40, s24, 0x400000
    s_addc_u32 s41, s25, 0
    s_mov_b32 s42, 0x620000
    s_mov_b32 s43, 0x20000
    s_add_u32 s44, s24, 0xb00000
    s_addc_u32 s45, s25, 0
    s_mov_b32 s46, 0x90000
    s_mov_b32 s47, 0x20000
    s_mov_b32 s48, s16
    s_mov_b32 s49, s17
    s_mov_b32 s50, 0x4000
    s_mov_b32 s51, 0x20000
    v_lshlrev_b32 v66, 2, v0
    v_subrev_u32 v68, 4, v0
    v_lshrrev_b32 v69, 3, v68
    v_and_b32 v70, 3, v0
    v_cmp_eq_u32 vcc, v69, v70
    v_and_b32 v68, 4, v68
    v_lshlrev_b32 v68, 2, v68
    v_mov_b32 v69, 0x3f80
    v_lshlrev_b32 v69, v68, v69
    v_cndmask_b32 v69, 0, v69, vcc
    ds_write_b32 v66, v69
    v_subrev_u32 v68, 256, v0
    v_cmp_gt_u32 vcc, s90, v68
    s_nop 1
    v_cndmask_b32 v69, 0, 8, vcc
    v_cmpx_gt_u32 vcc, 384, v0
    ds_write_b32 v66, v69 offset:1792
    s_mov_b64 exec, -1
    s_lshl_b32 s64, s98, 4
    s_add_u32 s65, s64, 81856
    v_mov_b32 v68, s65
    v_mov_b32 v69, 0x7fff0000
    s_mov_b64 exec, 1
    ds_write_b32 v68, v69
    s_mov_b64 exec, -1
    s_mov_b32 s12, -1
    s_mov_b32 s13, 0
    s_mov_b32 s14, 0
    s_mov_b32 s15, -1
    s_mov_b32 s16, 0x12800000
    s_mov_b32 s17, 0x12800000
    s_movk_i32 s11, 128
    s_lshl_b32 s9, s3, 12
    s_add_u32 s9, s9, 125440
    s_mov_b32 s64, 41944
    s_mov_b32 s66, 43691
    v_mov_b32 v68, 0xfeaaaa00
    v_mov_b32 v66, 1
    s_mov_b32 s65, 158208
    s_waitcnt vmcnt(6)
    v_mul_u32_u24 v108, s64, v76
    v_mad_u32_u24 v69, v76, s66, v68
    v_max_i32 v108, v108, v69
    v_lshrrev_b32 v108, 22, v108
    v_lshl_add_u32 v108, v108, 2, s65
    ds_add_rtn_u32 v116, v108, v66
    v_mul_u32_u24 v109, s64, v77
    v_mad_u32_u24 v69, v77, s66, v68
    v_max_i32 v109, v109, v69
    v_lshrrev_b32 v109, 22, v109
    v_lshl_add_u32 v109, v109, 2, s65
    ds_add_rtn_u32 v117, v109, v66
    v_mul_u32_u24 v110, s64, v78
    v_mad_u32_u24 v69, v78, s66, v68
    v_max_i32 v110, v110, v69
    v_lshrrev_b32 v110, 22, v110
    v_lshl_add_u32 v110, v110, 2, s65
    ds_add_rtn_u32 v118, v110, v66
    v_mul_u32_u24 v111, s64, v79
    v_mad_u32_u24 v69, v79, s66, v68
    v_max_i32 v111, v111, v69
    v_lshrrev_b32 v111, 22, v111
    v_lshl_add_u32 v111, v111, 2, s65
    ds_add_rtn_u32 v119, v111, v66
    s_mov_b64 exec, s[94:95]
    v_mul_u32_u24 v112, s64, v80
    v_mad_u32_u24 v69, v80, s66, v68
    v_max_i32 v112, v112, v69
    v_lshrrev_b32 v112, 22, v112
    v_lshl_add_u32 v112, v112, 2, s65
    ds_add_rtn_u32 v120, v112, v66
    v_mul_u32_u24 v113, s64, v81
    v_mad_u32_u24 v69, v81, s66, v68
    v_max_i32 v113, v113, v69
    v_lshrrev_b32 v113, 22, v113
    v_lshl_add_u32 v113, v113, 2, s65
    ds_add_rtn_u32 v121, v113, v66
    v_mul_u32_u24 v114, s64, v82
    v_mad_u32_u24 v69, v82, s66, v68
    v_max_i32 v114, v114, v69
    v_lshrrev_b32 v114, 22, v114
    v_lshl_add_u32 v114, v114, 2, s65
    ds_add_rtn_u32 v122, v114, v66
    v_mul_u32_u24 v115, s64, v83
    v_mad_u32_u24 v69, v83, s66, v68
    v_max_i32 v115, v115, v69
    v_lshrrev_b32 v115, 22, v115
    v_lshl_add_u32 v115, v115, 2, s65
    ds_add_rtn_u32 v123, v115, v66
    s_mov_b64 exec, 1
    v_mov_b32 v32, 160256
    v_mov_b32 v33, 1
    ds_add_u32 v32, v33
    s_mov_b64 exec, -1
    s_setprio 0
    buffer_load_dwordx4 v[92:95], v125, s[56:59], s62 offen
    buffer_load_dwordx4 v[96:99], v125, s[56:59], s62 offen offset:16
    buffer_load_dwordx4 v[100:103], v155, s[56:59], s63 offen
    buffer_load_dwordx4 v[104:107], v155, s[56:59], s63 offen offset:16
    v_lshlrev_b32 v67, 4, v1
    v_add_u32 v67, 158208, v67
    v_mov_b32 v32, 160256
SB2W:
    ds_read_b32 v33, v32
    s_waitcnt lgkmcnt(0)
    v_readfirstlane_b32 s18, v33
    s_cmp_eq_u32 s18, 7
    s_cbranch_scc1 SB2W_G
    s_sub_u32 s93, s93, 1
    s_cmp_lg_u32 s93, 0
    s_cbranch_scc1 SB2W
    s_endpgm
SB2W_G:
    ds_read_b128 v[144:147], v67
    s_waitcnt lgkmcnt(0)
    v_add_u32 v149, v144, v145
    v_add_u32 v150, v149, v146
    v_add_u32 v152, v150, v147
    v_sub_u32 v153, 20464, v152
    s_nop 0
    v_add_u32_dpp v152, v152, v152 row_shr:1 row_mask:0xf bank_mask:0xf
    s_nop 1
    v_add_u32_dpp v152, v152, v152 row_shr:2 row_mask:0xf bank_mask:0xf
    s_nop 1
    v_add_u32_dpp v152, v152, v152 row_shr:4 row_mask:0xf bank_mask:0xf
    s_nop 1
    v_add_u32_dpp v152, v152, v152 row_shr:8 row_mask:0xf bank_mask:0xf
    s_nop 1
    v_add_u32_dpp v152, v152, v152 row_bcast:15 row_mask:0xa bank_mask:0xf
    s_nop 1
    v_add_u32_dpp v152, v152, v152 row_bcast:31 row_mask:0xc bank_mask:0xf
    v_add_u32 v148, v152, v153
    v_add_u32 v151, v148, v150
    v_add_u32 v150, v148, v149
    v_add_u32 v149, v148, v144
    ds_write_b128 v67, v[148:151] offset:1024
    ds_read_b32 v108, v108 offset:1024
    ds_read_b32 v109, v109 offset:1024
    ds_read_b32 v110, v110 offset:1024
    ds_read_b32 v111, v111 offset:1024
    s_mov_b64 exec, s[94:95]
    ds_read_b32 v112, v112 offset:1024
    ds_read_b32 v113, v113 offset:1024
    ds_read_b32 v114, v114 offset:1024
    ds_read_b32 v115, v115 offset:1024
    s_mov_b64 exec, -1
    s_mov_b32 s65, 0xfffef140
    s_waitcnt vmcnt(4) lgkmcnt(0)
    v_add_lshl_u32 v108, v108, v116, 2
    v_lshl_or_b32 v84, v76, 16, v84
    ds_write_b32 v108, v84
    v_add_lshl_u32 v109, v109, v117, 2
    v_lshl_or_b32 v85, v77, 16, v85
    ds_write_b32 v109, v85
    v_add_lshl_u32 v110, v110, v118, 2
    v_lshl_or_b32 v86, v78, 16, v86
    ds_write_b32 v110, v86
    v_add_lshl_u32 v111, v111, v119, 2
    v_lshl_or_b32 v87, v79, 16, v87
    ds_write_b32 v111, v87
    s_mov_b64 exec, s[94:95]
    v_add_lshl_u32 v112, v112, v120, 2
    v_lshl_or_b32 v88, v80, 16, v88
    ds_write_b32 v112, v88
    v_add_lshl_u32 v113, v113, v121, 2
    v_lshl_or_b32 v89, v81, 16, v89
    ds_write_b32 v113, v89
    v_add_lshl_u32 v114, v114, v122, 2
    v_lshl_or_b32 v90, v82, 16, v90
    ds_write_b32 v114, v90
    v_add_lshl_u32 v115, v115, v123, 2
    v_lshl_or_b32 v91, v83, 16, v91
    ds_write_b32 v115, v91
    s_mov_b64 exec, 1
    v_mov_b32 v32, 160260
    v_mov_b32 v33, 1
    ds_add_u32 v32, v33
    s_mov_b64 exec, -1
    v_lshl_add_u32 v108, v108, 1, s65
    v_lshl_add_u32 v109, v109, 1, s65
    v_lshl_add_u32 v110, v110, 1, s65
    v_lshl_add_u32 v111, v111, 1, s65
    v_lshl_add_u32 v112, v112, 1, s65
    v_lshl_add_u32 v113, v113, 1, s65
    v_lshl_add_u32 v114, v114, 1, s65
    v_lshl_add_u32 v115, v115, 1, s65
    s_cmp_ge_u32 s3, 4
    s_cbranch_scc1 NOWS
    v_add_u32 v66, s69, v126
    ds_read_b128 v[192:195], v66 offset:19712
    ds_read_b128 v[196:199], v66 offset:20736
    ds_read_b128 v[200:203], v66 offset:21760
    ds_read_b128 v[204:207], v66 offset:22784
    s_mov_b32 s66, 0xbfb8aa3b
    s_mov_b32 s67, s66
    s_mov_b32 s68, 0xffff0000
    s_waitcnt lgkmcnt(3)
    v_lshlrev_b32 v68, 16, v192
    v_and_b32 v69, s68, v192
    v_pk_mul_f32 v[68:69], v[68:69], s[66:67]
    v_cvt_pk_bf16_f32 v192, v68, v69
    v_lshlrev_b32 v68, 16, v193
    v_and_b32 v69, s68, v193
    v_pk_mul_f32 v[68:69], v[68:69], s[66:67]
    v_cvt_pk_bf16_f32 v193, v68, v69
    v_lshlrev_b32 v68, 16, v194
    v_and_b32 v69, s68, v194
    v_pk_mul_f32 v[68:69], v[68:69], s[66:67]
    v_cvt_pk_bf16_f32 v194, v68, v69
    v_lshlrev_b32 v68, 16, v195
    v_and_b32 v69, s68, v195
    v_pk_mul_f32 v[68:69], v[68:69], s[66:67]
    v_cvt_pk_bf16_f32 v195, v68, v69
    ds_write_b128 v66, v[192:195] offset:19712
    s_waitcnt lgkmcnt(3)
    v_lshlrev_b32 v68, 16, v196
    v_and_b32 v69, s68, v196
    v_pk_mul_f32 v[68:69], v[68:69], s[66:67]
    v_cvt_pk_bf16_f32 v196, v68, v69
    v_lshlrev_b32 v68, 16, v197
    v_and_b32 v69, s68, v197
    v_pk_mul_f32 v[68:69], v[68:69], s[66:67]
    v_cvt_pk_bf16_f32 v197, v68, v69
    v_lshlrev_b32 v68, 16, v198
    v_and_b32 v69, s68, v198
    v_pk_mul_f32 v[68:69], v[68:69], s[66:67]
    v_cvt_pk_bf16_f32 v198, v68, v69
    v_lshlrev_b32 v68, 16, v199
    v_and_b32 v69, s68, v199
    v_pk_mul_f32 v[68:69], v[68:69], s[66:67]
    v_cvt_pk_bf16_f32 v199, v68, v69
    ds_write_b128 v66, v[196:199] offset:20736
    s_waitcnt lgkmcnt(3)
    v_lshlrev_b32 v68, 16, v200
    v_and_b32 v69, s68, v200
    v_pk_mul_f32 v[68:69], v[68:69], s[66:67]
    v_cvt_pk_bf16_f32 v200, v68, v69
    v_lshlrev_b32 v68, 16, v201
    v_and_b32 v69, s68, v201
    v_pk_mul_f32 v[68:69], v[68:69], s[66:67]
    v_cvt_pk_bf16_f32 v201, v68, v69
    v_lshlrev_b32 v68, 16, v202
    v_and_b32 v69, s68, v202
    v_pk_mul_f32 v[68:69], v[68:69], s[66:67]
    v_cvt_pk_bf16_f32 v202, v68, v69
    v_lshlrev_b32 v68, 16, v203
    v_and_b32 v69, s68, v203
    v_pk_mul_f32 v[68:69], v[68:69], s[66:67]
    v_cvt_pk_bf16_f32 v203, v68, v69
    ds_write_b128 v66, v[200:203] offset:21760
    s_waitcnt lgkmcnt(3)
    v_lshlrev_b32 v68, 16, v204
    v_and_b32 v69, s68, v204
    v_pk_mul_f32 v[68:69], v[68:69], s[66:67]
    v_cvt_pk_bf16_f32 v204, v68, v69
    v_lshlrev_b32 v68, 16, v205
    v_and_b32 v69, s68, v205
    v_pk_mul_f32 v[68:69], v[68:69], s[66:67]
    v_cvt_pk_bf16_f32 v205, v68, v69
    v_lshlrev_b32 v68, 16, v206
    v_and_b32 v69, s68, v206
    v_pk_mul_f32 v[68:69], v[68:69], s[66:67]
    v_cvt_pk_bf16_f32 v206, v68, v69
    v_lshlrev_b32 v68, 16, v207
    v_and_b32 v69, s68, v207
    v_pk_mul_f32 v[68:69], v[68:69], s[66:67]
    v_cvt_pk_bf16_f32 v207, v68, v69
    ds_write_b128 v66, v[204:207] offset:22784
NOWS:
    s_lshr_b32 s19, s3, 1
    s_lshl_b32 s19, s19, 6
    v_xor_b32 v42, s19, v126
    v_mov_b32 v44, 216
    v_add_u32 v43, 94400, v124
    v_cmp_lt_u32 vcc, 31, v1
    v_bfrev_b32 v187, 2
    v_mul_u32_u24 v184, 2176, v1
    s_mul_i32 s98, s3, 69632
    s_lshl_b32 s20, s27, 3
    s_add_u32 s98, s98, s20
    v_cndmask_b32 v184, v184, v187, vcc
    v_bfe_u32 v46, v1, 2, 2
    v_lshrrev_b32 v47, 5, v1
    v_lshl_add_u32 v47, v47, 5, v46
    v_lshlrev_b32 v47, 8, v47
    v_bfe_u32 v48, v1, 4, 1
    v_lshl_add_u32 v47, v48, 5, v47
    v_and_b32 v48, 3, v1
    v_lshl_add_u32 v47, v48, 3, v47
    v_add_u32 v47, 19712, v47
    v_xor_b32 v48, 0, v46
    v_lshl_add_u32 v176, v48, 6, v47
    v_xor_b32 v48, 1, v46
    v_lshl_add_u32 v177, v48, 6, v47
    v_xor_b32 v48, 2, v46
    v_lshl_add_u32 v178, v48, 6, v47
    v_xor_b32 v48, 3, v46
    v_lshl_add_u32 v179, v48, 6, v47
    s_waitcnt vmcnt(0)
    ds_write_b64 v108, v[92:93]
    ds_write_b64 v109, v[94:95]
    ds_write_b64 v110, v[96:97]
    ds_write_b64 v111, v[98:99]
    s_mov_b64 exec, s[94:95]
    ds_write_b64 v112, v[100:101]
    ds_write_b64 v113, v[102:103]
    ds_write_b64 v114, v[104:105]
    ds_write_b64 v115, v[106:107]
    s_mov_b64 exec, -1
    s_branch PRE_B4
SVC_MID:
    s_setprio 3
    s_barrier
    s_mov_b32 s76, s12
    s_mov_b32 s77, s13
    s_mov_b32 s78, 0x8400
    s_mov_b32 s79, 0x20000
    buffer_load_dwordx4 v127, s[76:79], s69 offen offset:0 lds
    buffer_load_dwordx4 v127, s[76:79], s69 offen offset:1024 lds
    buffer_load_dwordx4 v127, s[76:79], s69 offen offset:2048 lds
    buffer_load_dwordx4 v127, s[76:79], s69 offen offset:3072 lds
    s_mov_b32 s56, s14
    s_mov_b32 s57, s15
    s_mov_b32 s58, 0x100
    s_mov_b32 s59, 0x20000
    s_mov_b32 s52, s18
    s_mov_b32 s53, s19
    s_mov_b32 s54, 0x80
    s_mov_b32 s55, 0x20000
    s_mov_b32 s28, s4
    s_mov_b32 s29, s5
    s_mov_b32 s30, 0x30d400
    s_mov_b32 s31, 0x20000
    s_mov_b32 s64, 32768
    v_lshlrev_b32 v66, 2, v1
    buffer_load_dwordx4 v[76:79], v126, s[76:79], s64 offen
    buffer_load_dword v80, v66, s[56:59], 0 offen
    buffer_load_dword v81, v66, s[52:55], 0 offen
    s_mov_b32 s32, s20
    s_mov_b32 s33, s21
    s_mov_b32 s34, 0x30d400
    s_mov_b32 s35, 0x20000
    s_mov_b32 s36, s24
    s_mov_b32 s37, s25
    s_mov_b32 s38, 0x310000
    s_mov_b32 s39, 0x20000
    s_add_u32 s40, s24, 0x400000
    s_addc_u32 s41, s25, 0
    s_mov_b32 s42, 0x620000
    s_mov_b32 s43, 0x20000
    s_add_u32 s44, s24, 0xb00000
    s_addc_u32 s45, s25, 0
    s_mov_b32 s46, 0x90000
    s_mov_b32 s47, 0x20000
    s_mov_b32 s48, s16
    s_mov_b32 s49, s17
    s_mov_b32 s50, 0x4000
    s_mov_b32 s51, 0x20000
    s_mov_b32 s12, -1
    s_mov_b32 s13, 0
    s_mov_b32 s14, 0
    s_mov_b32 s15, -1
    s_mov_b32 s16, 0x12800000
    s_mov_b32 s17, 0x12800000
    s_movk_i32 s11, 128
    s_lshl_b32 s9, s3, 12
    s_add_u32 s9, s9, 125440
    s_lshr_b32 s19, s3, 1
    s_lshl_b32 s19, s19, 6
    v_xor_b32 v42, s19, v126
    v_mov_b32 v44, 216
    v_add_u32 v43, 94400, v124
    v_cmp_lt_u32 vcc, 31, v1
    v_bfrev_b32 v187, 2
    v_mul_u32_u24 v184, 2176, v1
    s_mul_i32 s98, s3, 69632
    s_lshl_b32 s20, s27, 3
    s_add_u32 s98, s98, s20
    v_cndmask_b32 v184, v184, v187, vcc
    v_bfe_u32 v46, v1, 2, 2
    v_lshrrev_b32 v47, 5, v1
    v_lshl_add_u32 v47, v47, 5, v46
    v_lshlrev_b32 v47, 8, v47
    v_bfe_u32 v48, v1, 4, 1
    v_lshl_add_u32 v47, v48, 5, v47
    v_and_b32 v48, 3, v1
    v_lshl_add_u32 v47, v48, 3, v47
    v_add_u32 v47, 19712, v47
    v_xor_b32 v48, 0, v46
    v_lshl_add_u32 v176, v48, 6, v47
    v_xor_b32 v48, 1, v46
    v_lshl_add_u32 v177, v48, 6, v47
    v_xor_b32 v48, 2, v46
    v_lshl_add_u32 v178, v48, 6, v47
    v_xor_b32 v48, 3, v46
    v_lshl_add_u32 v179, v48, 6, v47
    v_add_u32 v67, 158208, v126
    v_mov_b32 v32, 160256
SSB2:
    ds_read_b32 v33, v32
    s_waitcnt lgkmcnt(0)
    v_readfirstlane_b32 s18, v33
    s_cmp_eq_u32 s18, 7
    s_cbranch_scc1 SSB2_G
    s_sub_u32 s93, s93, 1
    s_cmp_lg_u32 s93, 0
    s_cbranch_scc1 SSB2
    s_endpgm
SSB2_G:
    s_buffer_load_dword s86, s[72:75], 0
    ds_read_b128 v[144:147], v67
    s_waitcnt lgkmcnt(0)
    v_add_u32 v149, v144, v145
    v_add_u32 v150, v149, v146
    v_add_u32 v152, v150, v147
    v_sub_u32 v153, 20464, v152
    s_nop 0
    v_add_u32_dpp v152, v152, v152 row_shr:1 row_mask:0xf bank_mask:0xf
    s_nop 1
    v_add_u32_dpp v152, v152, v152 row_shr:2 row_mask:0xf bank_mask:0xf
    s_nop 1
    v_add_u32_dpp v152, v152, v152 row_shr:4 row_mask:0xf bank_mask:0xf
    s_nop 1
    v_add_u32_dpp v152, v152, v152 row_shr:8 row_mask:0xf bank_mask:0xf
    s_nop 1
    v_add_u32_dpp v152, v152, v152 row_bcast:15 row_mask:0xa bank_mask:0xf
    s_nop 1
    v_add_u32_dpp v152, v152, v152 row_bcast:31 row_mask:0xc bank_mask:0xf
    v_add_u32 v148, v152, v153
    v_add_u32 v151, v148, v150
    v_add_u32 v150, v148, v149
    v_add_u32 v149, v148, v144
    v_mov_b32 v71, s86
    s_mul_i32 s64, s2, 3136
    s_sub_u32 s64, s64, 20464
    v_add_u32 v160, s64, v148
    v_lshl_or_b32 v160, v144, 20, v160
    v_add_u32 v162, s64, v149
    v_lshl_or_b32 v162, v145, 20, v162
    v_add_u32 v164, s64, v150
    v_lshl_or_b32 v164, v146, 20, v164
    v_add_u32 v166, s64, v151
    v_lshl_or_b32 v166, v147, 20, v166
    v_add_u32 v70, 81856, v126
    s_mul_i32 s64, s2, 12544
    v_lshlrev_b32 v100, 5, v1
    v_mov_b32 v32, 160260
SSB3:
    ds_read_b32 v33, v32
    s_waitcnt lgkmcnt(0)
    v_readfirstlane_b32 s18, v33
    s_cmp_eq_u32 s18, 7
    s_cbranch_scc1 SSB3_G
    s_sub_u32 s93, s93, 1
    s_cmp_lg_u32 s93, 0
    s_cbranch_scc1 SSB3
    s_endpgm
SSB3_G:
    ds_read_b128 v[192:195], v70 offset:0
    ds_read_b128 v[196:199], v70 offset:1024
    ds_read_b128 v[200:203], v70 offset:2048
    ds_read_b128 v[204:207], v70 offset:3072
    ds_read_b128 v[208:211], v70 offset:4096
    ds_read_b128 v[212:215], v70 offset:5120
    ds_read_b128 v[216:219], v70 offset:6144
    ds_read_b128 v[220:223], v70 offset:7168
    ds_read_b128 v[224:227], v70 offset:8192
    ds_read_b128 v[228:231], v70 offset:9216
    ds_read_b128 v[232:235], v70 offset:10240
    ds_read_b128 v[236:239], v70 offset:11264
    s_mov_b64 exec, 0xffff
    ds_read_b128 v[240:243], v70 offset:12288
    s_mov_b64 exec, -1
    s_waitcnt lgkmcnt(12)
    buffer_store_dwordx4 v[192:195], v126, s[36:39], s64 offen offset:0 sc1
    s_waitcnt lgkmcnt(11)
    buffer_store_dwordx4 v[196:199], v126, s[36:39], s64 offen offset:1024 sc1
    s_waitcnt lgkmcnt(10)
    buffer_store_dwordx4 v[200:203], v126, s[36:39], s64 offen offset:2048 sc1
    s_waitcnt lgkmcnt(9)
    buffer_store_dwordx4 v[204:207], v126, s[36:39], s64 offen offset:3072 sc1
    s_add_u32 s64, s64, 4096
    s_waitcnt lgkmcnt(8)
    buffer_store_dwordx4 v[208:211], v126, s[36:39], s64 offen offset:0 sc1
    s_waitcnt lgkmcnt(7)
    buffer_store_dwordx4 v[212:215], v126, s[36:39], s64 offen offset:1024 sc1
    s_waitcnt lgkmcnt(6)
    buffer_store_dwordx4 v[216:219], v126, s[36:39], s64 offen offset:2048 sc1
    s_waitcnt lgkmcnt(5)
    buffer_store_dwordx4 v[220:223], v126, s[36:39], s64 offen offset:3072 sc1
    s_add_u32 s64, s64, 4096
    s_waitcnt lgkmcnt(4)
    buffer_store_dwordx4 v[224:227], v126, s[36:39], s64 offen offset:0 sc1
    s_waitcnt lgkmcnt(3)
    buffer_store_dwordx4 v[228:231], v126, s[36:39], s64 offen offset:1024 sc1
    s_waitcnt lgkmcnt(2)
    buffer_store_dwordx4 v[232:235], v126, s[36:39], s64 offen offset:2048 sc1
    s_waitcnt lgkmcnt(1)
    buffer_store_dwordx4 v[236:239], v126, s[36:39], s64 offen offset:3072 sc1
    s_add_u32 s64, s64, 4096
    s_mov_b64 exec, 0xffff
    s_waitcnt lgkmcnt(0)
    buffer_store_dwordx4 v[240:243], v126, s[36:39], s64 offen offset:0 sc1
    s_mov_b64 exec, -1
    s_waitcnt vmcnt(13)
    s_mov_b32 s66, 0xbfb8aa3b
    s_mov_b32 s65, 0xffff0000
    v_lshlrev_b32 v66, 16, v76
    v_and_b32 v67, s65, v76
    v_mul_f32 v66, s66, v66
    v_mul_f32 v67, s66, v67
    v_cvt_pk_bf16_f32 v84, v66, v67
    v_lshlrev_b32 v68, 16, v84
    v_and_b32 v69, s65, v84
    v_sub_f32 v66, v66, v68
    v_sub_f32 v67, v67, v69
    v_cvt_pk_bf16_f32 v88, v66, v67
    v_lshlrev_b32 v66, 16, v77
    v_and_b32 v67, s65, v77
    v_mul_f32 v66, s66, v66
    v_mul_f32 v67, s66, v67
    v_cvt_pk_bf16_f32 v85, v66, v67
    v_lshlrev_b32 v68, 16, v85
    v_and_b32 v69, s65, v85
    v_sub_f32 v66, v66, v68
    v_sub_f32 v67, v67, v69
    v_cvt_pk_bf16_f32 v89, v66, v67
    v_lshlrev_b32 v66, 16, v78
    v_and_b32 v67, s65, v78
    v_mul_f32 v66, s66, v66
    v_mul_f32 v67, s66, v67
    v_cvt_pk_bf16_f32 v86, v66, v67
    v_lshlrev_b32 v68, 16, v86
    v_and_b32 v69, s65, v86
    v_sub_f32 v66, v66, v68
    v_sub_f32 v67, v67, v69
    v_cvt_pk_bf16_f32 v90, v66, v67
    v_lshlrev_b32 v66, 16, v79
    v_and_b32 v67, s65, v79
    v_mul_f32 v66, s66, v66
    v_mul_f32 v67, s66, v67
    v_cvt_pk_bf16_f32 v87, v66, v67
    v_lshlrev_b32 v68, 16, v87
    v_and_b32 v69, s65, v87
    v_sub_f32 v66, v66, v68
    v_sub_f32 v67, v67, v69
    v_cvt_pk_bf16_f32 v91, v66, v67
    v_lshrrev_b32 v66, 4, v1
    v_mul_u32_u24 v66, 272, v66
    v_and_b32 v67, 15, v1
    v_lshl_add_u32 v66, v67, 4, v66
    v_add_u32 v66, 79680, v66
    ds_write_b128 v66, v[84:87]
    ds_write_b128 v66, v[88:91] offset:1088
    v_lshlrev_b32 v92, 16, v80
    v_and_b32 v93, s65, v80
    v_lshlrev_b32 v94, 16, v81
    v_and_b32 v95, s65, v81
    v_lshlrev_b32 v66, 3, v1
    ds_write_b64 v66, v[92:93] offset:1024
    s_mov_b64 exec, s[12:13]
    ds_write_b64 v66, v[94:95] offset:256
    s_mov_b64 exec, -1
SVC_NPOLL:
    v_readfirstlane_b32 s66, v71
    s_cmp_lg_u32 s66, 0
    s_cbranch_scc1 SVC_NGOT
    buffer_load_dword v71, off, s[72:75], 0 sc1
    s_waitcnt vmcnt(0)
    s_sub_u32 s93, s93, 1
    s_cmp_lg_u32 s93, 0
    s_cbranch_scc1 SVC_NPOLL
    s_endpgm
SVC_NGOT:
    ds_write_b32 v44, v71
    s_mul_i32 s65, s2, 2176
    v_mov_b32 v161, v71
    v_mov_b32 v163, v71
    v_mov_b32 v165, v71
    v_mov_b32 v167, v71
    s_waitcnt vmcnt(0)
    buffer_store_dwordx4 v[160:163], v100, s[44:47], s65 offen sc1
    buffer_store_dwordx4 v[164:167], v100, s[44:47], s65 offen offset:16 sc1
    s_setprio 0
PRE_B4:
    s_mul_i32 s64, s2, 25088
    s_waitcnt lgkmcnt(0)
    s_barrier
    s_cmp_eq_u32 s3, 7
    s_cbranch_scc1 NOEC
    ds_read_b128 v[76:79], v43 offset:0
    ds_read_b128 v[80:83], v43 offset:7168
    ds_read_b128 v[84:87], v43 offset:14336
    s_cmp_ge_u32 s3, 4
    s_cbranch_scc1 NOPUB
    v_cmpx_gt_u32 vcc, 3584, v124
    ds_read_b128 v[88:91], v43 offset:21504
    s_add_u32 s66, s64, 21504
    s_waitcnt lgkmcnt(0)
    buffer_store_dwordx4 v[88:91], v124, s[40:43], s66 offen sc1
    s_mov_b64 exec, -1
NOPUB:
    s_waitcnt lgkmcnt(2)
    buffer_store_dwordx4 v[76:79], v124, s[40:43], s64 offen sc1
    s_add_u32 s64, s64, 7168
    s_waitcnt lgkmcnt(1)
    buffer_store_dwordx4 v[80:83], v124, s[40:43], s64 offen sc1
    s_add_u32 s64, s64, 7168
    s_waitcnt lgkmcnt(0)
    buffer_store_dwordx4 v[84:87], v124, s[40:43], s64 offen sc1
    s_add_u32 s64, s64, 7168
NOEC:
    ds_read_b32 v11, v44
    ds_read_b64_tr_b16 v[192:193], v176 offset:0
    ds_read_b64_tr_b16 v[194:195], v176 offset:1024
    ds_read_b64_tr_b16 v[196:197], v176 offset:2048
    ds_read_b64_tr_b16 v[198:199], v176 offset:3072
    ds_read_b64_tr_b16 v[200:201], v176 offset:4096
    ds_read_b64_tr_b16 v[202:203], v176 offset:5120
    ds_read_b64_tr_b16 v[204:205], v176 offset:6144
    ds_read_b64_tr_b16 v[206:207], v176 offset:7168
    ds_read_b64_tr_b16 v[208:209], v177 offset:0
    ds_read_b64_tr_b16 v[210:211], v177 offset:1024
    ds_read_b64_tr_b16 v[212:213], v177 offset:2048
    ds_read_b64_tr_b16 v[214:215], v177 offset:3072
    ds_read_b64_tr_b16 v[216:217], v177 offset:4096
    ds_read_b64_tr_b16 v[218:219], v177 offset:5120
    ds_read_b64_tr_b16 v[220:221], v177 offset:6144
    ds_read_b64_tr_b16 v[222:223], v177 offset:7168
    ds_read_b64_tr_b16 v[224:225], v178 offset:0
    ds_read_b64_tr_b16 v[226:227], v178 offset:1024
    ds_read_b64_tr_b16 v[228:229], v178 offset:2048
    ds_read_b64_tr_b16 v[230:231], v178 offset:3072
    ds_read_b64_tr_b16 v[232:233], v178 offset:4096
    ds_read_b64_tr_b16 v[234:235], v178 offset:5120
    ds_read_b64_tr_b16 v[236:237], v178 offset:6144
    ds_read_b64_tr_b16 v[238:239], v178 offset:7168
    ds_read_b64_tr_b16 v[240:241], v179 offset:0
    ds_read_b64_tr_b16 v[242:243], v179 offset:1024
    ds_read_b64_tr_b16 v[244:245], v179 offset:2048
    ds_read_b64_tr_b16 v[246:247], v179 offset:3072
    ds_read_b64_tr_b16 v[248:249], v179 offset:4096
    ds_read_b64_tr_b16 v[250:251], v179 offset:5120
    ds_read_b64_tr_b16 v[252:253], v179 offset:6144
    ds_read_b64_tr_b16 v[254:255], v179 offset:7168
    s_cmp_lg_u32 s3, 7
    s_cbranch_scc1 NOX2
    s_waitcnt lgkmcnt(0)
    v_lshrrev_b32 v66, 4, v1
    v_xor_b32 v66, v66, v1
    v_and_b32 v66, 7, v66
    v_lshrrev_b32 v67, 3, v1
    v_lshlrev_b32 v67, 7, v67
    v_lshl_add_u32 v66, v66, 4, v67
    v_xor_b32 v67, 64, v66
    s_lshl_b32 s64, s26, 7
    s_mov_b32 m0, 36096
    s_nop 0
    buffer_load_dwordx4 v66, s[28:31], s64 offen offset:0 lds
    buffer_load_dwordx4 v67, s[28:31], s64 offen offset:1024 lds
    buffer_load_dwordx4 v66, s[28:31], s64 offen offset:2048 lds
    buffer_load_dwordx4 v67, s[28:31], s64 offen offset:3072 lds
    s_add_u32 s64, s64, 4096
    s_mov_b32 m0, 40192
    s_nop 0
    buffer_load_dwordx4 v66, s[28:31], s64 offen offset:0 lds
    buffer_load_dwordx4 v67, s[28:31], s64 offen offset:1024 lds
    buffer_load_dwordx4 v66, s[28:31], s64 offen offset:2048 lds
    buffer_load_dwordx4 v67, s[28:31], s64 offen offset:3072 lds
    s_add_u32 s64, s64, 4096
    s_mov_b32 m0, 44288
    s_nop 0
    buffer_load_dwordx4 v66, s[28:31], s64 offen offset:0 lds
    buffer_load_dwordx4 v67, s[28:31], s64 offen offset:1024 lds
    buffer_load_dwordx4 v66, s[28:31], s64 offen offset:2048 lds
    buffer_load_dwordx4 v67, s[28:31], s64 offen offset:3072 lds
    s_add_u32 s64, s64, 4096
    s_mov_b32 m0, 48384
    s_nop 0
    buffer_load_dwordx4 v66, s[28:31], s64 offen offset:0 lds
NOX2:
    v_mov_b32 v148, 0xffff
    v_mov_b32 v149, 0xffff
    v_mov_b32 v150, 0xffff
    v_mov_b32 v151, 0xffff
    ds_write_b128 v124, v[148:151] offset:3328
    ds_write_b128 v124, v[148:151] offset:11520
    v_bfe_u32 v144, v1, 3, 2
    v_bfe_u32 v145, v1, 1, 1
    v_lshl_or_b32 v145, v144, 1, v145
    v_bfe_u32 v146, v1, 2, 1
    v_and_b32 v147, 1, v1
    v_lshl_or_b32 v146, v146, 1, v147
    v_lshrrev_b32 v149, 5, v1
    v_lshl_add_u32 v151, v145, 2, v146
    v_lshlrev_b32 v8, 2, v151
    v_lshlrev_b32 v6, 3, v151
    v_add_u32 v6, 19712, v6
    v_lshlrev_b32 v9, 6, v149
    v_bfe_u32 v151, v1, 4, 1
    v_and_b32 v152, 3, v1
    v_lshlrev_b32 v151, 5, v151
    v_lshl_add_u32 v151, v152, 3, v151
    v_add_u32 v20, 52480, v151
    v_bfe_u32 v151, v1, 2, 2
    v_mul_u32_u24 v152, 272, v151
    v_add_u32 v152, v152, v20
    v_add_u32 v21, 27200, v152
    v_add_u32 v22, 28288, v152
    v_lshlrev_b32 v23, 2, v151
    v_add_u32 v23, 2048, v23
    v_lshlrev_b32 v24, 3, v149
    v_add_u32 v24, 2048, v24
    v_and_b32 v151, 31, v1
    v_lshlrev_b32 v25, 3, v151
    v_add_u32 v25, 98240, v25
    s_lshl_b32 s22, s3, 11
    s_add_u32 s22, s22, 81856
    v_lshlrev_b32 v30, 5, v1
    v_add_u32 v30, s22, v30
    v_and_b32 v46, 31, v1
    v_bfe_u32 v47, v1, 1, 3
    v_lshrrev_b32 v48, 5, v1
    v_lshlrev_b32 v34, 7, v46
    v_lshl_add_u32 v34, v47, 4, v34
    v_xor_b32 v34, v9, v34
    s_lshr_b32 s19, s3, 1
    s_lshl_b32 s20, s19, 12
    v_add_u32 v34, s20, v34
    v_xor_b32 v35, 16, v34
    v_xor_b32 v36, 32, v34
    v_xor_b32 v37, 48, v34
    v_lshlrev_b32 v74, 7, v46
    s_lshl_b32 s20, s19, 5
    v_add_u32 v46, s20, v46
    s_movk_i32 s20, 100
    v_cmp_gt_u32 s[82:83], s20, v46
    s_and_b32 s21, s3, 1
    s_lshl_b32 s20, s21, 7
    s_add_u32 s20, s20, 52480
    v_mul_u32_u24 v38, 272, v46
    v_lshl_add_u32 v38, v48, 3, v38
    v_add_u32 v38, s20, v38
    s_lshl_b32 s20, s21, 8
    v_lshl_add_u32 v39, v48, 4, s20
    v_cmp_lt_u32 vcc, 31, v1
    s_lshl_b32 s21, s21, 7
    v_subrev_u32 v40, 19712, v176
    v_xor_b32 v40, s21, v40
    v_xor_b32 v41, 64, v40
    v_add_u32 v40, 141824, v40
    v_add_u32 v41, 141824, v41
    v_cndmask_b32 v74, v74, v187, vcc
    s_lshl_b32 s97, s3, 12
    s_add_u32 s97, s97, 557056
    s_mov_b32 s96, 0
    s_mul_i32 s99, s3, 1536
    s_add_u32 s99, s99, 81856
    v_lshl_add_u32 v188, v1, 4, s99
    v_lshl_add_u32 v185, v1, 2, s99
    v_lshlrev_b32 v186, 3, v1
    v_subrev_u32 v186, 4096, v186
    v_mov_b64 v[180:181], 0
    v_mov_b64 v[182:183], 0
    ds_write_b128 v188, v[180:183]
    ds_write_b32 v185, v180 offset:1024
    ds_read_b128 v[144:147], v39 offset:1024
    ds_read_b128 v[148:151], v39 offset:1056
    ds_read_b128 v[152:155], v39 offset:1088
    ds_read_b128 v[156:159], v39 offset:1120
    ds_read_b128 v[160:163], v39 offset:1152
    ds_read_b128 v[164:167], v39 offset:1184
    ds_read_b128 v[168:171], v39 offset:1216
    ds_read_b128 v[172:175], v39 offset:1248
    ds_read_b64_tr_b16 v[76:77], v40 offset:0
    ds_read_b64_tr_b16 v[78:79], v40 offset:1024
    ds_read_b64_tr_b16 v[80:81], v40 offset:2048
    ds_read_b64_tr_b16 v[82:83], v40 offset:3072
    ds_read_b64_tr_b16 v[84:85], v40 offset:4096
    ds_read_b64_tr_b16 v[86:87], v40 offset:5120
    ds_read_b64_tr_b16 v[88:89], v40 offset:6144
    ds_read_b64_tr_b16 v[90:91], v40 offset:7168
    ds_read_b64_tr_b16 v[92:93], v41 offset:0
    ds_read_b64_tr_b16 v[94:95], v41 offset:1024
    ds_read_b64_tr_b16 v[96:97], v41 offset:2048
    ds_read_b64_tr_b16 v[98:99], v41 offset:3072
    ds_read_b64_tr_b16 v[100:101], v41 offset:4096
    ds_read_b64_tr_b16 v[102:103], v41 offset:5120
    ds_read_b64_tr_b16 v[104:105], v41 offset:6144
    ds_read_b64_tr_b16 v[106:107], v41 offset:7168
    v_bfe_u32 v66, v1, 2, 2
    v_lshlrev_b32 v67, 12, v66
    v_lshrrev_b32 v68, 5, v1
    v_lshl_add_u32 v67, v68, 8, v67
    v_bfe_u32 v68, v1, 4, 1
    v_lshl_add_u32 v67, v68, 4, v67
    v_and_b32 v68, 1, v1
    v_lshl_add_u32 v67, v68, 5, v67
    v_bfe_u32 v68, v1, 1, 1
    v_lshl_add_u32 v67, v68, 3, v67
    s_and_b32 s18, s3, 1
    v_xor_b32 v66, s18, v66
    v_lshl_add_u32 v68, v66, 6, v67
    v_xor_b32 v69, 0x80, v68
    v_add_u32 v2, 125440, v68
    v_add_u32 v3, 125440, v69
    s_and_b32 s18, s3, 3
    s_lshl_b32 s18, s18, 12
    s_add_u32 s91, s18, 141824
    v_bfe_u32 v46, v8, 4, 3
    v_bfe_u32 v47, v8, 2, 2
    v_lshl_add_u32 v48, v47, 3, v46
    v_lshlrev_b32 v48, 7, v48
    v_and_b32 v46, 6, v46
    v_and_b32 v47, 1, v47
    v_or_b32 v46, v46, v47
    v_lshlrev_b32 v46, 4, v46
    v_xor_b32 v46, v9, v46
    v_add3_u32 v50, v46, v48, s91
    v_xor_b32 v51, 16, v50
    v_xor_b32 v52, 32, v50
    v_xor_b32 v53, 48, v50
    v_lshrrev_b32 v46, 3, v1
    v_lshlrev_b32 v54, 4, v46
    v_and_b32 v46, 6, v46
    v_and_b32 v47, 7, v1
    v_xor_b32 v46, v46, v47
    v_lshlrev_b32 v56, 4, v46
    v_xor_b32 v57, 16, v56
    v_lshrrev_b32 v70, 5, v1
    v_and_b32 v66, 31, v1
    s_lshr_b32 s20, s3, 1
    s_lshl_b32 s20, s20, 5
    v_add_u32 v67, s20, v66
    v_min_u32 v67, 99, v67
    v_lshlrev_b32 v68, 2, v67
    v_mul_u32_u24 v67, 272, v67
    v_lshl_add_u32 v67, v70, 4, v67
    v_add_u32 v67, 98240, v67
    v_mul_u32_u24 v66, 80, v66
    v_lshl_add_u32 v66, v70, 5, v66
    v_add_u32 v66, s9, v66
    s_and_b32 s22, s3, 1
    s_lshl_b32 s21, s22, 7
    v_lshl_add_u32 v71, v70, 6, s21
    s_add_u32 s21, s26, s20
    s_lshl_b32 s21, s21, 7
    s_lshl_b32 s22, s22, 6
    s_add_u32 s21, s21, s22
    v_lshrrev_b32 v70, 2, v1
    v_and_b32 v69, 3, v1
    v_lshlrev_b32 v69, 4, v69
    v_lshl_add_u32 v69, v70, 7, v69
    v_add_u32 v69, s21, v69
    s_waitcnt lgkmcnt(12)
    v_readfirstlane_b32 s92, v11
    v_mov_b32 v17, 0
    v_mov_b32 v112, v187
    s_cmp_eq_u32 s3, 7
    s_cbranch_scc1 ES_SVC
    s_waitcnt vmcnt(0)
    v_mov_b32 v32, 204
    v_mov_b32 v33, 1
    s_mov_b64 exec, 1
    ds_add_rtn_u32 v33, v32, v33
    s_mov_b64 exec, -1
    s_waitcnt lgkmcnt(0)
    v_readfirstlane_b32 s18, v33
    s_cmp_lg_u32 s18, 6
    s_cbranch_scc1 NOEPUB
    s_lshl_b32 s64, s2, 7
    s_add_u32 s64, s64, 557056
    s_mov_b64 exec, 1
    buffer_store_dword v11, off, s[44:47], s64 sc1
    s_mov_b64 exec, -1
NOEPUB:
    s_branch ES_J
ES_SVC:
    s_waitcnt vmcnt(0) lgkmcnt(0)
ES_J:
    s_barrier
    buffer_load_dwordx2 v[190:191], v184, s[44:47], s98 offen sc1
    ds_read_b128 v[128:131], v34 offset:36096
    ds_read_b128 v[132:135], v35 offset:36096
    ds_read_b128 v[136:139], v36 offset:36096
    ds_read_b128 v[140:143], v37 offset:36096
    ds_write_b128 v124, v[180:183] offset:19712
    ds_write_b128 v124, v[180:183] offset:27904
    s_mov_b32 s84, 0xbfb8aa3b
    s_mov_b32 s85, s84
    s_waitcnt lgkmcnt(2)
    v_mfma_f32_32x32x16_bf16 v[144:159], v[76:79], v[128:131], v[144:159]
    v_mfma_f32_32x32x16_bf16 v[144:159], v[80:83], v[132:135], v[144:159]
    v_mfma_f32_32x32x16_bf16 v[144:159], v[84:87], v[136:139], v[144:159]
    v_mfma_f32_32x32x16_bf16 v[144:159], v[88:91], v[140:143], v[144:159]
    v_mfma_f32_32x32x16_bf16 v[160:175], v[92:95], v[128:131], v[160:175]
    v_mfma_f32_32x32x16_bf16 v[160:175], v[96:99], v[132:135], v[160:175]
    v_mfma_f32_32x32x16_bf16 v[160:175], v[100:103], v[136:139], v[160:175]
    v_mfma_f32_32x32x16_bf16 v[160:175], v[104:107], v[140:143], v[160:175]
GPOLL:
    s_waitcnt vmcnt(0)
    v_cmp_eq_u32 vcc, s92, v191
    s_cmp_eq_u32 vcc_lo, -1
    s_cbranch_scc1 GGOT
    s_not_b64 exec, vcc
    buffer_load_dwordx2 v[190:191], v184, s[44:47], s98 offen sc1
    s_mov_b64 exec, -1
    s_sub_u32 s93, s93, 1
    s_cmp_lg_u32 s93, 0
    s_cbranch_scc1 GPOLL
    s_endpgm
GGOT:
    v_lshrrev_b32 v13, 20, v190
    v_add_u32 v13, 1, v13
    v_lshrrev_b32 v13, 1, v13
    v_mov_b32 v14, v13
    v_and_b32 v12, 0xfffff, v190
    v_lshlrev_b32 v12, 2, v12
    v_add_u32_dpp v14, v14, v14 row_shr:1 row_mask:0xf bank_mask:0xf
    v_add_u32 v12, 4096, v12
    v_cmp_lt_u32 s[18:19], 0, v13
    v_add_u32_dpp v14, v14, v14 row_shr:2 row_mask:0xf bank_mask:0xf
    s_nop 1
    v_add_u32_dpp v14, v14, v14 row_shr:4 row_mask:0xf bank_mask:0xf
    s_nop 1
    v_add_u32_dpp v14, v14, v14 row_shr:8 row_mask:0xf bank_mask:0xf
    s_nop 1
    v_add_u32_dpp v14, v14, v14 row_bcast:15 row_mask:0xa bank_mask:0xf
    v_sub_u32 v15, v14, v13
    v_lshlrev_b32 v26, 3, v15
    v_readlane_b32 s80, v14, 31
    v_sub_u32 v12, v12, v26
    v_lshl_add_u32 v26, v15, 2, s99
    s_mov_b64 exec, s[18:19]
    v_cmpx_gt_u32 vcc, 320, v15
    ds_write_b32 v26, v12
    s_mov_b64 exec, -1
    ds_read2st64_b32 v[108:109], v185 offset0:0 offset1:1
    ds_read2st64_b32 v[110:111], v185 offset0:2 offset1:3
    s_cmp_gt_u32 s80, 320
    s_cbranch_scc1 OVF
NOOVF:
    v_cmp_gt_i32 s[60:61], s80, v1
    s_sub_u32 s22, s80, 64
    v_cmp_gt_i32 s[64:65], s22, v1
    s_sub_u32 s22, s80, 128
    v_cmp_gt_i32 s[68:69], s22, v1
    s_sub_u32 s22, s80, 192
    v_cmp_gt_i32 s[72:73], s22, v1
    s_waitcnt lgkmcnt(0)
    v_max_u32_dpp v108, v108, v108 row_shr:1 row_mask:0xf bank_mask:0xf
    v_max_u32_dpp v109, v109, v109 row_shr:1 row_mask:0xf bank_mask:0xf
    v_max_u32_dpp v110, v110, v110 row_shr:1 row_mask:0xf bank_mask:0xf
    v_max_u32_dpp v111, v111, v111 row_shr:1 row_mask:0xf bank_mask:0xf
    v_max_u32_dpp v108, v108, v108 row_shr:2 row_mask:0xf bank_mask:0xf
    v_max_u32_dpp v109, v109, v109 row_shr:2 row_mask:0xf bank_mask:0xf
    v_max_u32_dpp v110, v110, v110 row_shr:2 row_mask:0xf bank_mask:0xf
    v_max_u32_dpp v111, v111, v111 row_shr:2 row_mask:0xf bank_mask:0xf
    v_max_u32_dpp v108, v108, v108 row_shr:4 row_mask:0xf bank_mask:0xf
    v_max_u32_dpp v109, v109, v109 row_shr:4 row_mask:0xf bank_mask:0xf
    v_max_u32_dpp v110, v110, v110 row_shr:4 row_mask:0xf bank_mask:0xf
    v_max_u32_dpp v111, v111, v111 row_shr:4 row_mask:0xf bank_mask:0xf
    v_max_u32_dpp v108, v108, v108 row_shr:8 row_mask:0xf bank_mask:0xf
    v_max_u32_dpp v109, v109, v109 row_shr:8 row_mask:0xf bank_mask:0xf
    v_max_u32_dpp v110, v110, v110 row_shr:8 row_mask:0xf bank_mask:0xf
    v_max_u32_dpp v111, v111, v111 row_shr:8 row_mask:0xf bank_mask:0xf
    v_max_u32_dpp v108, v108, v108 row_bcast:15 row_mask:0xa bank_mask:0xf
    v_max_u32_dpp v109, v109, v109 row_bcast:15 row_mask:0xa bank_mask:0xf
    v_max_u32_dpp v110, v110, v110 row_bcast:15 row_mask:0xa bank_mask:0xf
    v_max_u32_dpp v111, v111, v111 row_bcast:15 row_mask:0xa bank_mask:0xf
    v_max_u32_dpp v108, v108, v108 row_bcast:31 row_mask:0xc bank_mask:0xf
    v_max_u32_dpp v109, v109, v109 row_bcast:31 row_mask:0xc bank_mask:0xf
    v_max_u32_dpp v110, v110, v110 row_bcast:31 row_mask:0xc bank_mask:0xf
    v_max_u32_dpp v111, v111, v111 row_bcast:31 row_mask:0xc bank_mask:0xf
    v_readlane_b32 s18, v108, 63
    v_readlane_b32 s19, v109, 63
    v_readlane_b32 s20, v110, 63
    v_readlane_b32 s81, v111, 63
    v_add_u32 v108, v108, v186
    v_cndmask_b32 v108, v187, v108, s[60:61]
    buffer_load_dwordx2 v[114:115], v108, s[36:39], 0 offen offset:0 sc1
    s_max_u32 s19, s19, s18
    v_max_u32 v109, s18, v109
    v_add_u32 v109, v109, v186
    v_cndmask_b32 v109, v187, v109, s[64:65]
    buffer_load_dwordx2 v[116:117], v109, s[36:39], 0 offen offset:512 sc1
    s_max_u32 s20, s20, s19
    v_max_u32 v110, s19, v110
    v_add_u32 v110, v110, v186
    v_cndmask_b32 v110, v187, v110, s[68:69]
    buffer_load_dwordx2 v[118:119], v110, s[36:39], 0 offen offset:1024 sc1
    s_max_u32 s81, s81, s20
    v_max_u32 v111, s20, v111
    v_add_u32 v111, v111, v186
    v_cndmask_b32 v111, v187, v111, s[72:73]
    buffer_load_dwordx2 v[120:121], v111, s[36:39], 0 offen offset:1536 sc1
    s_lshl_b32 s21, s3, 11
    s_add_u32 m0, s21, 125440
    s_nop 0
    buffer_load_dwordx4 v42, s[48:51], s21 offen offset:0 lds
    buffer_load_dwordx4 v42, s[48:51], s21 offen offset:1024 lds
    s_mov_b64 exec, s[82:83]
    v_pk_mul_f32 v[144:145], v[144:145], s[84:85]
    v_pk_mul_f32 v[146:147], v[146:147], s[84:85]
    v_cvt_pk_bf16_f32 v144, v144, v145
    v_cvt_pk_bf16_f32 v145, v146, v147
    ds_write_b64 v38, v[144:145] offset:0
    v_pk_mul_f32 v[148:149], v[148:149], s[84:85]
    v_pk_mul_f32 v[150:151], v[150:151], s[84:85]
    v_cvt_pk_bf16_f32 v148, v148, v149
    v_cvt_pk_bf16_f32 v149, v150, v151
    ds_write_b64 v38, v[148:149] offset:16
    v_pk_mul_f32 v[152:153], v[152:153], s[84:85]
    v_pk_mul_f32 v[154:155], v[154:155], s[84:85]
    v_cvt_pk_bf16_f32 v152, v152, v153
    v_cvt_pk_bf16_f32 v153, v154, v155
    ds_write_b64 v38, v[152:153] offset:32
    v_pk_mul_f32 v[156:157], v[156:157], s[84:85]
    v_pk_mul_f32 v[158:159], v[158:159], s[84:85]
    v_cvt_pk_bf16_f32 v156, v156, v157
    v_cvt_pk_bf16_f32 v157, v158, v159
    ds_write_b64 v38, v[156:157] offset:48
    v_pk_mul_f32 v[160:161], v[160:161], s[84:85]
    v_pk_mul_f32 v[162:163], v[162:163], s[84:85]
    v_cvt_pk_bf16_f32 v160, v160, v161
    v_cvt_pk_bf16_f32 v161, v162, v163
    ds_write_b64 v38, v[160:161] offset:64
    v_pk_mul_f32 v[164:165], v[164:165], s[84:85]
    v_pk_mul_f32 v[166:167], v[166:167], s[84:85]
    v_cvt_pk_bf16_f32 v164, v164, v165
    v_cvt_pk_bf16_f32 v165, v166, v167
    ds_write_b64 v38, v[164:165] offset:80
    v_pk_mul_f32 v[168:169], v[168:169], s[84:85]
    v_pk_mul_f32 v[170:171], v[170:171], s[84:85]
    v_cvt_pk_bf16_f32 v168, v168, v169
    v_cvt_pk_bf16_f32 v169, v170, v171
    ds_write_b64 v38, v[168:169] offset:96
    v_pk_mul_f32 v[172:173], v[172:173], s[84:85]
    v_pk_mul_f32 v[174:175], v[174:175], s[84:85]
    v_cvt_pk_bf16_f32 v172, v172, v173
    v_cvt_pk_bf16_f32 v173, v174, v175
    ds_write_b64 v38, v[172:173] offset:112
    s_mov_b64 exec, -1
    v_lshlrev_b32 v108, 1, v108
    v_lshlrev_b32 v109, 1, v109
    v_lshlrev_b32 v110, 1, v110
    v_lshlrev_b32 v111, 1, v111
    v_lshlrev_b32 v13, 2, v1
    v_mov_b32 v14, 192
    s_lshl_b32 s18, s26, 2
    s_sub_u32 s18, 512, s18
    v_mov_b32 v12, 16
    s_lshl_b32 s19, s89, 2
    s_add_u32 s19, s19, 512
    s_mov_b32 s23, 0xffff
    s_waitcnt vmcnt(5)
    s_mov_b64 exec, s[60:61]
    v_mad_u32_u16 v140, v114, 4, s18 op_sel:[1,0,0,0]
    v_mad_u32_u16 v141, v115, 4, s18 op_sel:[1,0,0,0]
    ds_add_rtn_u32 v96, v140, v12
    v_cmpx_gt_u32 s[62:63], s19, v141
    ds_add_rtn_u32 v97, v141, v12
    s_waitcnt vmcnt(4)
    s_mov_b64 exec, s[64:65]
    v_mad_u32_u16 v142, v116, 4, s18 op_sel:[1,0,0,0]
    v_mad_u32_u16 v143, v117, 4, s18 op_sel:[1,0,0,0]
    ds_add_rtn_u32 v98, v142, v12
    v_cmpx_gt_u32 s[66:67], s19, v143
    ds_add_rtn_u32 v99, v143, v12
    s_waitcnt vmcnt(3)
    s_mov_b64 exec, s[68:69]
    v_mad_u32_u16 v144, v118, 4, s18 op_sel:[1,0,0,0]
    v_mad_u32_u16 v145, v119, 4, s18 op_sel:[1,0,0,0]
    ds_add_rtn_u32 v100, v144, v12
    v_cmpx_gt_u32 s[70:71], s19, v145
    ds_add_rtn_u32 v101, v145, v12
    s_waitcnt vmcnt(2)
    s_mov_b64 exec, s[72:73]
    v_mad_u32_u16 v146, v120, 4, s18 op_sel:[1,0,0,0]
    v_mad_u32_u16 v147, v121, 4, s18 op_sel:[1,0,0,0]
    ds_add_rtn_u32 v102, v146, v12
    v_cmpx_gt_u32 s[74:75], s19, v147
    ds_add_rtn_u32 v103, v147, v12
    s_mov_b64 exec, -1
    s_cmp_gt_u32 s80, 256
    s_cbranch_scc1 R5_k
R5J_k:
    buffer_load_dword v113, v74, s[44:47], s97 offen sc1
    s_waitcnt lgkmcnt(0)
    s_barrier
    s_cmp_lg_u32 s3, 0
    s_cbranch_scc1 NOSCH
    ds_read2st64_b32 v[156:157], v13 offset0:2 offset1:3
    s_sub_u32 s20, s89, 64
    s_bfm_b64 s[18:19], s20, 0
    v_mov_b32 v172, 1
    v_mul_u32_u24 v166, 272, v1
    v_add_u32 v167, 17408, v166
    s_waitcnt lgkmcnt(0)
    v_lshrrev_b32 v156, 4, v156
    v_min_u32 v158, 63, v156
    v_sub_u32 v158, 63, v158
    v_lshlrev_b32 v158, 2, v158
    v_lshrrev_b32 v157, 4, v157
    v_min_u32 v159, 63, v157
    v_sub_u32 v159, 63, v159
    v_lshlrev_b32 v159, 2, v159
    ds_add_rtn_u32 v160, v158, v172 offset:2560
    s_mov_b64 exec, s[18:19]
    ds_add_rtn_u32 v161, v159, v172 offset:2560
    s_mov_b64 exec, -1
    ds_read_b32 v162, v13 offset:2560
    s_waitcnt lgkmcnt(0)
    v_mov_b32 v163, v162
    s_nop 1
    v_add_u32_dpp v163, v163, v163 row_shr:1 row_mask:0xf bank_mask:0xf
    s_nop 1
    v_add_u32_dpp v163, v163, v163 row_shr:2 row_mask:0xf bank_mask:0xf
    s_nop 1
    v_add_u32_dpp v163, v163, v163 row_shr:4 row_mask:0xf bank_mask:0xf
    s_nop 1
    v_add_u32_dpp v163, v163, v163 row_shr:8 row_mask:0xf bank_mask:0xf
    s_nop 1
    v_add_u32_dpp v163, v163, v163 row_bcast:15 row_mask:0xa bank_mask:0xf
    s_nop 1
    v_add_u32_dpp v163, v163, v163 row_bcast:31 row_mask:0xc bank_mask:0xf
    v_sub_u32 v163, v163, v162
    ds_bpermute_b32 v164, v158, v163
    ds_bpermute_b32 v165, v159, v163
    s_waitcnt lgkmcnt(0)
    v_add_u32 v164, v164, v160
    v_and_b32 v168, -4, v164
    v_lshlrev_b32 v174, 2, v164
    v_add_u32 v165, v165, v161
    v_and_b32 v169, -4, v165
    v_lshlrev_b32 v175, 2, v165
    ds_max_u32 v168, v156 offset:2816
    ds_write_b32 v174, v166 offset:2048
    s_mov_b64 exec, s[18:19]
    ds_max_u32 v169, v157 offset:2816
    ds_write_b32 v175, v167 offset:2048
    s_mov_b64 exec, -1
    ds_read_b32 v162, v13 offset:2816
    v_and_b32 v170, 7, v164
    v_lshlrev_b32 v170, 20, v170
    v_add_u32 v170, 0x100000, v170
    v_and_b32 v174, 12, v174
    v_or_b32 v170, v170, v174
    v_and_b32 v171, 7, v165
    v_lshlrev_b32 v171, 20, v171
    v_add_u32 v171, 0x100000, v171
    v_and_b32 v175, 12, v175
    v_or_b32 v171, v171, v175
    s_waitcnt lgkmcnt(0)
    v_mov_b32 v163, v162
    v_mov_b32 v173, v162
    s_nop 1
    v_add_u32_dpp v163, v163, v163 row_shr:1 row_mask:0xf bank_mask:0xf
    v_max_u32_dpp v173, v173, v173 row_shr:1 row_mask:0xf bank_mask:0xf
    s_nop 0
    v_add_u32_dpp v163, v163, v163 row_shr:2 row_mask:0xf bank_mask:0xf
    v_max_u32_dpp v173, v173, v173 row_shr:2 row_mask:0xf bank_mask:0xf
    s_nop 0
    v_add_u32_dpp v163, v163, v163 row_shr:4 row_mask:0xf bank_mask:0xf
    v_max_u32_dpp v173, v173, v173 row_shr:4 row_mask:0xf bank_mask:0xf
    s_nop 0
    v_add_u32_dpp v163, v163, v163 row_shr:8 row_mask:0xf bank_mask:0xf
    v_max_u32_dpp v173, v173, v173 row_shr:8 row_mask:0xf bank_mask:0xf
    s_nop 0
    v_add_u32_dpp v163, v163, v163 row_bcast:15 row_mask:0xa bank_mask:0xf
    v_max_u32_dpp v173, v173, v173 row_bcast:15 row_mask:0xa bank_mask:0xf
    v_sub_u32 v163, v163, v162
    ds_bpermute_b32 v164, v168, v163
    ds_bpermute_b32 v165, v169, v163
    v_cmp_ge_u32 vcc, s90, v1
    v_mov_b32 v160, 0x7fffffff
    v_mov_b32 v161, 196
    v_cndmask_b32 v163, v160, v163, vcc
    ds_write_b32 v13, v163 offset:3072
    s_brev_b32 s20, 1
    s_mov_b32 s21, 0
    s_mov_b64 exec, s[20:21]
    ds_write_b32 v161, v173
    s_mov_b64 exec, -1
    s_waitcnt lgkmcnt(2)
    v_lshl_add_u32 v170, v164, 4, v170
    v_lshl_add_u32 v171, v165, 4, v171
    ds_write2st64_b32 v13, v170, v171 offset0:6 offset1:7
    s_waitcnt lgkmcnt(0)
    s_barrier
    s_waitcnt vmcnt(0)
    v_cmp_eq_u32 vcc, s92, v113
    s_cmp_eq_u32 vcc_lo, -1
    s_cbranch_scc0 E_NOTYETw0
    s_mov_b32 s96, 1
    buffer_load_dwordx4 v[76:79], v108, s[40:43], 0 offen offset:0 sc1
    buffer_load_dwordx4 v[80:83], v109, s[40:43], 0 offen offset:1024 sc1
    buffer_load_dwordx4 v[84:87], v110, s[40:43], 0 offen offset:2048 sc1
    buffer_load_dwordx4 v[88:91], v111, s[40:43], 0 offen offset:3072 sc1
    s_cmp_gt_u32 s80, 256
    s_cbranch_scc1 R5_e1
R5J_e1:
E_Jw0:
    ds_write_b128 v124, v[180:183] offset:36096
    ds_write_b128 v124, v[180:183] offset:44288
    s_branch SCHJ
NOSCH:
    ds_write_b128 v124, v[180:183] offset:36096
    ds_write_b128 v124, v[180:183] offset:44288
    s_waitcnt vmcnt(0)
    v_cmp_eq_u32 vcc, s92, v113
    s_cmp_eq_u32 vcc_lo, -1
    s_cbranch_scc0 E_NOTYET0
    s_mov_b32 s96, 1
    buffer_load_dwordx4 v[76:79], v108, s[40:43], 0 offen offset:0 sc1
    buffer_load_dwordx4 v[80:83], v109, s[40:43], 0 offen offset:1024 sc1
    buffer_load_dwordx4 v[84:87], v110, s[40:43], 0 offen offset:2048 sc1
    buffer_load_dwordx4 v[88:91], v111, s[40:43], 0 offen offset:3072 sc1
    s_cmp_gt_u32 s80, 256
    s_cbranch_scc1 R5_e2
R5J_e2:
E_J0:
    s_barrier
SCHJ:
    ds_read_b32 v16, v13 offset:3072
    ds_read_b64 v[26:27], v14
    s_mov_b64 exec, s[60:61]
    ds_read_b32 v124, v140 offset:1024
    s_mov_b64 exec, s[62:63]
    ds_read_b32 v125, v141 offset:1024
    s_mov_b64 exec, s[64:65]
    ds_read_b32 v126, v142 offset:1024
    s_mov_b64 exec, s[66:67]
    ds_read_b32 v127, v143 offset:1024
    s_mov_b64 exec, s[68:69]
    ds_read_b32 v128, v144 offset:1024
    s_mov_b64 exec, s[70:71]
    ds_read_b32 v129, v145 offset:1024
    s_mov_b64 exec, s[72:73]
    ds_read_b32 v130, v146 offset:1024
    s_mov_b64 exec, s[74:75]
    ds_read_b32 v131, v147 offset:1024
    s_mov_b64 exec, -1
    s_waitcnt lgkmcnt(0)
    v_readlane_b32 s18, v16, s90
    v_readfirstlane_b32 s99, v26
    v_readfirstlane_b32 s20, v27
    s_add_u32 s18, s18, 7
    s_lshr_b32 s18, s18, 3
    s_cmp_gt_u32 s18, 126
    s_cselect_b32 s99, 1, s99
    s_cselect_b32 s18, 0, s18
    s_cmp_lg_u32 s99, 0
    s_cbranch_scc1 NOKSC
    s_mov_b64 exec, s[60:61]
    v_mad_u32_u16 v96, v124, 1, v96
    v_bfi_b32 v114, s23, v114, v124
    ds_write_b32 v96, v114 offset:3328
    s_mov_b64 exec, s[62:63]
    v_mad_u32_u16 v97, v125, 1, v97
    v_bfi_b32 v115, s23, v115, v125
    ds_write_b32 v97, v115 offset:3328
    s_mov_b64 exec, s[64:65]
    v_mad_u32_u16 v98, v126, 1, v98
    v_bfi_b32 v116, s23, v116, v126
    ds_write_b32 v98, v116 offset:3328
    s_mov_b64 exec, s[66:67]
    v_mad_u32_u16 v99, v127, 1, v99
    v_bfi_b32 v117, s23, v117, v127
    ds_write_b32 v99, v117 offset:3328
    s_mov_b64 exec, s[68:69]
    v_mad_u32_u16 v100, v128, 1, v100
    v_bfi_b32 v118, s23, v118, v128
    ds_write_b32 v100, v118 offset:3328
    s_mov_b64 exec, s[70:71]
    v_mad_u32_u16 v101, v129, 1, v101
    v_bfi_b32 v119, s23, v119, v129
    ds_write_b32 v101, v119 offset:3328
    s_mov_b64 exec, s[72:73]
    v_mad_u32_u16 v102, v130, 1, v102
    v_bfi_b32 v120, s23, v120, v130
    ds_write_b32 v102, v120 offset:3328
    s_mov_b64 exec, s[74:75]
    v_mad_u32_u16 v103, v131, 1, v103
    v_bfi_b32 v121, s23, v121, v131
    ds_write_b32 v103, v121 offset:3328
    s_mov_b64 exec, -1
    s_cmp_gt_u32 s80, 256
    s_cbranch_scc1 R5_s
R5J_s:
NOKSC:
    s_lshr_b32 s19, s18, 3
    s_and_b32 s21, s18, 7
    s_add_u32 s20, s20, 7
    s_lshr_b32 s20, s20, 3
    s_cmp_lt_u32 s19, s20
    s_cselect_b32 s21, 0, s21
    s_max_u32 s19, s19, s20
    s_mul_i32 s4, s3, s19
    s_min_u32 s22, s3, s21
    s_add_u32 s4, s4, s22
    s_add_u32 s5, s4, s19
    s_cmp_lt_u32 s3, s21
    s_addc_u32 s5, s5, 0
    s_min_u32 s5, s5, s18
    s_min_u32 s4, s4, s18
    s_lshl_b32 s18, s4, 7
    v_add_u32 v8, s18, v8
    v_add_u32 v54, s18, v54
    s_waitcnt lgkmcnt(0)
    s_barrier
    ds_read_b128 v[60:63], v54 offset:3328
    ds_read_b32 v14, v8 offset:3328
    ds_read_b32 v12, v8 offset:3456
    s_lshl_b32 s18, s4, 8
    v_add_u32 v6, s18, v6
    s_lshl_b32 s4, s4, 3
    s_lshl_b32 s5, s5, 3
    v_cmp_ge_u32 vcc, s4, v16
    v_add_u32 v8, 256, v8
    s_bcnt1_i32_b64 s21, vcc
    s_sub_u32 s6, s21, 1
    s_add_u32 s18, s6, 1
    s_and_b32 s18, s18, -2
    s_lshl_b32 s18, s18, 4
    s_add_u32 s19, s6, 0
    s_or_b32 s19, s19, 1
    s_lshl_b32 s19, s19, 4
    v_add_u32 v28, s18, v23
    v_add_u32 v29, s19, v23
    ds_read_b32 v28, v28
    ds_read_b32 v29, v29
    s_waitcnt lgkmcnt(2)
    v_mad_u32_u16 v15, v14, s11, v9
    v_mad_u32_u16 v13, v12, s11, v9
    v_lshrrev_b32 v11, 16, v14
    s_cmp_lt_u32 s3, 4
    s_cbranch_scc1 DF1
    s_add_u32 m0, s91, 0
    v_mad_u32_u16 v60, v60, s11, v56
    buffer_load_dwordx4 v60, s[28:31], 0 offen lds
    s_add_u32 m0, s91, 1024
    v_mad_u32_u16 v61, v61, s11, v57
    buffer_load_dwordx4 v61, s[28:31], 0 offen lds
    s_add_u32 m0, s91, 2048
    v_mad_u32_u16 v62, v62, s11, v56
    buffer_load_dwordx4 v62, s[28:31], 0 offen lds
    s_add_u32 m0, s91, 3072
    v_mad_u32_u16 v63, v63, s11, v57
    buffer_load_dwordx4 v63, s[28:31], 0 offen lds
DF1:
    v_readlane_b32 s7, v16, s21
    v_readlane_b32 s19, v16, s6
    v_lshlrev_b32 v96, 1, v96
    v_lshlrev_b32 v97, 1, v97
    v_lshlrev_b32 v98, 1, v98
    v_lshlrev_b32 v99, 1, v99
    v_lshlrev_b32 v100, 1, v100
    v_lshlrev_b32 v101, 1, v101
    v_lshlrev_b32 v102, 1, v102
    v_lshlrev_b32 v103, 1, v103
    s_cmp_eq_u32 s19, s4
    s_cselect_b32 s8, 1, 0
    s_waitcnt lgkmcnt(0)
    s_mov_b64 exec, s[12:13]
    v_add_u32 v21, v28, v20
    v_add_u32 v22, v29, v20
    s_mov_b64 exec, -1
    ds_read_b64_tr_b16 v[176:177], v21 offset:0
    ds_read_b64_tr_b16 v[178:179], v22 offset:0
    ds_read_b64_tr_b16 v[180:181], v21 offset:64
    ds_read_b64_tr_b16 v[182:183], v22 offset:64
    ds_read_b64_tr_b16 v[184:185], v21 offset:128
    ds_read_b64_tr_b16 v[186:187], v22 offset:128
    ds_read_b64_tr_b16 v[188:189], v21 offset:192
    ds_read_b64_tr_b16 v[190:191], v22 offset:192
    s_waitcnt vmcnt(4)
    s_cmp_ge_u32 s3, 4
    s_cbranch_scc1 DF2
    s_waitcnt vmcnt(0)
DF2:
    s_cmp_eq_u32 s96, 0
    s_cbranch_scc1 E_CHK
E_HAVE:
    s_cmp_ge_u32 s3, 4
    s_cbranch_scc1 DF3
    buffer_load_dwordx4 v[156:159], v15, s[28:31], 0 offen offset:0
    buffer_load_dwordx4 v[160:163], v15, s[28:31], 0 offen offset:16
    buffer_load_dwordx4 v[164:167], v15, s[28:31], 0 offen offset:32
    buffer_load_dwordx4 v[168:171], v15, s[28:31], 0 offen offset:48
DF3:
    s_cmp_lg_u32 s99, 0
    s_cbranch_scc1 M_FALLBACK
    s_mov_b64 exec, s[60:61]
    ds_write_b64 v96, v[76:77] offset:19712
    s_mov_b64 exec, s[62:63]
    ds_write_b64 v97, v[78:79] offset:19712
    s_mov_b64 exec, s[64:65]
    ds_write_b64 v98, v[80:81] offset:19712
    s_mov_b64 exec, s[66:67]
    ds_write_b64 v99, v[82:83] offset:19712
    s_mov_b64 exec, s[68:69]
    ds_write_b64 v100, v[84:85] offset:19712
    s_mov_b64 exec, s[70:71]
    ds_write_b64 v101, v[86:87] offset:19712
    s_mov_b64 exec, s[72:73]
    ds_write_b64 v102, v[88:89] offset:19712
    s_mov_b64 exec, s[74:75]
    ds_write_b64 v103, v[90:91] offset:19712
    s_mov_b64 exec, -1
    s_cmp_gt_u32 s80, 256
    s_cbranch_scc1 R5_x
R5J_x:
    s_max_u32 s92, s5, 16
    s_sub_u32 s92, s92, 16
    s_sub_u32 s88, s5, 8
    v_mov_b64 v[92:93], 0
    v_mov_b64 v[94:95], s[16:17]
    v_mov_b64 v[96:97], 0
    v_mov_b64 v[98:99], s[16:17]
    v_mov_b64 v[100:101], 0
    v_mov_b64 v[102:103], s[16:17]
    v_mov_b64 v[104:105], 0
    v_mov_b64 v[106:107], s[16:17]
    v_mov_b64 v[18:19], 0
    s_waitcnt lgkmcnt(0)
    s_barrier
    s_mov_b64 exec, s[12:13]
    ds_read_b128 v[172:175], v11
    s_mov_b64 exec, s[14:15]
    ds_read2_b64 v[172:175], v6 offset0:0 offset1:0
    s_mov_b64 exec, -1
    s_cmp_lt_u32 s3, 4
    s_cbranch_scc1 FS1
    s_waitcnt vmcnt(0)
    ds_read_b128 v[156:159], v50
    ds_read_b128 v[160:163], v51
    ds_read_b128 v[164:167], v52
    ds_read_b128 v[168:171], v53
FS1:
    v_add_u32 v6, 256, v6
    v_lshrrev_b32 v11, 16, v12
    s_cmp_ge_u32 s4, s5
    s_cbranch_scc1 M_LOOPEXIT
    s_waitcnt lgkmcnt(0)
    v_mfma_f32_32x32x16_bf16 v[124:139], v[172:175], v[176:179], 0
    s_waitcnt vmcnt(3)
    v_mfma_f32_32x32x16_bf16 v[124:139], v[156:159], v[192:195], v[124:139]
    s_waitcnt vmcnt(2)
    v_mfma_f32_32x32x16_bf16 v[124:139], v[160:163], v[196:199], v[124:139]
    s_waitcnt vmcnt(1)
    v_mfma_f32_32x32x16_bf16 v[124:139], v[164:167], v[200:203], v[124:139]
    s_waitcnt vmcnt(0)
    v_mfma_f32_32x32x16_bf16 v[124:139], v[168:171], v[204:207], v[124:139]
    buffer_load_dwordx4 v[34:37], v13, s[28:31], 0 offen offset:0
    buffer_load_dwordx4 v[38:41], v13, s[28:31], 0 offen offset:16
    buffer_load_dwordx4 v[42:45], v13, s[28:31], 0 offen offset:32
    buffer_load_dwordx4 v[46:49], v13, s[28:31], 0 offen offset:48
    s_nop 3
    s_add_u32 s98, s4, s5
    s_lshr_b32 s98, s98, 1
    s_add_u32 s98, s98, 20
    s_min_u32 s98, s98, s5
    s_cmp_lt_u32 s3, 4
    s_cbranch_scc1 NOPRIO
    s_setprio 1
NOPRIO:
    s_branch M_LOOP0
M_CHK0:
    s_setprio 0
    s_mov_b32 s98, s5
    s_cmp_ge_u32 s4, s5
    s_cbranch_scc1 M_LOOPEXIT
    s_branch M_LOOP0
M_CHK1:
    s_setprio 0
    s_mov_b32 s98, s5
    s_cmp_ge_u32 s4, s5
    s_cbranch_scc1 M_LOOPEXIT
    s_branch M_LOOP1
    .p2align 6
M_LOOP0:
    s_sub_u32 s10, s7, s4
    s_cmp_le_u32 s10, 8
    s_cbranch_scc1 M_DISP0
    v_mfma_f32_32x32x16_bf16 v[140:155], v[156:159], v[208:211], 0
    v_exp_f32 v108, v124
    v_exp_f32 v109, v125
    v_exp_f32 v110, v126
    v_mfma_f32_32x32x16_bf16 v[140:155], v[160:163], v[212:215], v[140:155]
    v_exp_f32 v111, v127
    v_exp_f32 v112, v128
    v_exp_f32 v113, v129
    v_mfma_f32_32x32x16_bf16 v[140:155], v[164:167], v[216:219], v[140:155]
    v_exp_f32 v114, v130
    v_exp_f32 v115, v131
    v_exp_f32 v116, v132
    v_mfma_f32_32x32x16_bf16 v[140:155], v[168:171], v[220:223], v[140:155]
    v_exp_f32 v117, v133
    v_exp_f32 v118, v134
    v_exp_f32 v119, v135
    v_mfma_f32_32x32x16_bf16 v[140:155], v[172:175], v[180:183], v[140:155]
    v_exp_f32 v120, v136
    v_exp_f32 v121, v137
    v_exp_f32 v122, v138
    v_exp_f32 v123, v139
    v_pk_fma_f32 v[74:75], v[92:93], v[108:109], v[92:93]
    v_pk_fma_f32 v[92:93], v[124:125], v[94:95], v[74:75]
    ds_read_b32 v12, v8 offset:3328
    v_pk_fma_f32 v[94:95], v[94:95], v[108:109], v[94:95]
    v_pk_fma_f32 v[74:75], v[92:93], v[110:111], v[92:93]
    v_pk_fma_f32 v[92:93], v[126:127], v[94:95], v[74:75]
    v_pk_fma_f32 v[94:95], v[94:95], v[110:111], v[94:95]
    v_pk_fma_f32 v[74:75], v[92:93], v[112:113], v[92:93]
    v_pk_fma_f32 v[92:93], v[128:129], v[94:95], v[74:75]
    v_pk_fma_f32 v[94:95], v[94:95], v[112:113], v[94:95]
    v_pk_fma_f32 v[74:75], v[92:93], v[114:115], v[92:93]
    v_pk_fma_f32 v[92:93], v[130:131], v[94:95], v[74:75]
    v_pk_fma_f32 v[94:95], v[94:95], v[114:115], v[94:95]
    v_pk_fma_f32 v[74:75], v[92:93], v[116:117], v[92:93]
    v_pk_fma_f32 v[92:93], v[132:133], v[94:95], v[74:75]
    v_pk_fma_f32 v[94:95], v[94:95], v[116:117], v[94:95]
    v_pk_fma_f32 v[74:75], v[92:93], v[118:119], v[92:93]
    v_pk_fma_f32 v[92:93], v[134:135], v[94:95], v[74:75]
    v_pk_fma_f32 v[94:95], v[94:95], v[118:119], v[94:95]
    v_pk_fma_f32 v[74:75], v[92:93], v[120:121], v[92:93]
    v_pk_fma_f32 v[92:93], v[136:137], v[94:95], v[74:75]
    v_pk_fma_f32 v[94:95], v[94:95], v[120:121], v[94:95]
    v_pk_fma_f32 v[74:75], v[92:93], v[122:123], v[92:93]
    v_pk_fma_f32 v[92:93], v[138:139], v[94:95], v[74:75]
    v_pk_fma_f32 v[94:95], v[94:95], v[122:123], v[94:95]
    s_waitcnt lgkmcnt(0)
    v_mfma_f32_32x32x16_bf16 v[124:139], v[156:159], v[224:227], 0
    v_exp_f32 v108, v140
    v_exp_f32 v109, v141
    v_exp_f32 v110, v142
    v_mfma_f32_32x32x16_bf16 v[124:139], v[160:163], v[228:231], v[124:139]
    v_exp_f32 v111, v143
    v_exp_f32 v112, v144
    v_exp_f32 v113, v145
    v_mfma_f32_32x32x16_bf16 v[124:139], v[164:167], v[232:235], v[124:139]
    v_exp_f32 v114, v146
    v_exp_f32 v115, v147
    v_exp_f32 v116, v148
    v_mfma_f32_32x32x16_bf16 v[124:139], v[168:171], v[236:239], v[124:139]
    v_exp_f32 v117, v149
    v_exp_f32 v118, v150
    v_exp_f32 v119, v151
    v_mfma_f32_32x32x16_bf16 v[124:139], v[172:175], v[184:187], v[124:139]
    v_exp_f32 v120, v152
    v_exp_f32 v121, v153
    v_exp_f32 v122, v154
    v_exp_f32 v123, v155
    v_mad_u32_u16 v13, v12, s11, v9
    v_pk_fma_f32 v[74:75], v[96:97], v[108:109], v[96:97]
    v_pk_fma_f32 v[96:97], v[140:141], v[98:99], v[74:75]
    v_pk_fma_f32 v[98:99], v[98:99], v[108:109], v[98:99]
    v_pk_fma_f32 v[74:75], v[96:97], v[110:111], v[96:97]
    v_pk_fma_f32 v[96:97], v[142:143], v[98:99], v[74:75]
    v_pk_fma_f32 v[98:99], v[98:99], v[110:111], v[98:99]
    v_pk_fma_f32 v[74:75], v[96:97], v[112:113], v[96:97]
    v_pk_fma_f32 v[96:97], v[144:145], v[98:99], v[74:75]
    v_pk_fma_f32 v[98:99], v[98:99], v[112:113], v[98:99]
    v_pk_fma_f32 v[74:75], v[96:97], v[114:115], v[96:97]
    v_pk_fma_f32 v[96:97], v[146:147], v[98:99], v[74:75]
    v_pk_fma_f32 v[98:99], v[98:99], v[114:115], v[98:99]
    v_pk_fma_f32 v[74:75], v[96:97], v[116:117], v[96:97]
    v_pk_fma_f32 v[96:97], v[148:149], v[98:99], v[74:75]
    v_pk_fma_f32 v[98:99], v[98:99], v[116:117], v[98:99]
    v_pk_fma_f32 v[74:75], v[96:97], v[118:119], v[96:97]
    v_pk_fma_f32 v[96:97], v[150:151], v[98:99], v[74:75]
    v_pk_fma_f32 v[98:99], v[98:99], v[118:119], v[98:99]
    v_pk_fma_f32 v[74:75], v[96:97], v[120:121], v[96:97]
    v_pk_fma_f32 v[96:97], v[152:153], v[98:99], v[74:75]
    v_pk_fma_f32 v[98:99], v[98:99], v[120:121], v[98:99]
    v_pk_fma_f32 v[74:75], v[96:97], v[122:123], v[96:97]
    v_pk_fma_f32 v[96:97], v[154:155], v[98:99], v[74:75]
    v_pk_fma_f32 v[98:99], v[98:99], v[122:123], v[98:99]
    v_mfma_f32_32x32x16_bf16 v[140:155], v[156:159], v[240:243], 0
    v_exp_f32 v108, v124
    v_exp_f32 v109, v125
    v_exp_f32 v110, v126
    v_mfma_f32_32x32x16_bf16 v[140:155], v[160:163], v[244:247], v[140:155]
    v_exp_f32 v111, v127
    v_exp_f32 v112, v128
    v_exp_f32 v113, v129
    v_mfma_f32_32x32x16_bf16 v[140:155], v[164:167], v[248:251], v[140:155]
    v_exp_f32 v114, v130
    v_exp_f32 v115, v131
    v_exp_f32 v116, v132
    v_mfma_f32_32x32x16_bf16 v[140:155], v[168:171], v[252:255], v[140:155]
    v_exp_f32 v117, v133
    v_exp_f32 v118, v134
    v_exp_f32 v119, v135
    v_mfma_f32_32x32x16_bf16 v[140:155], v[172:175], v[188:191], v[140:155]
    v_exp_f32 v120, v136
    v_exp_f32 v121, v137
    v_exp_f32 v122, v138
    v_exp_f32 v123, v139
    s_mov_b64 exec, s[12:13]
    ds_read_b128 v[172:175], v11
    s_mov_b64 exec, s[14:15]
    ds_read2_b64 v[172:175], v6 offset0:0 offset1:0
    s_mov_b64 exec, -1
    s_cmp_ge_u32 s4, s92
    v_pk_fma_f32 v[74:75], v[100:101], v[108:109], v[100:101]
    v_pk_fma_f32 v[100:101], v[124:125], v[102:103], v[74:75]
    v_pk_fma_f32 v[102:103], v[102:103], v[108:109], v[102:103]
    v_pk_fma_f32 v[74:75], v[100:101], v[110:111], v[100:101]
    s_waitcnt vmcnt(0)
    s_cbranch_scc1 NOLD0_0
    buffer_load_dwordx4 v[156:159], v13, s[28:31], 0 offen offset:0
    buffer_load_dwordx4 v[160:163], v13, s[28:31], 0 offen offset:16
    buffer_load_dwordx4 v[164:167], v13, s[28:31], 0 offen offset:32
    buffer_load_dwordx4 v[168:171], v13, s[28:31], 0 offen offset:48
NOLD0_0:
    v_pk_fma_f32 v[100:101], v[126:127], v[102:103], v[74:75]
    v_pk_fma_f32 v[102:103], v[102:103], v[110:111], v[102:103]
    v_pk_fma_f32 v[74:75], v[100:101], v[112:113], v[100:101]
    v_pk_fma_f32 v[100:101], v[128:129], v[102:103], v[74:75]
    v_pk_fma_f32 v[102:103], v[102:103], v[112:113], v[102:103]
    v_pk_fma_f32 v[74:75], v[100:101], v[114:115], v[100:101]
    v_pk_fma_f32 v[100:101], v[130:131], v[102:103], v[74:75]
    v_pk_fma_f32 v[102:103], v[102:103], v[114:115], v[102:103]
    v_pk_fma_f32 v[74:75], v[100:101], v[116:117], v[100:101]
    v_pk_fma_f32 v[100:101], v[132:133], v[102:103], v[74:75]
    v_pk_fma_f32 v[102:103], v[102:103], v[116:117], v[102:103]
    v_pk_fma_f32 v[74:75], v[100:101], v[118:119], v[100:101]
    v_pk_fma_f32 v[100:101], v[134:135], v[102:103], v[74:75]
    v_pk_fma_f32 v[102:103], v[102:103], v[118:119], v[102:103]
    v_pk_fma_f32 v[74:75], v[100:101], v[120:121], v[100:101]
    v_pk_fma_f32 v[100:101], v[136:137], v[102:103], v[74:75]
    v_pk_fma_f32 v[102:103], v[102:103], v[120:121], v[102:103]
    v_pk_fma_f32 v[74:75], v[100:101], v[122:123], v[100:101]
    v_pk_fma_f32 v[100:101], v[138:139], v[102:103], v[74:75]
    v_pk_fma_f32 v[102:103], v[102:103], v[122:123], v[102:103]
    s_waitcnt lgkmcnt(0)
    s_cmp_ge_u32 s4, s88
    s_cbranch_scc1 LAST0_0
    v_mfma_f32_32x32x16_bf16 v[124:139], v[34:37], v[192:195], 0
    v_exp_f32 v108, v140
    v_exp_f32 v109, v141
    v_exp_f32 v110, v142
    v_mfma_f32_32x32x16_bf16 v[124:139], v[38:41], v[196:199], v[124:139]
    v_exp_f32 v111, v143
    v_exp_f32 v112, v144
    v_exp_f32 v113, v145
    v_mfma_f32_32x32x16_bf16 v[124:139], v[42:45], v[200:203], v[124:139]
    v_exp_f32 v114, v146
    v_exp_f32 v115, v147
    v_exp_f32 v116, v148
    v_mfma_f32_32x32x16_bf16 v[124:139], v[46:49], v[204:207], v[124:139]
    v_exp_f32 v117, v149
    v_exp_f32 v118, v150
    v_exp_f32 v119, v151
    v_mfma_f32_32x32x16_bf16 v[124:139], v[172:175], v[176:179], v[124:139]
    v_exp_f32 v120, v152
    v_exp_f32 v121, v153
    v_exp_f32 v122, v154
    v_exp_f32 v123, v155
    v_lshrrev_b32 v11, 16, v12
LASTJ0_0:
    v_pk_fma_f32 v[74:75], v[104:105], v[108:109], v[104:105]
    v_pk_fma_f32 v[104:105], v[140:141], v[106:107], v[74:75]
    v_pk_fma_f32 v[106:107], v[106:107], v[108:109], v[106:107]
    v_pk_fma_f32 v[74:75], v[104:105], v[110:111], v[104:105]
    v_pk_fma_f32 v[104:105], v[142:143], v[106:107], v[74:75]
    v_pk_fma_f32 v[106:107], v[106:107], v[110:111], v[106:107]
    v_pk_fma_f32 v[74:75], v[104:105], v[112:113], v[104:105]
    v_pk_fma_f32 v[104:105], v[144:145], v[106:107], v[74:75]
    v_pk_fma_f32 v[106:107], v[106:107], v[112:113], v[106:107]
    v_pk_fma_f32 v[74:75], v[104:105], v[114:115], v[104:105]
    v_pk_fma_f32 v[104:105], v[146:147], v[106:107], v[74:75]
    v_pk_fma_f32 v[106:107], v[106:107], v[114:115], v[106:107]
    v_pk_fma_f32 v[74:75], v[104:105], v[116:117], v[104:105]
    v_pk_fma_f32 v[104:105], v[148:149], v[106:107], v[74:75]
    v_pk_fma_f32 v[106:107], v[106:107], v[116:117], v[106:107]
    v_pk_fma_f32 v[74:75], v[104:105], v[118:119], v[104:105]
    v_pk_fma_f32 v[104:105], v[150:151], v[106:107], v[74:75]
    v_pk_fma_f32 v[106:107], v[106:107], v[118:119], v[106:107]
    v_pk_fma_f32 v[74:75], v[104:105], v[120:121], v[104:105]
    v_pk_fma_f32 v[104:105], v[152:153], v[106:107], v[74:75]
    v_pk_fma_f32 v[106:107], v[106:107], v[120:121], v[106:107]
    v_pk_fma_f32 v[74:75], v[104:105], v[122:123], v[104:105]
    v_pk_fma_f32 v[104:105], v[154:155], v[106:107], v[74:75]
    v_pk_fma_f32 v[106:107], v[106:107], v[122:123], v[106:107]
M_NEXT0:
    s_add_u32 s4, s4, 8
    s_cmp_ge_u32 s4, s98
    s_cbranch_scc1 M_CHK1
M_LOOP1:
    s_sub_u32 s10, s7, s4
    s_cmp_le_u32 s10, 8
    s_cbranch_scc1 M_DISP1
    v_mfma_f32_32x32x16_bf16 v[140:155], v[34:37], v[208:211], 0
    v_exp_f32 v108, v124
    v_exp_f32 v109, v125
    v_exp_f32 v110, v126
    v_mfma_f32_32x32x16_bf16 v[140:155], v[38:41], v[212:215], v[140:155]
    v_exp_f32 v111, v127
    v_exp_f32 v112, v128
    v_exp_f32 v113, v129
    v_mfma_f32_32x32x16_bf16 v[140:155], v[42:45], v[216:219], v[140:155]
    v_exp_f32 v114, v130
    v_exp_f32 v115, v131
    v_exp_f32 v116, v132
    v_mfma_f32_32x32x16_bf16 v[140:155], v[46:49], v[220:223], v[140:155]
    v_exp_f32 v117, v133
    v_exp_f32 v118, v134
    v_exp_f32 v119, v135
    v_mfma_f32_32x32x16_bf16 v[140:155], v[172:175], v[180:183], v[140:155]
    v_exp_f32 v120, v136
    v_exp_f32 v121, v137
    v_exp_f32 v122, v138
    v_exp_f32 v123, v139
    v_pk_fma_f32 v[74:75], v[92:93], v[108:109], v[92:93]
    v_pk_fma_f32 v[92:93], v[124:125], v[94:95], v[74:75]
    ds_read_b32 v12, v8 offset:3456
    v_pk_fma_f32 v[94:95], v[94:95], v[108:109], v[94:95]
    v_pk_fma_f32 v[74:75], v[92:93], v[110:111], v[92:93]
    v_pk_fma_f32 v[92:93], v[126:127], v[94:95], v[74:75]
    v_pk_fma_f32 v[94:95], v[94:95], v[110:111], v[94:95]
    v_pk_fma_f32 v[74:75], v[92:93], v[112:113], v[92:93]
    v_pk_fma_f32 v[92:93], v[128:129], v[94:95], v[74:75]
    v_pk_fma_f32 v[94:95], v[94:95], v[112:113], v[94:95]
    v_pk_fma_f32 v[74:75], v[92:93], v[114:115], v[92:93]
    v_pk_fma_f32 v[92:93], v[130:131], v[94:95], v[74:75]
    v_pk_fma_f32 v[94:95], v[94:95], v[114:115], v[94:95]
    v_pk_fma_f32 v[74:75], v[92:93], v[116:117], v[92:93]
    v_pk_fma_f32 v[92:93], v[132:133], v[94:95], v[74:75]
    v_pk_fma_f32 v[94:95], v[94:95], v[116:117], v[94:95]
    v_pk_fma_f32 v[74:75], v[92:93], v[118:119], v[92:93]
    v_pk_fma_f32 v[92:93], v[134:135], v[94:95], v[74:75]
    v_pk_fma_f32 v[94:95], v[94:95], v[118:119], v[94:95]
    v_pk_fma_f32 v[74:75], v[92:93], v[120:121], v[92:93]
    v_pk_fma_f32 v[92:93], v[136:137], v[94:95], v[74:75]
    v_pk_fma_f32 v[94:95], v[94:95], v[120:121], v[94:95]
    v_pk_fma_f32 v[74:75], v[92:93], v[122:123], v[92:93]
    v_pk_fma_f32 v[92:93], v[138:139], v[94:95], v[74:75]
    v_pk_fma_f32 v[94:95], v[94:95], v[122:123], v[94:95]
    s_waitcnt lgkmcnt(0)
    v_mfma_f32_32x32x16_bf16 v[124:139], v[34:37], v[224:227], 0
    v_exp_f32 v108, v140
    v_exp_f32 v109, v141
    v_exp_f32 v110, v142
    v_mfma_f32_32x32x16_bf16 v[124:139], v[38:41], v[228:231], v[124:139]
    v_exp_f32 v111, v143
    v_exp_f32 v112, v144
    v_exp_f32 v113, v145
    v_mfma_f32_32x32x16_bf16 v[124:139], v[42:45], v[232:235], v[124:139]
    v_exp_f32 v114, v146
    v_exp_f32 v115, v147
    v_exp_f32 v116, v148
    v_mfma_f32_32x32x16_bf16 v[124:139], v[46:49], v[236:239], v[124:139]
    v_exp_f32 v117, v149
    v_exp_f32 v118, v150
    v_exp_f32 v119, v151
    v_mfma_f32_32x32x16_bf16 v[124:139], v[172:175], v[184:187], v[124:139]
    v_exp_f32 v120, v152
    v_exp_f32 v121, v153
    v_exp_f32 v122, v154
    v_exp_f32 v123, v155
    v_mad_u32_u16 v13, v12, s11, v9
    v_pk_fma_f32 v[74:75], v[96:97], v[108:109], v[96:97]
    v_pk_fma_f32 v[96:97], v[140:141], v[98:99], v[74:75]
    v_pk_fma_f32 v[98:99], v[98:99], v[108:109], v[98:99]
    v_pk_fma_f32 v[74:75], v[96:97], v[110:111], v[96:97]
    v_pk_fma_f32 v[96:97], v[142:143], v[98:99], v[74:75]
    v_pk_fma_f32 v[98:99], v[98:99], v[110:111], v[98:99]
    v_pk_fma_f32 v[74:75], v[96:97], v[112:113], v[96:97]
    v_pk_fma_f32 v[96:97], v[144:145], v[98:99], v[74:75]
    v_pk_fma_f32 v[98:99], v[98:99], v[112:113], v[98:99]
    v_pk_fma_f32 v[74:75], v[96:97], v[114:115], v[96:97]
    v_pk_fma_f32 v[96:97], v[146:147], v[98:99], v[74:75]
    v_pk_fma_f32 v[98:99], v[98:99], v[114:115], v[98:99]
    v_pk_fma_f32 v[74:75], v[96:97], v[116:117], v[96:97]
    v_pk_fma_f32 v[96:97], v[148:149], v[98:99], v[74:75]
    v_pk_fma_f32 v[98:99], v[98:99], v[116:117], v[98:99]
    v_pk_fma_f32 v[74:75], v[96:97], v[118:119], v[96:97]
    v_pk_fma_f32 v[96:97], v[150:151], v[98:99], v[74:75]
    v_pk_fma_f32 v[98:99], v[98:99], v[118:119], v[98:99]
    v_pk_fma_f32 v[74:75], v[96:97], v[120:121], v[96:97]
    v_pk_fma_f32 v[96:97], v[152:153], v[98:99], v[74:75]
    v_pk_fma_f32 v[98:99], v[98:99], v[120:121], v[98:99]
    v_pk_fma_f32 v[74:75], v[96:97], v[122:123], v[96:97]
    v_pk_fma_f32 v[96:97], v[154:155], v[98:99], v[74:75]
    v_pk_fma_f32 v[98:99], v[98:99], v[122:123], v[98:99]
    v_mfma_f32_32x32x16_bf16 v[140:155], v[34:37], v[240:243], 0
    v_exp_f32 v108, v124
    v_exp_f32 v109, v125
    v_exp_f32 v110, v126
    v_mfma_f32_32x32x16_bf16 v[140:155], v[38:41], v[244:247], v[140:155]
    v_exp_f32 v111, v127
    v_exp_f32 v112, v128
    v_exp_f32 v113, v129
    v_mfma_f32_32x32x16_bf16 v[140:155], v[42:45], v[248:251], v[140:155]
    v_exp_f32 v114, v130
    v_exp_f32 v115, v131
    v_exp_f32 v116, v132
    v_mfma_f32_32x32x16_bf16 v[140:155], v[46:49], v[252:255], v[140:155]
    v_exp_f32 v117, v133
    v_exp_f32 v118, v134
    v_exp_f32 v119, v135
    v_mfma_f32_32x32x16_bf16 v[140:155], v[172:175], v[188:191], v[140:155]
    v_exp_f32 v120, v136
    v_exp_f32 v121, v137
    v_exp_f32 v122, v138
    v_exp_f32 v123, v139
    v_add_u32 v8, 256, v8
    s_mov_b64 exec, s[12:13]
    ds_read_b128 v[172:175], v11
    s_mov_b64 exec, s[14:15]
    ds_read2_b64 v[172:175], v6 offset0:32 offset1:32
    s_mov_b64 exec, -1
    s_cmp_ge_u32 s4, s92
    v_pk_fma_f32 v[74:75], v[100:101], v[108:109], v[100:101]
    v_pk_fma_f32 v[100:101], v[124:125], v[102:103], v[74:75]
    v_pk_fma_f32 v[102:103], v[102:103], v[108:109], v[102:103]
    v_pk_fma_f32 v[74:75], v[100:101], v[110:111], v[100:101]
    s_waitcnt vmcnt(0)
    s_cbranch_scc1 NOLD0_1
    buffer_load_dwordx4 v[34:37], v13, s[28:31], 0 offen offset:0
    buffer_load_dwordx4 v[38:41], v13, s[28:31], 0 offen offset:16
    buffer_load_dwordx4 v[42:45], v13, s[28:31], 0 offen offset:32
    buffer_load_dwordx4 v[46:49], v13, s[28:31], 0 offen offset:48
NOLD0_1:
    v_pk_fma_f32 v[100:101], v[126:127], v[102:103], v[74:75]
    v_pk_fma_f32 v[102:103], v[102:103], v[110:111], v[102:103]
    v_pk_fma_f32 v[74:75], v[100:101], v[112:113], v[100:101]
    v_pk_fma_f32 v[100:101], v[128:129], v[102:103], v[74:75]
    v_pk_fma_f32 v[102:103], v[102:103], v[112:113], v[102:103]
    v_pk_fma_f32 v[74:75], v[100:101], v[114:115], v[100:101]
    v_pk_fma_f32 v[100:101], v[130:131], v[102:103], v[74:75]
    v_pk_fma_f32 v[102:103], v[102:103], v[114:115], v[102:103]
    v_pk_fma_f32 v[74:75], v[100:101], v[116:117], v[100:101]
    v_pk_fma_f32 v[100:101], v[132:133], v[102:103], v[74:75]
    v_pk_fma_f32 v[102:103], v[102:103], v[116:117], v[102:103]
    v_pk_fma_f32 v[74:75], v[100:101], v[118:119], v[100:101]
    v_pk_fma_f32 v[100:101], v[134:135], v[102:103], v[74:75]
    v_pk_fma_f32 v[102:103], v[102:103], v[118:119], v[102:103]
    v_pk_fma_f32 v[74:75], v[100:101], v[120:121], v[100:101]
    v_pk_fma_f32 v[100:101], v[136:137], v[102:103], v[74:75]
    v_pk_fma_f32 v[102:103], v[102:103], v[120:121], v[102:103]
    v_pk_fma_f32 v[74:75], v[100:101], v[122:123], v[100:101]
    v_pk_fma_f32 v[100:101], v[138:139], v[102:103], v[74:75]
    v_pk_fma_f32 v[102:103], v[102:103], v[122:123], v[102:103]
    s_waitcnt lgkmcnt(0)
    s_cmp_ge_u32 s4, s88
    s_cbranch_scc1 LAST0_1
    v_mfma_f32_32x32x16_bf16 v[124:139], v[156:159], v[192:195], 0
    v_exp_f32 v108, v140
    v_exp_f32 v109, v141
    v_exp_f32 v110, v142
    v_mfma_f32_32x32x16_bf16 v[124:139], v[160:163], v[196:199], v[124:139]
    v_exp_f32 v111, v143
    v_exp_f32 v112, v144
    v_exp_f32 v113, v145
    v_mfma_f32_32x32x16_bf16 v[124:139], v[164:167], v[200:203], v[124:139]
    v_exp_f32 v114, v146
    v_exp_f32 v115, v147
    v_exp_f32 v116, v148
    v_mfma_f32_32x32x16_bf16 v[124:139], v[168:171], v[204:207], v[124:139]
    v_exp_f32 v117, v149
    v_exp_f32 v118, v150
    v_exp_f32 v119, v151
    v_mfma_f32_32x32x16_bf16 v[124:139], v[172:175], v[176:179], v[124:139]
    v_exp_f32 v120, v152
    v_exp_f32 v121, v153
    v_exp_f32 v122, v154
    v_exp_f32 v123, v155
    v_lshrrev_b32 v11, 16, v12
    v_add_u32 v6, 512, v6
LASTJ0_1:
    v_pk_fma_f32 v[74:75], v[104:105], v[108:109], v[104:105]
    v_pk_fma_f32 v[104:105], v[140:141], v[106:107], v[74:75]
    v_pk_fma_f32 v[106:107], v[106:107], v[108:109], v[106:107]
    v_pk_fma_f32 v[74:75], v[104:105], v[110:111], v[104:105]
    v_pk_fma_f32 v[104:105], v[142:143], v[106:107], v[74:75]
    v_pk_fma_f32 v[106:107], v[106:107], v[110:111], v[106:107]
    v_pk_fma_f32 v[74:75], v[104:105], v[112:113], v[104:105]
    v_pk_fma_f32 v[104:105], v[144:145], v[106:107], v[74:75]
    v_pk_fma_f32 v[106:107], v[106:107], v[112:113], v[106:107]
    v_pk_fma_f32 v[74:75], v[104:105], v[114:115], v[104:105]
    v_pk_fma_f32 v[104:105], v[146:147], v[106:107], v[74:75]
    v_pk_fma_f32 v[106:107], v[106:107], v[114:115], v[106:107]
    v_pk_fma_f32 v[74:75], v[104:105], v[116:117], v[104:105]
    v_pk_fma_f32 v[104:105], v[148:149], v[106:107], v[74:75]
    v_pk_fma_f32 v[106:107], v[106:107], v[116:117], v[106:107]
    v_pk_fma_f32 v[74:75], v[104:105], v[118:119], v[104:105]
    v_pk_fma_f32 v[104:105], v[150:151], v[106:107], v[74:75]
    v_pk_fma_f32 v[106:107], v[106:107], v[118:119], v[106:107]
    v_pk_fma_f32 v[74:75], v[104:105], v[120:121], v[104:105]
    v_pk_fma_f32 v[104:105], v[152:153], v[106:107], v[74:75]
    v_pk_fma_f32 v[106:107], v[106:107], v[120:121], v[106:107]
    v_pk_fma_f32 v[74:75], v[104:105], v[122:123], v[104:105]
    v_pk_fma_f32 v[104:105], v[154:155], v[106:107], v[74:75]
    v_pk_fma_f32 v[106:107], v[106:107], v[122:123], v[106:107]
M_NEXT1:
    s_add_u32 s4, s4, 8
    s_cmp_lt_u32 s4, s98
    s_cbranch_scc1 M_LOOP0
    s_branch M_CHK0
M_DISP0:
    s_cmp_gt_u32 s10, 4
    s_cbranch_scc1 M_DISPH0
    s_cmp_eq_u32 s10, 1
    s_cbranch_scc1 M_V1_0
    s_cmp_eq_u32 s10, 2
    s_cbranch_scc1 M_V2_0
    s_cmp_eq_u32 s10, 3
    s_cbranch_scc1 M_V3_0
    s_branch M_V4_0
M_DISPH0:
    s_cmp_eq_u32 s10, 5
    s_cbranch_scc1 M_V5_0
    s_cmp_eq_u32 s10, 6
    s_cbranch_scc1 M_V6_0
    s_cmp_eq_u32 s10, 7
    s_cbranch_scc1 M_V7_0
    s_branch M_V8_0
M_FLUSH0:
    v_rcp_f32 v116, v78
    v_rcp_f32 v117, v79
    v_rcp_f32 v118, v82
    v_rcp_f32 v119, v83
    v_rcp_f32 v120, v86
    v_rcp_f32 v121, v87
    v_rcp_f32 v122, v90
    v_rcp_f32 v123, v91
    v_max3_f32 v17, v17, v78, v79
    v_max3_f32 v17, v17, v82, v83
    v_max3_f32 v17, v17, v86, v87
    v_max3_f32 v17, v17, v90, v91
    v_pk_mul_f32 v[108:109], v[76:77], v[116:117]
    v_pk_mul_f32 v[110:111], v[80:81], v[118:119]
    v_pk_mul_f32 v[112:113], v[84:85], v[120:121]
    v_pk_mul_f32 v[114:115], v[88:89], v[122:123]
    s_add_u32 s6, s6, 1
    s_add_u32 s18, s6, 1
    v_readlane_b32 s7, v16, s18
    s_cmp_eq_u32 s8, 0
    s_cbranch_scc1 M_FLUSHT0
    v_pk_fma_f32 v[18:19], v[108:109], 0, v[18:19] op_sel_hi:[1,0,1]
    v_pk_fma_f32 v[18:19], v[110:111], 0, v[18:19] op_sel_hi:[1,0,1]
    v_pk_fma_f32 v[18:19], v[112:113], 0, v[18:19] op_sel_hi:[1,0,1]
    v_pk_fma_f32 v[18:19], v[114:115], 0, v[18:19] op_sel_hi:[1,0,1]
    v_cvt_pk_bf16_f32 v116, v108, v110
    v_cvt_pk_bf16_f32 v117, v112, v114
    v_add_u32 v26, v26, v25
    ds_write_b64 v26, v[116:117]
    v_cvt_pk_bf16_f32 v118, v109, v111
    v_cvt_pk_bf16_f32 v119, v113, v115
    v_add_u32 v27, v27, v25
    ds_write_b64 v27, v[118:119]
    s_add_u32 s4, s4, 8
    s_cmp_lt_u32 s4, s98
    s_cbranch_scc1 M_LOOP1
    s_branch M_CHK1
M_FLUSHT0:
    ds_write_b128 v30, v[108:111]
    ds_write_b128 v30, v[112:115] offset:16
    s_lshl_b32 s18, s3, 2
    v_mov_b32 v32, s18
    v_mov_b32 v33, 1
    s_mov_b32 s8, 1
    ds_write_b32 v32, v33 offset:160
    s_add_u32 s4, s4, 8
    s_cmp_lt_u32 s4, s98
    s_cbranch_scc1 M_LOOP1
    s_branch M_CHK1
M_DISP1:
    s_cmp_gt_u32 s10, 4
    s_cbranch_scc1 M_DISPH1
    s_cmp_eq_u32 s10, 1
    s_cbranch_scc1 M_V1_1
    s_cmp_eq_u32 s10, 2
    s_cbranch_scc1 M_V2_1
    s_cmp_eq_u32 s10, 3
    s_cbranch_scc1 M_V3_1
    s_branch M_V4_1
M_DISPH1:
    s_cmp_eq_u32 s10, 5
    s_cbranch_scc1 M_V5_1
    s_cmp_eq_u32 s10, 6
    s_cbranch_scc1 M_V6_1
    s_cmp_eq_u32 s10, 7
    s_cbranch_scc1 M_V7_1
    s_branch M_V8_1
M_FLUSH1:
    v_rcp_f32 v116, v78
    v_rcp_f32 v117, v79
    v_rcp_f32 v118, v82
    v_rcp_f32 v119, v83
    v_rcp_f32 v120, v86
    v_rcp_f32 v121, v87
    v_rcp_f32 v122, v90
    v_rcp_f32 v123, v91
    v_max3_f32 v17, v17, v78, v79
    v_max3_f32 v17, v17, v82, v83
    v_max3_f32 v17, v17, v86, v87
    v_max3_f32 v17, v17, v90, v91
    v_pk_mul_f32 v[108:109], v[76:77], v[116:117]
    v_pk_mul_f32 v[110:111], v[80:81], v[118:119]
    v_pk_mul_f32 v[112:113], v[84:85], v[120:121]
    v_pk_mul_f32 v[114:115], v[88:89], v[122:123]
    s_add_u32 s6, s6, 1
    s_add_u32 s18, s6, 1
    v_readlane_b32 s7, v16, s18
    s_cmp_eq_u32 s8, 0
    s_cbranch_scc1 M_FLUSHT1
    v_pk_fma_f32 v[18:19], v[108:109], 0, v[18:19] op_sel_hi:[1,0,1]
    v_pk_fma_f32 v[18:19], v[110:111], 0, v[18:19] op_sel_hi:[1,0,1]
    v_pk_fma_f32 v[18:19], v[112:113], 0, v[18:19] op_sel_hi:[1,0,1]
    v_pk_fma_f32 v[18:19], v[114:115], 0, v[18:19] op_sel_hi:[1,0,1]
    v_cvt_pk_bf16_f32 v116, v108, v110
    v_cvt_pk_bf16_f32 v117, v112, v114
    v_add_u32 v26, v26, v25
    ds_write_b64 v26, v[116:117]
    v_cvt_pk_bf16_f32 v118, v109, v111
    v_cvt_pk_bf16_f32 v119, v113, v115
    v_add_u32 v27, v27, v25
    ds_write_b64 v27, v[118:119]
    s_add_u32 s4, s4, 8
    s_cmp_lt_u32 s4, s98
    s_cbranch_scc1 M_LOOP0
    s_branch M_CHK0
M_FLUSHT1:
    ds_write_b128 v30, v[108:111]
    ds_write_b128 v30, v[112:115] offset:16
    s_lshl_b32 s18, s3, 2
    v_mov_b32 v32, s18
    v_mov_b32 v33, 1
    s_mov_b32 s8, 1
    ds_write_b32 v32, v33 offset:160
    s_add_u32 s4, s4, 8
    s_cmp_lt_u32 s4, s98
    s_cbranch_scc1 M_LOOP0
    s_branch M_CHK0
    .p2align 6
M_V1_0:
    v_mfma_f32_32x32x16_bf16 v[140:155], v[156:159], v[208:211], 0
    v_exp_f32 v108, v124
    v_exp_f32 v109, v125
    v_exp_f32 v110, v126
    v_mfma_f32_32x32x16_bf16 v[140:155], v[160:163], v[212:215], v[140:155]
    v_exp_f32 v111, v127
    v_exp_f32 v112, v128
    v_exp_f32 v113, v129
    v_mfma_f32_32x32x16_bf16 v[140:155], v[164:167], v[216:219], v[140:155]
    v_exp_f32 v114, v130
    v_exp_f32 v115, v131
    v_exp_f32 v116, v132
    v_mfma_f32_32x32x16_bf16 v[140:155], v[168:171], v[220:223], v[140:155]
    v_exp_f32 v117, v133
    v_exp_f32 v118, v134
    v_exp_f32 v119, v135
    v_mfma_f32_32x32x16_bf16 v[140:155], v[172:175], v[180:183], v[140:155]
    v_exp_f32 v120, v136
    v_exp_f32 v121, v137
    v_exp_f32 v122, v138
    v_exp_f32 v123, v139
    v_pk_fma_f32 v[74:75], v[92:93], v[108:109], v[92:93]
    v_pk_fma_f32 v[76:77], v[124:125], v[94:95], v[74:75]
    ds_read_b32 v12, v8 offset:3328
    v_pk_fma_f32 v[78:79], v[94:95], v[108:109], v[94:95]
    v_pk_fma_f32 v[94:95], v[110:111], s[16:17], s[16:17]
    v_pk_mul_f32 v[92:93], v[126:127], s[16:17]
    v_pk_fma_f32 v[74:75], v[92:93], v[112:113], v[92:93]
    s_add_u32 s18, s6, 2
    s_and_b32 s18, s18, -2
    s_lshl_b32 s18, s18, 4
    s_add_u32 s19, s6, 1
    s_or_b32 s19, s19, 1
    s_lshl_b32 s19, s19, 4
    v_add_u32 v28, s18, v23
    v_add_u32 v29, s19, v23
    ds_read_b32 v28, v28
    ds_read_b32 v29, v29
    v_pk_fma_f32 v[92:93], v[128:129], v[94:95], v[74:75]
    v_pk_fma_f32 v[94:95], v[94:95], v[112:113], v[94:95]
    v_pk_fma_f32 v[74:75], v[92:93], v[114:115], v[92:93]
    v_pk_fma_f32 v[92:93], v[130:131], v[94:95], v[74:75]
    s_lshl_b32 s20, s6, 4
    v_add_u32 v26, s20, v24
    ds_read_b64 v[26:27], v26
    v_pk_fma_f32 v[94:95], v[94:95], v[114:115], v[94:95]
    v_pk_fma_f32 v[74:75], v[92:93], v[116:117], v[92:93]
    v_pk_fma_f32 v[92:93], v[132:133], v[94:95], v[74:75]
    v_pk_fma_f32 v[94:95], v[94:95], v[116:117], v[94:95]
    v_pk_fma_f32 v[74:75], v[92:93], v[118:119], v[92:93]
    v_pk_fma_f32 v[92:93], v[134:135], v[94:95], v[74:75]
    v_pk_fma_f32 v[94:95], v[94:95], v[118:119], v[94:95]
    v_pk_fma_f32 v[74:75], v[92:93], v[120:121], v[92:93]
    v_pk_fma_f32 v[92:93], v[136:137], v[94:95], v[74:75]
    v_pk_fma_f32 v[94:95], v[94:95], v[120:121], v[94:95]
    v_pk_fma_f32 v[74:75], v[92:93], v[122:123], v[92:93]
    v_pk_fma_f32 v[92:93], v[138:139], v[94:95], v[74:75]
    v_pk_fma_f32 v[94:95], v[94:95], v[122:123], v[94:95]
    s_waitcnt lgkmcnt(0)
    v_mfma_f32_32x32x16_bf16 v[124:139], v[156:159], v[224:227], 0
    v_exp_f32 v108, v140
    v_exp_f32 v109, v141
    v_exp_f32 v110, v142
    v_mfma_f32_32x32x16_bf16 v[124:139], v[160:163], v[228:231], v[124:139]
    v_exp_f32 v111, v143
    v_exp_f32 v112, v144
    v_exp_f32 v113, v145
    v_mfma_f32_32x32x16_bf16 v[124:139], v[164:167], v[232:235], v[124:139]
    v_exp_f32 v114, v146
    v_exp_f32 v115, v147
    v_exp_f32 v116, v148
    v_mfma_f32_32x32x16_bf16 v[124:139], v[168:171], v[236:239], v[124:139]
    v_exp_f32 v117, v149
    v_exp_f32 v118, v150
    v_exp_f32 v119, v151
    v_mfma_f32_32x32x16_bf16 v[124:139], v[172:175], v[184:187], v[124:139]
    v_exp_f32 v120, v152
    v_exp_f32 v121, v153
    v_exp_f32 v122, v154
    v_exp_f32 v123, v155
    v_mad_u32_u16 v13, v12, s11, v9
    v_pk_fma_f32 v[74:75], v[96:97], v[108:109], v[96:97]
    v_pk_fma_f32 v[80:81], v[140:141], v[98:99], v[74:75]
    s_mov_b64 exec, s[12:13]
    v_add_u32 v21, v28, v20
    v_add_u32 v22, v29, v20
    s_mov_b64 exec, -1
    v_pk_fma_f32 v[82:83], v[98:99], v[108:109], v[98:99]
    v_pk_fma_f32 v[98:99], v[110:111], s[16:17], s[16:17]
    ds_read_b64_tr_b16 v[176:177], v21 offset:0
    ds_read_b64_tr_b16 v[178:179], v22 offset:0
    v_pk_mul_f32 v[96:97], v[142:143], s[16:17]
    v_pk_fma_f32 v[74:75], v[96:97], v[112:113], v[96:97]
    v_pk_fma_f32 v[96:97], v[144:145], v[98:99], v[74:75]
    ds_read_b64_tr_b16 v[180:181], v21 offset:64
    ds_read_b64_tr_b16 v[182:183], v22 offset:64
    v_pk_fma_f32 v[98:99], v[98:99], v[112:113], v[98:99]
    v_pk_fma_f32 v[74:75], v[96:97], v[114:115], v[96:97]
    v_pk_fma_f32 v[96:97], v[146:147], v[98:99], v[74:75]
    ds_read_b64_tr_b16 v[184:185], v21 offset:128
    ds_read_b64_tr_b16 v[186:187], v22 offset:128
    v_pk_fma_f32 v[98:99], v[98:99], v[114:115], v[98:99]
    v_pk_fma_f32 v[74:75], v[96:97], v[116:117], v[96:97]
    v_pk_fma_f32 v[96:97], v[148:149], v[98:99], v[74:75]
    v_pk_fma_f32 v[98:99], v[98:99], v[116:117], v[98:99]
    v_pk_fma_f32 v[74:75], v[96:97], v[118:119], v[96:97]
    v_pk_fma_f32 v[96:97], v[150:151], v[98:99], v[74:75]
    v_pk_fma_f32 v[98:99], v[98:99], v[118:119], v[98:99]
    v_pk_fma_f32 v[74:75], v[96:97], v[120:121], v[96:97]
    v_pk_fma_f32 v[96:97], v[152:153], v[98:99], v[74:75]
    v_pk_fma_f32 v[98:99], v[98:99], v[120:121], v[98:99]
    v_pk_fma_f32 v[74:75], v[96:97], v[122:123], v[96:97]
    v_pk_fma_f32 v[96:97], v[154:155], v[98:99], v[74:75]
    v_pk_fma_f32 v[98:99], v[98:99], v[122:123], v[98:99]
    v_mfma_f32_32x32x16_bf16 v[140:155], v[156:159], v[240:243], 0
    v_exp_f32 v108, v124
    v_exp_f32 v109, v125
    v_exp_f32 v110, v126
    v_mfma_f32_32x32x16_bf16 v[140:155], v[160:163], v[244:247], v[140:155]
    v_exp_f32 v111, v127
    v_exp_f32 v112, v128
    v_exp_f32 v113, v129
    v_mfma_f32_32x32x16_bf16 v[140:155], v[164:167], v[248:251], v[140:155]
    v_exp_f32 v114, v130
    v_exp_f32 v115, v131
    v_exp_f32 v116, v132
    v_mfma_f32_32x32x16_bf16 v[140:155], v[168:171], v[252:255], v[140:155]
    v_exp_f32 v117, v133
    v_exp_f32 v118, v134
    v_exp_f32 v119, v135
    v_mfma_f32_32x32x16_bf16 v[140:155], v[172:175], v[188:191], v[140:155]
    v_exp_f32 v120, v136
    v_exp_f32 v121, v137
    v_exp_f32 v122, v138
    v_exp_f32 v123, v139
    s_mov_b64 exec, s[12:13]
    ds_read_b128 v[172:175], v11
    s_mov_b64 exec, s[14:15]
    ds_read2_b64 v[172:175], v6 offset0:0 offset1:0
    s_mov_b64 exec, -1
    s_cmp_ge_u32 s4, s92
    v_pk_fma_f32 v[74:75], v[100:101], v[108:109], v[100:101]
    v_pk_fma_f32 v[84:85], v[124:125], v[102:103], v[74:75]
    ds_read_b64_tr_b16 v[188:189], v21 offset:192
    ds_read_b64_tr_b16 v[190:191], v22 offset:192
    v_pk_fma_f32 v[86:87], v[102:103], v[108:109], v[102:103]
    v_pk_fma_f32 v[102:103], v[110:111], s[16:17], s[16:17]
    s_waitcnt vmcnt(0)
    s_cbranch_scc1 NOLD1_0
    buffer_load_dwordx4 v[156:159], v13, s[28:31], 0 offen offset:0
    buffer_load_dwordx4 v[160:163], v13, s[28:31], 0 offen offset:16
    buffer_load_dwordx4 v[164:167], v13, s[28:31], 0 offen offset:32
    buffer_load_dwordx4 v[168:171], v13, s[28:31], 0 offen offset:48
NOLD1_0:
    v_pk_mul_f32 v[100:101], v[126:127], s[16:17]
    v_pk_fma_f32 v[74:75], v[100:101], v[112:113], v[100:101]
    v_pk_fma_f32 v[100:101], v[128:129], v[102:103], v[74:75]
    v_pk_fma_f32 v[102:103], v[102:103], v[112:113], v[102:103]
    v_pk_fma_f32 v[74:75], v[100:101], v[114:115], v[100:101]
    v_pk_fma_f32 v[100:101], v[130:131], v[102:103], v[74:75]
    v_pk_fma_f32 v[102:103], v[102:103], v[114:115], v[102:103]
    v_pk_fma_f32 v[74:75], v[100:101], v[116:117], v[100:101]
    v_pk_fma_f32 v[100:101], v[132:133], v[102:103], v[74:75]
    v_pk_fma_f32 v[102:103], v[102:103], v[116:117], v[102:103]
    v_pk_fma_f32 v[74:75], v[100:101], v[118:119], v[100:101]
    v_pk_fma_f32 v[100:101], v[134:135], v[102:103], v[74:75]
    v_pk_fma_f32 v[102:103], v[102:103], v[118:119], v[102:103]
    v_pk_fma_f32 v[74:75], v[100:101], v[120:121], v[100:101]
    v_pk_fma_f32 v[100:101], v[136:137], v[102:103], v[74:75]
    v_pk_fma_f32 v[102:103], v[102:103], v[120:121], v[102:103]
    v_pk_fma_f32 v[74:75], v[100:101], v[122:123], v[100:101]
    v_pk_fma_f32 v[100:101], v[138:139], v[102:103], v[74:75]
    v_pk_fma_f32 v[102:103], v[102:103], v[122:123], v[102:103]
    s_waitcnt lgkmcnt(0)
    s_cmp_ge_u32 s4, s88
    s_cbranch_scc1 LAST1_0
    v_mfma_f32_32x32x16_bf16 v[124:139], v[34:37], v[192:195], 0
    v_exp_f32 v108, v140
    v_exp_f32 v109, v141
    v_exp_f32 v110, v142
    v_mfma_f32_32x32x16_bf16 v[124:139], v[38:41], v[196:199], v[124:139]
    v_exp_f32 v111, v143
    v_exp_f32 v112, v144
    v_exp_f32 v113, v145
    v_mfma_f32_32x32x16_bf16 v[124:139], v[42:45], v[200:203], v[124:139]
    v_exp_f32 v114, v146
    v_exp_f32 v115, v147
    v_exp_f32 v116, v148
    v_mfma_f32_32x32x16_bf16 v[124:139], v[46:49], v[204:207], v[124:139]
    v_exp_f32 v117, v149
    v_exp_f32 v118, v150
    v_exp_f32 v119, v151
    v_mfma_f32_32x32x16_bf16 v[124:139], v[172:175], v[176:179], v[124:139]
    v_exp_f32 v120, v152
    v_exp_f32 v121, v153
    v_exp_f32 v122, v154
    v_exp_f32 v123, v155
    v_lshrrev_b32 v11, 16, v12
LASTJ1_0:
    v_pk_fma_f32 v[74:75], v[104:105], v[108:109], v[104:105]
    v_pk_fma_f32 v[88:89], v[140:141], v[106:107], v[74:75]
    v_pk_fma_f32 v[90:91], v[106:107], v[108:109], v[106:107]
    v_pk_fma_f32 v[106:107], v[110:111], s[16:17], s[16:17]
    v_pk_mul_f32 v[104:105], v[142:143], s[16:17]
    v_pk_fma_f32 v[74:75], v[104:105], v[112:113], v[104:105]
    v_pk_fma_f32 v[104:105], v[144:145], v[106:107], v[74:75]
    v_pk_fma_f32 v[106:107], v[106:107], v[112:113], v[106:107]
    v_pk_fma_f32 v[74:75], v[104:105], v[114:115], v[104:105]
    v_pk_fma_f32 v[104:105], v[146:147], v[106:107], v[74:75]
    v_pk_fma_f32 v[106:107], v[106:107], v[114:115], v[106:107]
    v_pk_fma_f32 v[74:75], v[104:105], v[116:117], v[104:105]
    v_pk_fma_f32 v[104:105], v[148:149], v[106:107], v[74:75]
    v_pk_fma_f32 v[106:107], v[106:107], v[116:117], v[106:107]
    v_pk_fma_f32 v[74:75], v[104:105], v[118:119], v[104:105]
    v_pk_fma_f32 v[104:105], v[150:151], v[106:107], v[74:75]
    v_pk_fma_f32 v[106:107], v[106:107], v[118:119], v[106:107]
    v_pk_fma_f32 v[74:75], v[104:105], v[120:121], v[104:105]
    v_pk_fma_f32 v[104:105], v[152:153], v[106:107], v[74:75]
    v_pk_fma_f32 v[106:107], v[106:107], v[120:121], v[106:107]
    v_pk_fma_f32 v[74:75], v[104:105], v[122:123], v[104:105]
    v_pk_fma_f32 v[104:105], v[154:155], v[106:107], v[74:75]
    v_pk_fma_f32 v[106:107], v[106:107], v[122:123], v[106:107]
    s_branch M_FLUSH0
    .p2align 6
M_V2_0:
    v_mfma_f32_32x32x16_bf16 v[140:155], v[156:159], v[208:211], 0
    v_exp_f32 v108, v124
    v_exp_f32 v109, v125
    v_exp_f32 v110, v126
    v_mfma_f32_32x32x16_bf16 v[140:155], v[160:163], v[212:215], v[140:155]
    v_exp_f32 v111, v127
    v_exp_f32 v112, v128
    v_exp_f32 v113, v129
    v_mfma_f32_32x32x16_bf16 v[140:155], v[164:167], v[216:219], v[140:155]
    v_exp_f32 v114, v130
    v_exp_f32 v115, v131
    v_exp_f32 v116, v132
    v_mfma_f32_32x32x16_bf16 v[140:155], v[168:171], v[220:223], v[140:155]
    v_exp_f32 v117, v133
    v_exp_f32 v118, v134
    v_exp_f32 v119, v135
    v_mfma_f32_32x32x16_bf16 v[140:155], v[172:175], v[180:183], v[140:155]
    v_exp_f32 v120, v136
    v_exp_f32 v121, v137
    v_exp_f32 v122, v138
    v_exp_f32 v123, v139
    v_pk_fma_f32 v[74:75], v[92:93], v[108:109], v[92:93]
    v_pk_fma_f32 v[92:93], v[124:125], v[94:95], v[74:75]
    ds_read_b32 v12, v8 offset:3328
    v_pk_fma_f32 v[94:95], v[94:95], v[108:109], v[94:95]
    v_pk_fma_f32 v[74:75], v[92:93], v[110:111], v[92:93]
    v_pk_fma_f32 v[76:77], v[126:127], v[94:95], v[74:75]
    v_pk_fma_f32 v[78:79], v[94:95], v[110:111], v[94:95]
    s_add_u32 s18, s6, 2
    s_and_b32 s18, s18, -2
    s_lshl_b32 s18, s18, 4
    s_add_u32 s19, s6, 1
    s_or_b32 s19, s19, 1
    s_lshl_b32 s19, s19, 4
    v_add_u32 v28, s18, v23
    v_add_u32 v29, s19, v23
    ds_read_b32 v28, v28
    ds_read_b32 v29, v29
    v_pk_fma_f32 v[94:95], v[112:113], s[16:17], s[16:17]
    v_pk_mul_f32 v[92:93], v[128:129], s[16:17]
    v_pk_fma_f32 v[74:75], v[92:93], v[114:115], v[92:93]
    v_pk_fma_f32 v[92:93], v[130:131], v[94:95], v[74:75]
    s_lshl_b32 s20, s6, 4
    v_add_u32 v26, s20, v24
    ds_read_b64 v[26:27], v26
    v_pk_fma_f32 v[94:95], v[94:95], v[114:115], v[94:95]
    v_pk_fma_f32 v[74:75], v[92:93], v[116:117], v[92:93]
    v_pk_fma_f32 v[92:93], v[132:133], v[94:95], v[74:75]
    v_pk_fma_f32 v[94:95], v[94:95], v[116:117], v[94:95]
    v_pk_fma_f32 v[74:75], v[92:93], v[118:119], v[92:93]
    v_pk_fma_f32 v[92:93], v[134:135], v[94:95], v[74:75]
    v_pk_fma_f32 v[94:95], v[94:95], v[118:119], v[94:95]
    v_pk_fma_f32 v[74:75], v[92:93], v[120:121], v[92:93]
    v_pk_fma_f32 v[92:93], v[136:137], v[94:95], v[74:75]
    v_pk_fma_f32 v[94:95], v[94:95], v[120:121], v[94:95]
    v_pk_fma_f32 v[74:75], v[92:93], v[122:123], v[92:93]
    v_pk_fma_f32 v[92:93], v[138:139], v[94:95], v[74:75]
    v_pk_fma_f32 v[94:95], v[94:95], v[122:123], v[94:95]
    s_waitcnt lgkmcnt(0)
    v_mfma_f32_32x32x16_bf16 v[124:139], v[156:159], v[224:227], 0
    v_exp_f32 v108, v140
    v_exp_f32 v109, v141
    v_exp_f32 v110, v142
    v_mfma_f32_32x32x16_bf16 v[124:139], v[160:163], v[228:231], v[124:139]
    v_exp_f32 v111, v143
    v_exp_f32 v112, v144
    v_exp_f32 v113, v145
    v_mfma_f32_32x32x16_bf16 v[124:139], v[164:167], v[232:235], v[124:139]
    v_exp_f32 v114, v146
    v_exp_f32 v115, v147
    v_exp_f32 v116, v148
    v_mfma_f32_32x32x16_bf16 v[124:139], v[168:171], v[236:239], v[124:139]
    v_exp_f32 v117, v149
    v_exp_f32 v118, v150
    v_exp_f32 v119, v151
    v_mfma_f32_32x32x16_bf16 v[124:139], v[172:175], v[184:187], v[124:139]
    v_exp_f32 v120, v152
    v_exp_f32 v121, v153
    v_exp_f32 v122, v154
    v_exp_f32 v123, v155
    v_mad_u32_u16 v13, v12, s11, v9
    v_pk_fma_f32 v[74:75], v[96:97], v[108:109], v[96:97]
    v_pk_fma_f32 v[96:97], v[140:141], v[98:99], v[74:75]
    s_mov_b64 exec, s[12:13]
    v_add_u32 v21, v28, v20
    v_add_u32 v22, v29, v20
    s_mov_b64 exec, -1
    v_pk_fma_f32 v[98:99], v[98:99], v[108:109], v[98:99]
    v_pk_fma_f32 v[74:75], v[96:97], v[110:111], v[96:97]
    ds_read_b64_tr_b16 v[176:177], v21 offset:0
    ds_read_b64_tr_b16 v[178:179], v22 offset:0
    v_pk_fma_f32 v[80:81], v[142:143], v[98:99], v[74:75]
    v_pk_fma_f32 v[82:83], v[98:99], v[110:111], v[98:99]
    v_pk_fma_f32 v[98:99], v[112:113], s[16:17], s[16:17]
    ds_read_b64_tr_b16 v[180:181], v21 offset:64
    ds_read_b64_tr_b16 v[182:183], v22 offset:64
    v_pk_mul_f32 v[96:97], v[144:145], s[16:17]
    v_pk_fma_f32 v[74:75], v[96:97], v[114:115], v[96:97]
    v_pk_fma_f32 v[96:97], v[146:147], v[98:99], v[74:75]
    ds_read_b64_tr_b16 v[184:185], v21 offset:128
    ds_read_b64_tr_b16 v[186:187], v22 offset:128
    v_pk_fma_f32 v[98:99], v[98:99], v[114:115], v[98:99]
    v_pk_fma_f32 v[74:75], v[96:97], v[116:117], v[96:97]
    v_pk_fma_f32 v[96:97], v[148:149], v[98:99], v[74:75]
    v_pk_fma_f32 v[98:99], v[98:99], v[116:117], v[98:99]
    v_pk_fma_f32 v[74:75], v[96:97], v[118:119], v[96:97]
    v_pk_fma_f32 v[96:97], v[150:151], v[98:99], v[74:75]
    v_pk_fma_f32 v[98:99], v[98:99], v[118:119], v[98:99]
    v_pk_fma_f32 v[74:75], v[96:97], v[120:121], v[96:97]
    v_pk_fma_f32 v[96:97], v[152:153], v[98:99], v[74:75]
    v_pk_fma_f32 v[98:99], v[98:99], v[120:121], v[98:99]
    v_pk_fma_f32 v[74:75], v[96:97], v[122:123], v[96:97]
    v_pk_fma_f32 v[96:97], v[154:155], v[98:99], v[74:75]
    v_pk_fma_f32 v[98:99], v[98:99], v[122:123], v[98:99]
    v_mfma_f32_32x32x16_bf16 v[140:155], v[156:159], v[240:243], 0
    v_exp_f32 v108, v124
    v_exp_f32 v109, v125
    v_exp_f32 v110, v126
    v_mfma_f32_32x32x16_bf16 v[140:155], v[160:163], v[244:247], v[140:155]
    v_exp_f32 v111, v127
    v_exp_f32 v112, v128
    v_exp_f32 v113, v129
    v_mfma_f32_32x32x16_bf16 v[140:155], v[164:167], v[248:251], v[140:155]
    v_exp_f32 v114, v130
    v_exp_f32 v115, v131
    v_exp_f32 v116, v132
    v_mfma_f32_32x32x16_bf16 v[140:155], v[168:171], v[252:255], v[140:155]
    v_exp_f32 v117, v133
    v_exp_f32 v118, v134
    v_exp_f32 v119, v135
    v_mfma_f32_32x32x16_bf16 v[140:155], v[172:175], v[188:191], v[140:155]
    v_exp_f32 v120, v136
    v_exp_f32 v121, v137
    v_exp_f32 v122, v138
    v_exp_f32 v123, v139
    s_mov_b64 exec, s[12:13]
    ds_read_b128 v[172:175], v11
    s_mov_b64 exec, s[14:15]
    ds_read2_b64 v[172:175], v6 offset0:0 offset1:0
    s_mov_b64 exec, -1
    s_cmp_ge_u32 s4, s92
    v_pk_fma_f32 v[74:75], v[100:101], v[108:109], v[100:101]
    v_pk_fma_f32 v[100:101], v[124:125], v[102:103], v[74:75]
    ds_read_b64_tr_b16 v[188:189], v21 offset:192
    ds_read_b64_tr_b16 v[190:191], v22 offset:192
    v_pk_fma_f32 v[102:103], v[102:103], v[108:109], v[102:103]
    v_pk_fma_f32 v[74:75], v[100:101], v[110:111], v[100:101]
    s_waitcnt vmcnt(0)
    s_cbranch_scc1 NOLD2_0
    buffer_load_dwordx4 v[156:159], v13, s[28:31], 0 offen offset:0
    buffer_load_dwordx4 v[160:163], v13, s[28:31], 0 offen offset:16
    buffer_load_dwordx4 v[164:167], v13, s[28:31], 0 offen offset:32
    buffer_load_dwordx4 v[168:171], v13, s[28:31], 0 offen offset:48
NOLD2_0:
    v_pk_fma_f32 v[84:85], v[126:127], v[102:103], v[74:75]
    v_pk_fma_f32 v[86:87], v[102:103], v[110:111], v[102:103]
    v_pk_fma_f32 v[102:103], v[112:113], s[16:17], s[16:17]
    v_pk_mul_f32 v[100:101], v[128:129], s[16:17]
    v_pk_fma_f32 v[74:75], v[100:101], v[114:115], v[100:101]
    v_pk_fma_f32 v[100:101], v[130:131], v[102:103], v[74:75]
    v_pk_fma_f32 v[102:103], v[102:103], v[114:115], v[102:103]
    v_pk_fma_f32 v[74:75], v[100:101], v[116:117], v[100:101]
    v_pk_fma_f32 v[100:101], v[132:133], v[102:103], v[74:75]
    v_pk_fma_f32 v[102:103], v[102:103], v[116:117], v[102:103]
    v_pk_fma_f32 v[74:75], v[100:101], v[118:119], v[100:101]
    v_pk_fma_f32 v[100:101], v[134:135], v[102:103], v[74:75]
    v_pk_fma_f32 v[102:103], v[102:103], v[118:119], v[102:103]
    v_pk_fma_f32 v[74:75], v[100:101], v[120:121], v[100:101]
    v_pk_fma_f32 v[100:101], v[136:137], v[102:103], v[74:75]
    v_pk_fma_f32 v[102:103], v[102:103], v[120:121], v[102:103]
    v_pk_fma_f32 v[74:75], v[100:101], v[122:123], v[100:101]
    v_pk_fma_f32 v[100:101], v[138:139], v[102:103], v[74:75]
    v_pk_fma_f32 v[102:103], v[102:103], v[122:123], v[102:103]
    s_waitcnt lgkmcnt(0)
    s_cmp_ge_u32 s4, s88
    s_cbranch_scc1 LAST2_0
    v_mfma_f32_32x32x16_bf16 v[124:139], v[34:37], v[192:195], 0
    v_exp_f32 v108, v140
    v_exp_f32 v109, v141
    v_exp_f32 v110, v142
    v_mfma_f32_32x32x16_bf16 v[124:139], v[38:41], v[196:199], v[124:139]
    v_exp_f32 v111, v143
    v_exp_f32 v112, v144
    v_exp_f32 v113, v145
    v_mfma_f32_32x32x16_bf16 v[124:139], v[42:45], v[200:203], v[124:139]
    v_exp_f32 v114, v146
    v_exp_f32 v115, v147
    v_exp_f32 v116, v148
    v_mfma_f32_32x32x16_bf16 v[124:139], v[46:49], v[204:207], v[124:139]
    v_exp_f32 v117, v149
    v_exp_f32 v118, v150
    v_exp_f32 v119, v151
    v_mfma_f32_32x32x16_bf16 v[124:139], v[172:175], v[176:179], v[124:139]
    v_exp_f32 v120, v152
    v_exp_f32 v121, v153
    v_exp_f32 v122, v154
    v_exp_f32 v123, v155
    v_lshrrev_b32 v11, 16, v12
LASTJ2_0:
    v_pk_fma_f32 v[74:75], v[104:105], v[108:109], v[104:105]
    v_pk_fma_f32 v[104:105], v[140:141], v[106:107], v[74:75]
    v_pk_fma_f32 v[106:107], v[106:107], v[108:109], v[106:107]
    v_pk_fma_f32 v[74:75], v[104:105], v[110:111], v[104:105]
    v_pk_fma_f32 v[88:89], v[142:143], v[106:107], v[74:75]
    v_pk_fma_f32 v[90:91], v[106:107], v[110:111], v[106:107]
    v_pk_fma_f32 v[106:107], v[112:113], s[16:17], s[16:17]
    v_pk_mul_f32 v[104:105], v[144:145], s[16:17]
    v_pk_fma_f32 v[74:75], v[104:105], v[114:115], v[104:105]
    v_pk_fma_f32 v[104:105], v[146:147], v[106:107], v[74:75]
    v_pk_fma_f32 v[106:107], v[106:107], v[114:115], v[106:107]
    v_pk_fma_f32 v[74:75], v[104:105], v[116:117], v[104:105]
    v_pk_fma_f32 v[104:105], v[148:149], v[106:107], v[74:75]
    v_pk_fma_f32 v[106:107], v[106:107], v[116:117], v[106:107]
    v_pk_fma_f32 v[74:75], v[104:105], v[118:119], v[104:105]
    v_pk_fma_f32 v[104:105], v[150:151], v[106:107], v[74:75]
    v_pk_fma_f32 v[106:107], v[106:107], v[118:119], v[106:107]
    v_pk_fma_f32 v[74:75], v[104:105], v[120:121], v[104:105]
    v_pk_fma_f32 v[104:105], v[152:153], v[106:107], v[74:75]
    v_pk_fma_f32 v[106:107], v[106:107], v[120:121], v[106:107]
    v_pk_fma_f32 v[74:75], v[104:105], v[122:123], v[104:105]
    v_pk_fma_f32 v[104:105], v[154:155], v[106:107], v[74:75]
    v_pk_fma_f32 v[106:107], v[106:107], v[122:123], v[106:107]
    s_branch M_FLUSH0
    .p2align 6
M_V3_0:
    v_mfma_f32_32x32x16_bf16 v[140:155], v[156:159], v[208:211], 0
    v_exp_f32 v108, v124
    v_exp_f32 v109, v125
    v_exp_f32 v110, v126
    v_mfma_f32_32x32x16_bf16 v[140:155], v[160:163], v[212:215], v[140:155]
    v_exp_f32 v111, v127
    v_exp_f32 v112, v128
    v_exp_f32 v113, v129
    v_mfma_f32_32x32x16_bf16 v[140:155], v[164:167], v[216:219], v[140:155]
    v_exp_f32 v114, v130
    v_exp_f32 v115, v131
    v_exp_f32 v116, v132
    v_mfma_f32_32x32x16_bf16 v[140:155], v[168:171], v[220:223], v[140:155]
    v_exp_f32 v117, v133
    v_exp_f32 v118, v134
    v_exp_f32 v119, v135
    v_mfma_f32_32x32x16_bf16 v[140:155], v[172:175], v[180:183], v[140:155]
    v_exp_f32 v120, v136
    v_exp_f32 v121, v137
    v_exp_f32 v122, v138
    v_exp_f32 v123, v139
    v_pk_fma_f32 v[74:75], v[92:93], v[108:109], v[92:93]
    v_pk_fma_f32 v[92:93], v[124:125], v[94:95], v[74:75]
    ds_read_b32 v12, v8 offset:3328
    v_pk_fma_f32 v[94:95], v[94:95], v[108:109], v[94:95]
    v_pk_fma_f32 v[74:75], v[92:93], v[110:111], v[92:93]
    v_pk_fma_f32 v[92:93], v[126:127], v[94:95], v[74:75]
    v_pk_fma_f32 v[94:95], v[94:95], v[110:111], v[94:95]
    s_add_u32 s18, s6, 2
    s_and_b32 s18, s18, -2
    s_lshl_b32 s18, s18, 4
    s_add_u32 s19, s6, 1
    s_or_b32 s19, s19, 1
    s_lshl_b32 s19, s19, 4
    v_add_u32 v28, s18, v23
    v_add_u32 v29, s19, v23
    ds_read_b32 v28, v28
    ds_read_b32 v29, v29
    v_pk_fma_f32 v[74:75], v[92:93], v[112:113], v[92:93]
    v_pk_fma_f32 v[76:77], v[128:129], v[94:95], v[74:75]
    v_pk_fma_f32 v[78:79], v[94:95], v[112:113], v[94:95]
    v_pk_fma_f32 v[94:95], v[114:115], s[16:17], s[16:17]
    s_lshl_b32 s20, s6, 4
    v_add_u32 v26, s20, v24
    ds_read_b64 v[26:27], v26
    v_pk_mul_f32 v[92:93], v[130:131], s[16:17]
    v_pk_fma_f32 v[74:75], v[92:93], v[116:117], v[92:93]
    v_pk_fma_f32 v[92:93], v[132:133], v[94:95], v[74:75]
    v_pk_fma_f32 v[94:95], v[94:95], v[116:117], v[94:95]
    v_pk_fma_f32 v[74:75], v[92:93], v[118:119], v[92:93]
    v_pk_fma_f32 v[92:93], v[134:135], v[94:95], v[74:75]
    v_pk_fma_f32 v[94:95], v[94:95], v[118:119], v[94:95]
    v_pk_fma_f32 v[74:75], v[92:93], v[120:121], v[92:93]
    v_pk_fma_f32 v[92:93], v[136:137], v[94:95], v[74:75]
    v_pk_fma_f32 v[94:95], v[94:95], v[120:121], v[94:95]
    v_pk_fma_f32 v[74:75], v[92:93], v[122:123], v[92:93]
    v_pk_fma_f32 v[92:93], v[138:139], v[94:95], v[74:75]
    v_pk_fma_f32 v[94:95], v[94:95], v[122:123], v[94:95]
    s_waitcnt lgkmcnt(0)
    v_mfma_f32_32x32x16_bf16 v[124:139], v[156:159], v[224:227], 0
    v_exp_f32 v108, v140
    v_exp_f32 v109, v141
    v_exp_f32 v110, v142
    v_mfma_f32_32x32x16_bf16 v[124:139], v[160:163], v[228:231], v[124:139]
    v_exp_f32 v111, v143
    v_exp_f32 v112, v144
    v_exp_f32 v113, v145
    v_mfma_f32_32x32x16_bf16 v[124:139], v[164:167], v[232:235], v[124:139]
    v_exp_f32 v114, v146
    v_exp_f32 v115, v147
    v_exp_f32 v116, v148
    v_mfma_f32_32x32x16_bf16 v[124:139], v[168:171], v[236:239], v[124:139]
    v_exp_f32 v117, v149
    v_exp_f32 v118, v150
    v_exp_f32 v119, v151
    v_mfma_f32_32x32x16_bf16 v[124:139], v[172:175], v[184:187], v[124:139]
    v_exp_f32 v120, v152
    v_exp_f32 v121, v153
    v_exp_f32 v122, v154
    v_exp_f32 v123, v155
    v_mad_u32_u16 v13, v12, s11, v9
    v_pk_fma_f32 v[74:75], v[96:97], v[108:109], v[96:97]
    v_pk_fma_f32 v[96:97], v[140:141], v[98:99], v[74:75]
    s_mov_b64 exec, s[12:13]
    v_add_u32 v21, v28, v20
    v_add_u32 v22, v29, v20
    s_mov_b64 exec, -1
    v_pk_fma_f32 v[98:99], v[98:99], v[108:109], v[98:99]
    v_pk_fma_f32 v[74:75], v[96:97], v[110:111], v[96:97]
    ds_read_b64_tr_b16 v[176:177], v21 offset:0
    ds_read_b64_tr_b16 v[178:179], v22 offset:0
    v_pk_fma_f32 v[96:97], v[142:143], v[98:99], v[74:75]
    v_pk_fma_f32 v[98:99], v[98:99], v[110:111], v[98:99]
    v_pk_fma_f32 v[74:75], v[96:97], v[112:113], v[96:97]
    ds_read_b64_tr_b16 v[180:181], v21 offset:64
    ds_read_b64_tr_b16 v[182:183], v22 offset:64
    v_pk_fma_f32 v[80:81], v[144:145], v[98:99], v[74:75]
    v_pk_fma_f32 v[82:83], v[98:99], v[112:113], v[98:99]
    v_pk_fma_f32 v[98:99], v[114:115], s[16:17], s[16:17]
    ds_read_b64_tr_b16 v[184:185], v21 offset:128
    ds_read_b64_tr_b16 v[186:187], v22 offset:128
    v_pk_mul_f32 v[96:97], v[146:147], s[16:17]
    v_pk_fma_f32 v[74:75], v[96:97], v[116:117], v[96:97]
    v_pk_fma_f32 v[96:97], v[148:149], v[98:99], v[74:75]
    v_pk_fma_f32 v[98:99], v[98:99], v[116:117], v[98:99]
    v_pk_fma_f32 v[74:75], v[96:97], v[118:119], v[96:97]
    v_pk_fma_f32 v[96:97], v[150:151], v[98:99], v[74:75]
    v_pk_fma_f32 v[98:99], v[98:99], v[118:119], v[98:99]
    v_pk_fma_f32 v[74:75], v[96:97], v[120:121], v[96:97]
    v_pk_fma_f32 v[96:97], v[152:153], v[98:99], v[74:75]
    v_pk_fma_f32 v[98:99], v[98:99], v[120:121], v[98:99]
    v_pk_fma_f32 v[74:75], v[96:97], v[122:123], v[96:97]
    v_pk_fma_f32 v[96:97], v[154:155], v[98:99], v[74:75]
    v_pk_fma_f32 v[98:99], v[98:99], v[122:123], v[98:99]
    v_mfma_f32_32x32x16_bf16 v[140:155], v[156:159], v[240:243], 0
    v_exp_f32 v108, v124
    v_exp_f32 v109, v125
    v_exp_f32 v110, v126
    v_mfma_f32_32x32x16_bf16 v[140:155], v[160:163], v[244:247], v[140:155]
    v_exp_f32 v111, v127
    v_exp_f32 v112, v128
    v_exp_f32 v113, v129
    v_mfma_f32_32x32x16_bf16 v[140:155], v[164:167], v[248:251], v[140:155]
    v_exp_f32 v114, v130
    v_exp_f32 v115, v131
    v_exp_f32 v116, v132
    v_mfma_f32_32x32x16_bf16 v[140:155], v[168:171], v[252:255], v[140:155]
    v_exp_f32 v117, v133
    v_exp_f32 v118, v134
    v_exp_f32 v119, v135
    v_mfma_f32_32x32x16_bf16 v[140:155], v[172:175], v[188:191], v[140:155]
    v_exp_f32 v120, v136
    v_exp_f32 v121, v137
    v_exp_f32 v122, v138
    v_exp_f32 v123, v139
    s_mov_b64 exec, s[12:13]
    ds_read_b128 v[172:175], v11
    s_mov_b64 exec, s[14:15]
    ds_read2_b64 v[172:175], v6 offset0:0 offset1:0
    s_mov_b64 exec, -1
    s_cmp_ge_u32 s4, s92
    v_pk_fma_f32 v[74:75], v[100:101], v[108:109], v[100:101]
    v_pk_fma_f32 v[100:101], v[124:125], v[102:103], v[74:75]
    ds_read_b64_tr_b16 v[188:189], v21 offset:192
    ds_read_b64_tr_b16 v[190:191], v22 offset:192
    v_pk_fma_f32 v[102:103], v[102:103], v[108:109], v[102:103]
    v_pk_fma_f32 v[74:75], v[100:101], v[110:111], v[100:101]
    s_waitcnt vmcnt(0)
    s_cbranch_scc1 NOLD3_0
    buffer_load_dwordx4 v[156:159], v13, s[28:31], 0 offen offset:0
    buffer_load_dwordx4 v[160:163], v13, s[28:31], 0 offen offset:16
    buffer_load_dwordx4 v[164:167], v13, s[28:31], 0 offen offset:32
    buffer_load_dwordx4 v[168:171], v13, s[28:31], 0 offen offset:48
NOLD3_0:
    v_pk_fma_f32 v[100:101], v[126:127], v[102:103], v[74:75]
    v_pk_fma_f32 v[102:103], v[102:103], v[110:111], v[102:103]
    v_pk_fma_f32 v[74:75], v[100:101], v[112:113], v[100:101]
    v_pk_fma_f32 v[84:85], v[128:129], v[102:103], v[74:75]
    v_pk_fma_f32 v[86:87], v[102:103], v[112:113], v[102:103]
    v_pk_fma_f32 v[102:103], v[114:115], s[16:17], s[16:17]
    v_pk_mul_f32 v[100:101], v[130:131], s[16:17]
    v_pk_fma_f32 v[74:75], v[100:101], v[116:117], v[100:101]
    v_pk_fma_f32 v[100:101], v[132:133], v[102:103], v[74:75]
    v_pk_fma_f32 v[102:103], v[102:103], v[116:117], v[102:103]
    v_pk_fma_f32 v[74:75], v[100:101], v[118:119], v[100:101]
    v_pk_fma_f32 v[100:101], v[134:135], v[102:103], v[74:75]
    v_pk_fma_f32 v[102:103], v[102:103], v[118:119], v[102:103]
    v_pk_fma_f32 v[74:75], v[100:101], v[120:121], v[100:101]
    v_pk_fma_f32 v[100:101], v[136:137], v[102:103], v[74:75]
    v_pk_fma_f32 v[102:103], v[102:103], v[120:121], v[102:103]
    v_pk_fma_f32 v[74:75], v[100:101], v[122:123], v[100:101]
    v_pk_fma_f32 v[100:101], v[138:139], v[102:103], v[74:75]
    v_pk_fma_f32 v[102:103], v[102:103], v[122:123], v[102:103]
    s_waitcnt lgkmcnt(0)
    s_cmp_ge_u32 s4, s88
    s_cbranch_scc1 LAST3_0
    v_mfma_f32_32x32x16_bf16 v[124:139], v[34:37], v[192:195], 0
    v_exp_f32 v108, v140
    v_exp_f32 v109, v141
    v_exp_f32 v110, v142
    v_mfma_f32_32x32x16_bf16 v[124:139], v[38:41], v[196:199], v[124:139]
    v_exp_f32 v111, v143
    v_exp_f32 v112, v144
    v_exp_f32 v113, v145
    v_mfma_f32_32x32x16_bf16 v[124:139], v[42:45], v[200:203], v[124:139]
    v_exp_f32 v114, v146
    v_exp_f32 v115, v147
    v_exp_f32 v116, v148
    v_mfma_f32_32x32x16_bf16 v[124:139], v[46:49], v[204:207], v[124:139]
    v_exp_f32 v117, v149
    v_exp_f32 v118, v150
    v_exp_f32 v119, v151
    v_mfma_f32_32x32x16_bf16 v[124:139], v[172:175], v[176:179], v[124:139]
    v_exp_f32 v120, v152
    v_exp_f32 v121, v153
    v_exp_f32 v122, v154
    v_exp_f32 v123, v155
    v_lshrrev_b32 v11, 16, v12
LASTJ3_0:
    v_pk_fma_f32 v[74:75], v[104:105], v[108:109], v[104:105]
    v_pk_fma_f32 v[104:105], v[140:141], v[106:107], v[74:75]
    v_pk_fma_f32 v[106:107], v[106:107], v[108:109], v[106:107]
    v_pk_fma_f32 v[74:75], v[104:105], v[110:111], v[104:105]
    v_pk_fma_f32 v[104:105], v[142:143], v[106:107], v[74:75]
    v_pk_fma_f32 v[106:107], v[106:107], v[110:111], v[106:107]
    v_pk_fma_f32 v[74:75], v[104:105], v[112:113], v[104:105]
    v_pk_fma_f32 v[88:89], v[144:145], v[106:107], v[74:75]
    v_pk_fma_f32 v[90:91], v[106:107], v[112:113], v[106:107]
    v_pk_fma_f32 v[106:107], v[114:115], s[16:17], s[16:17]
    v_pk_mul_f32 v[104:105], v[146:147], s[16:17]
    v_pk_fma_f32 v[74:75], v[104:105], v[116:117], v[104:105]
    v_pk_fma_f32 v[104:105], v[148:149], v[106:107], v[74:75]
    v_pk_fma_f32 v[106:107], v[106:107], v[116:117], v[106:107]
    v_pk_fma_f32 v[74:75], v[104:105], v[118:119], v[104:105]
    v_pk_fma_f32 v[104:105], v[150:151], v[106:107], v[74:75]
    v_pk_fma_f32 v[106:107], v[106:107], v[118:119], v[106:107]
    v_pk_fma_f32 v[74:75], v[104:105], v[120:121], v[104:105]
    v_pk_fma_f32 v[104:105], v[152:153], v[106:107], v[74:75]
    v_pk_fma_f32 v[106:107], v[106:107], v[120:121], v[106:107]
    v_pk_fma_f32 v[74:75], v[104:105], v[122:123], v[104:105]
    v_pk_fma_f32 v[104:105], v[154:155], v[106:107], v[74:75]
    v_pk_fma_f32 v[106:107], v[106:107], v[122:123], v[106:107]
    s_branch M_FLUSH0
    .p2align 6
M_V4_0:
    v_mfma_f32_32x32x16_bf16 v[140:155], v[156:159], v[208:211], 0
    v_exp_f32 v108, v124
    v_exp_f32 v109, v125
    v_exp_f32 v110, v126
    v_mfma_f32_32x32x16_bf16 v[140:155], v[160:163], v[212:215], v[140:155]
    v_exp_f32 v111, v127
    v_exp_f32 v112, v128
    v_exp_f32 v113, v129
    v_mfma_f32_32x32x16_bf16 v[140:155], v[164:167], v[216:219], v[140:155]
    v_exp_f32 v114, v130
    v_exp_f32 v115, v131
    v_exp_f32 v116, v132
    v_mfma_f32_32x32x16_bf16 v[140:155], v[168:171], v[220:223], v[140:155]
    v_exp_f32 v117, v133
    v_exp_f32 v118, v134
    v_exp_f32 v119, v135
    v_mfma_f32_32x32x16_bf16 v[140:155], v[172:175], v[180:183], v[140:155]
    v_exp_f32 v120, v136
    v_exp_f32 v121, v137
    v_exp_f32 v122, v138
    v_exp_f32 v123, v139
    v_pk_fma_f32 v[74:75], v[92:93], v[108:109], v[92:93]
    v_pk_fma_f32 v[92:93], v[124:125], v[94:95], v[74:75]
    ds_read_b32 v12, v8 offset:3328
    v_pk_fma_f32 v[94:95], v[94:95], v[108:109], v[94:95]
    v_pk_fma_f32 v[74:75], v[92:93], v[110:111], v[92:93]
    v_pk_fma_f32 v[92:93], v[126:127], v[94:95], v[74:75]
    v_pk_fma_f32 v[94:95], v[94:95], v[110:111], v[94:95]
    s_add_u32 s18, s6, 2
    s_and_b32 s18, s18, -2
    s_lshl_b32 s18, s18, 4
    s_add_u32 s19, s6, 1
    s_or_b32 s19, s19, 1
    s_lshl_b32 s19, s19, 4
    v_add_u32 v28, s18, v23
    v_add_u32 v29, s19, v23
    ds_read_b32 v28, v28
    ds_read_b32 v29, v29
    v_pk_fma_f32 v[74:75], v[92:93], v[112:113], v[92:93]
    v_pk_fma_f32 v[92:93], v[128:129], v[94:95], v[74:75]
    v_pk_fma_f32 v[94:95], v[94:95], v[112:113], v[94:95]
    v_pk_fma_f32 v[74:75], v[92:93], v[114:115], v[92:93]
    s_lshl_b32 s20, s6, 4
    v_add_u32 v26, s20, v24
    ds_read_b64 v[26:27], v26
    v_pk_fma_f32 v[76:77], v[130:131], v[94:95], v[74:75]
    v_pk_fma_f32 v[78:79], v[94:95], v[114:115], v[94:95]
    v_pk_fma_f32 v[94:95], v[116:117], s[16:17], s[16:17]
    v_pk_mul_f32 v[92:93], v[132:133], s[16:17]
    v_pk_fma_f32 v[74:75], v[92:93], v[118:119], v[92:93]
    v_pk_fma_f32 v[92:93], v[134:135], v[94:95], v[74:75]
    v_pk_fma_f32 v[94:95], v[94:95], v[118:119], v[94:95]
    v_pk_fma_f32 v[74:75], v[92:93], v[120:121], v[92:93]
    v_pk_fma_f32 v[92:93], v[136:137], v[94:95], v[74:75]
    v_pk_fma_f32 v[94:95], v[94:95], v[120:121], v[94:95]
    v_pk_fma_f32 v[74:75], v[92:93], v[122:123], v[92:93]
    v_pk_fma_f32 v[92:93], v[138:139], v[94:95], v[74:75]
    v_pk_fma_f32 v[94:95], v[94:95], v[122:123], v[94:95]
    s_waitcnt lgkmcnt(0)
    v_mfma_f32_32x32x16_bf16 v[124:139], v[156:159], v[224:227], 0
    v_exp_f32 v108, v140
    v_exp_f32 v109, v141
    v_exp_f32 v110, v142
    v_mfma_f32_32x32x16_bf16 v[124:139], v[160:163], v[228:231], v[124:139]
    v_exp_f32 v111, v143
    v_exp_f32 v112, v144
    v_exp_f32 v113, v145
    v_mfma_f32_32x32x16_bf16 v[124:139], v[164:167], v[232:235], v[124:139]
    v_exp_f32 v114, v146
    v_exp_f32 v115, v147
    v_exp_f32 v116, v148
    v_mfma_f32_32x32x16_bf16 v[124:139], v[168:171], v[236:239], v[124:139]
    v_exp_f32 v117, v149
    v_exp_f32 v118, v150
    v_exp_f32 v119, v151
    v_mfma_f32_32x32x16_bf16 v[124:139], v[172:175], v[184:187], v[124:139]
    v_exp_f32 v120, v152
    v_exp_f32 v121, v153
    v_exp_f32 v122, v154
    v_exp_f32 v123, v155
    v_mad_u32_u16 v13, v12, s11, v9
    v_pk_fma_f32 v[74:75], v[96:97], v[108:109], v[96:97]
    v_pk_fma_f32 v[96:97], v[140:141], v[98:99], v[74:75]
    s_mov_b64 exec, s[12:13]
    v_add_u32 v21, v28, v20
    v_add_u32 v22, v29, v20
    s_mov_b64 exec, -1
    v_pk_fma_f32 v[98:99], v[98:99], v[108:109], v[98:99]
    v_pk_fma_f32 v[74:75], v[96:97], v[110:111], v[96:97]
    ds_read_b64_tr_b16 v[176:177], v21 offset:0
    ds_read_b64_tr_b16 v[178:179], v22 offset:0
    v_pk_fma_f32 v[96:97], v[142:143], v[98:99], v[74:75]
    v_pk_fma_f32 v[98:99], v[98:99], v[110:111], v[98:99]
    v_pk_fma_f32 v[74:75], v[96:97], v[112:113], v[96:97]
    ds_read_b64_tr_b16 v[180:181], v21 offset:64
    ds_read_b64_tr_b16 v[182:183], v22 offset:64
    v_pk_fma_f32 v[96:97], v[144:145], v[98:99], v[74:75]
    v_pk_fma_f32 v[98:99], v[98:99], v[112:113], v[98:99]
    v_pk_fma_f32 v[74:75], v[96:97], v[114:115], v[96:97]
    ds_read_b64_tr_b16 v[184:185], v21 offset:128
    ds_read_b64_tr_b16 v[186:187], v22 offset:128
    v_pk_fma_f32 v[80:81], v[146:147], v[98:99], v[74:75]
    v_pk_fma_f32 v[82:83], v[98:99], v[114:115], v[98:99]
    v_pk_fma_f32 v[98:99], v[116:117], s[16:17], s[16:17]
    v_pk_mul_f32 v[96:97], v[148:149], s[16:17]
    v_pk_fma_f32 v[74:75], v[96:97], v[118:119], v[96:97]
    v_pk_fma_f32 v[96:97], v[150:151], v[98:99], v[74:75]
    v_pk_fma_f32 v[98:99], v[98:99], v[118:119], v[98:99]
    v_pk_fma_f32 v[74:75], v[96:97], v[120:121], v[96:97]
    v_pk_fma_f32 v[96:97], v[152:153], v[98:99], v[74:75]
    v_pk_fma_f32 v[98:99], v[98:99], v[120:121], v[98:99]
    v_pk_fma_f32 v[74:75], v[96:97], v[122:123], v[96:97]
    v_pk_fma_f32 v[96:97], v[154:155], v[98:99], v[74:75]
    v_pk_fma_f32 v[98:99], v[98:99], v[122:123], v[98:99]
    v_mfma_f32_32x32x16_bf16 v[140:155], v[156:159], v[240:243], 0
    v_exp_f32 v108, v124
    v_exp_f32 v109, v125
    v_exp_f32 v110, v126
    v_mfma_f32_32x32x16_bf16 v[140:155], v[160:163], v[244:247], v[140:155]
    v_exp_f32 v111, v127
    v_exp_f32 v112, v128
    v_exp_f32 v113, v129
    v_mfma_f32_32x32x16_bf16 v[140:155], v[164:167], v[248:251], v[140:155]
    v_exp_f32 v114, v130
    v_exp_f32 v115, v131
    v_exp_f32 v116, v132
    v_mfma_f32_32x32x16_bf16 v[140:155], v[168:171], v[252:255], v[140:155]
    v_exp_f32 v117, v133
    v_exp_f32 v118, v134
    v_exp_f32 v119, v135
    v_mfma_f32_32x32x16_bf16 v[140:155], v[172:175], v[188:191], v[140:155]
    v_exp_f32 v120, v136
    v_exp_f32 v121, v137
    v_exp_f32 v122, v138
    v_exp_f32 v123, v139
    s_mov_b64 exec, s[12:13]
    ds_read_b128 v[172:175], v11
    s_mov_b64 exec, s[14:15]
    ds_read2_b64 v[172:175], v6 offset0:0 offset1:0
    s_mov_b64 exec, -1
    s_cmp_ge_u32 s4, s92
    v_pk_fma_f32 v[74:75], v[100:101], v[108:109], v[100:101]
    v_pk_fma_f32 v[100:101], v[124:125], v[102:103], v[74:75]
    ds_read_b64_tr_b16 v[188:189], v21 offset:192
    ds_read_b64_tr_b16 v[190:191], v22 offset:192
    v_pk_fma_f32 v[102:103], v[102:103], v[108:109], v[102:103]
    v_pk_fma_f32 v[74:75], v[100:101], v[110:111], v[100:101]
    s_waitcnt vmcnt(0)
    s_cbranch_scc1 NOLD4_0
    buffer_load_dwordx4 v[156:159], v13, s[28:31], 0 offen offset:0
    buffer_load_dwordx4 v[160:163], v13, s[28:31], 0 offen offset:16
    buffer_load_dwordx4 v[164:167], v13, s[28:31], 0 offen offset:32
    buffer_load_dwordx4 v[168:171], v13, s[28:31], 0 offen offset:48
NOLD4_0:
    v_pk_fma_f32 v[100:101], v[126:127], v[102:103], v[74:75]
    v_pk_fma_f32 v[102:103], v[102:103], v[110:111], v[102:103]
    v_pk_fma_f32 v[74:75], v[100:101], v[112:113], v[100:101]
    v_pk_fma_f32 v[100:101], v[128:129], v[102:103], v[74:75]
    v_pk_fma_f32 v[102:103], v[102:103], v[112:113], v[102:103]
    v_pk_fma_f32 v[74:75], v[100:101], v[114:115], v[100:101]
    v_pk_fma_f32 v[84:85], v[130:131], v[102:103], v[74:75]
    v_pk_fma_f32 v[86:87], v[102:103], v[114:115], v[102:103]
    v_pk_fma_f32 v[102:103], v[116:117], s[16:17], s[16:17]
    v_pk_mul_f32 v[100:101], v[132:133], s[16:17]
    v_pk_fma_f32 v[74:75], v[100:101], v[118:119], v[100:101]
    v_pk_fma_f32 v[100:101], v[134:135], v[102:103], v[74:75]
    v_pk_fma_f32 v[102:103], v[102:103], v[118:119], v[102:103]
    v_pk_fma_f32 v[74:75], v[100:101], v[120:121], v[100:101]
    v_pk_fma_f32 v[100:101], v[136:137], v[102:103], v[74:75]
    v_pk_fma_f32 v[102:103], v[102:103], v[120:121], v[102:103]
    v_pk_fma_f32 v[74:75], v[100:101], v[122:123], v[100:101]
    v_pk_fma_f32 v[100:101], v[138:139], v[102:103], v[74:75]
    v_pk_fma_f32 v[102:103], v[102:103], v[122:123], v[102:103]
    s_waitcnt lgkmcnt(0)
    s_cmp_ge_u32 s4, s88
    s_cbranch_scc1 LAST4_0
    v_mfma_f32_32x32x16_bf16 v[124:139], v[34:37], v[192:195], 0
    v_exp_f32 v108, v140
    v_exp_f32 v109, v141
    v_exp_f32 v110, v142
    v_mfma_f32_32x32x16_bf16 v[124:139], v[38:41], v[196:199], v[124:139]
    v_exp_f32 v111, v143
    v_exp_f32 v112, v144
    v_exp_f32 v113, v145
    v_mfma_f32_32x32x16_bf16 v[124:139], v[42:45], v[200:203], v[124:139]
    v_exp_f32 v114, v146
    v_exp_f32 v115, v147
    v_exp_f32 v116, v148
    v_mfma_f32_32x32x16_bf16 v[124:139], v[46:49], v[204:207], v[124:139]
    v_exp_f32 v117, v149
    v_exp_f32 v118, v150
    v_exp_f32 v119, v151
    v_mfma_f32_32x32x16_bf16 v[124:139], v[172:175], v[176:179], v[124:139]
    v_exp_f32 v120, v152
    v_exp_f32 v121, v153
    v_exp_f32 v122, v154
    v_exp_f32 v123, v155
    v_lshrrev_b32 v11, 16, v12
LASTJ4_0:
    v_pk_fma_f32 v[74:75], v[104:105], v[108:109], v[104:105]
    v_pk_fma_f32 v[104:105], v[140:141], v[106:107], v[74:75]
    v_pk_fma_f32 v[106:107], v[106:107], v[108:109], v[106:107]
    v_pk_fma_f32 v[74:75], v[104:105], v[110:111], v[104:105]
    v_pk_fma_f32 v[104:105], v[142:143], v[106:107], v[74:75]
    v_pk_fma_f32 v[106:107], v[106:107], v[110:111], v[106:107]
    v_pk_fma_f32 v[74:75], v[104:105], v[112:113], v[104:105]
    v_pk_fma_f32 v[104:105], v[144:145], v[106:107], v[74:75]
    v_pk_fma_f32 v[106:107], v[106:107], v[112:113], v[106:107]
    v_pk_fma_f32 v[74:75], v[104:105], v[114:115], v[104:105]
    v_pk_fma_f32 v[88:89], v[146:147], v[106:107], v[74:75]
    v_pk_fma_f32 v[90:91], v[106:107], v[114:115], v[106:107]
    v_pk_fma_f32 v[106:107], v[116:117], s[16:17], s[16:17]
    v_pk_mul_f32 v[104:105], v[148:149], s[16:17]
    v_pk_fma_f32 v[74:75], v[104:105], v[118:119], v[104:105]
    v_pk_fma_f32 v[104:105], v[150:151], v[106:107], v[74:75]
    v_pk_fma_f32 v[106:107], v[106:107], v[118:119], v[106:107]
    v_pk_fma_f32 v[74:75], v[104:105], v[120:121], v[104:105]
    v_pk_fma_f32 v[104:105], v[152:153], v[106:107], v[74:75]
    v_pk_fma_f32 v[106:107], v[106:107], v[120:121], v[106:107]
    v_pk_fma_f32 v[74:75], v[104:105], v[122:123], v[104:105]
    v_pk_fma_f32 v[104:105], v[154:155], v[106:107], v[74:75]
    v_pk_fma_f32 v[106:107], v[106:107], v[122:123], v[106:107]
    s_branch M_FLUSH0
    .p2align 6
M_V5_0:
    v_mfma_f32_32x32x16_bf16 v[140:155], v[156:159], v[208:211], 0
    v_exp_f32 v108, v124
    v_exp_f32 v109, v125
    v_exp_f32 v110, v126
    v_mfma_f32_32x32x16_bf16 v[140:155], v[160:163], v[212:215], v[140:155]
    v_exp_f32 v111, v127
    v_exp_f32 v112, v128
    v_exp_f32 v113, v129
    v_mfma_f32_32x32x16_bf16 v[140:155], v[164:167], v[216:219], v[140:155]
    v_exp_f32 v114, v130
    v_exp_f32 v115, v131
    v_exp_f32 v116, v132
    v_mfma_f32_32x32x16_bf16 v[140:155], v[168:171], v[220:223], v[140:155]
    v_exp_f32 v117, v133
    v_exp_f32 v118, v134
    v_exp_f32 v119, v135
    v_mfma_f32_32x32x16_bf16 v[140:155], v[172:175], v[180:183], v[140:155]
    v_exp_f32 v120, v136
    v_exp_f32 v121, v137
    v_exp_f32 v122, v138
    v_exp_f32 v123, v139
    v_pk_fma_f32 v[74:75], v[92:93], v[108:109], v[92:93]
    v_pk_fma_f32 v[92:93], v[124:125], v[94:95], v[74:75]
    ds_read_b32 v12, v8 offset:3328
    v_pk_fma_f32 v[94:95], v[94:95], v[108:109], v[94:95]
    v_pk_fma_f32 v[74:75], v[92:93], v[110:111], v[92:93]
    v_pk_fma_f32 v[92:93], v[126:127], v[94:95], v[74:75]
    v_pk_fma_f32 v[94:95], v[94:95], v[110:111], v[94:95]
    s_add_u32 s18, s6, 2
    s_and_b32 s18, s18, -2
    s_lshl_b32 s18, s18, 4
    s_add_u32 s19, s6, 1
    s_or_b32 s19, s19, 1
    s_lshl_b32 s19, s19, 4
    v_add_u32 v28, s18, v23
    v_add_u32 v29, s19, v23
    ds_read_b32 v28, v28
    ds_read_b32 v29, v29
    v_pk_fma_f32 v[74:75], v[92:93], v[112:113], v[92:93]
    v_pk_fma_f32 v[92:93], v[128:129], v[94:95], v[74:75]
    v_pk_fma_f32 v[94:95], v[94:95], v[112:113], v[94:95]
    v_pk_fma_f32 v[74:75], v[92:93], v[114:115], v[92:93]
    s_lshl_b32 s20, s6, 4
    v_add_u32 v26, s20, v24
    ds_read_b64 v[26:27], v26
    v_pk_fma_f32 v[92:93], v[130:131], v[94:95], v[74:75]
    v_pk_fma_f32 v[94:95], v[94:95], v[114:115], v[94:95]
    v_pk_fma_f32 v[74:75], v[92:93], v[116:117], v[92:93]
    v_pk_fma_f32 v[76:77], v[132:133], v[94:95], v[74:75]
    v_pk_fma_f32 v[78:79], v[94:95], v[116:117], v[94:95]
    v_pk_fma_f32 v[94:95], v[118:119], s[16:17], s[16:17]
    v_pk_mul_f32 v[92:93], v[134:135], s[16:17]
    v_pk_fma_f32 v[74:75], v[92:93], v[120:121], v[92:93]
    v_pk_fma_f32 v[92:93], v[136:137], v[94:95], v[74:75]
    v_pk_fma_f32 v[94:95], v[94:95], v[120:121], v[94:95]
    v_pk_fma_f32 v[74:75], v[92:93], v[122:123], v[92:93]
    v_pk_fma_f32 v[92:93], v[138:139], v[94:95], v[74:75]
    v_pk_fma_f32 v[94:95], v[94:95], v[122:123], v[94:95]
    s_waitcnt lgkmcnt(0)
    v_mfma_f32_32x32x16_bf16 v[124:139], v[156:159], v[224:227], 0
    v_exp_f32 v108, v140
    v_exp_f32 v109, v141
    v_exp_f32 v110, v142
    v_mfma_f32_32x32x16_bf16 v[124:139], v[160:163], v[228:231], v[124:139]
    v_exp_f32 v111, v143
    v_exp_f32 v112, v144
    v_exp_f32 v113, v145
    v_mfma_f32_32x32x16_bf16 v[124:139], v[164:167], v[232:235], v[124:139]
    v_exp_f32 v114, v146
    v_exp_f32 v115, v147
    v_exp_f32 v116, v148
    v_mfma_f32_32x32x16_bf16 v[124:139], v[168:171], v[236:239], v[124:139]
    v_exp_f32 v117, v149
    v_exp_f32 v118, v150
    v_exp_f32 v119, v151
    v_mfma_f32_32x32x16_bf16 v[124:139], v[172:175], v[184:187], v[124:139]
    v_exp_f32 v120, v152
    v_exp_f32 v121, v153
    v_exp_f32 v122, v154
    v_exp_f32 v123, v155
    v_mad_u32_u16 v13, v12, s11, v9
    v_pk_fma_f32 v[74:75], v[96:97], v[108:109], v[96:97]
    v_pk_fma_f32 v[96:97], v[140:141], v[98:99], v[74:75]
    s_mov_b64 exec, s[12:13]
    v_add_u32 v21, v28, v20
    v_add_u32 v22, v29, v20
    s_mov_b64 exec, -1
    v_pk_fma_f32 v[98:99], v[98:99], v[108:109], v[98:99]
    v_pk_fma_f32 v[74:75], v[96:97], v[110:111], v[96:97]
    ds_read_b64_tr_b16 v[176:177], v21 offset:0
    ds_read_b64_tr_b16 v[178:179], v22 offset:0
    v_pk_fma_f32 v[96:97], v[142:143], v[98:99], v[74:75]
    v_pk_fma_f32 v[98:99], v[98:99], v[110:111], v[98:99]
    v_pk_fma_f32 v[74:75], v[96:97], v[112:113], v[96:97]
    ds_read_b64_tr_b16 v[180:181], v21 offset:64
    ds_read_b64_tr_b16 v[182:183], v22 offset:64
    v_pk_fma_f32 v[96:97], v[144:145], v[98:99], v[74:75]
    v_pk_fma_f32 v[98:99], v[98:99], v[112:113], v[98:99]
    v_pk_fma_f32 v[74:75], v[96:97], v[114:115], v[96:97]
    ds_read_b64_tr_b16 v[184:185], v21 offset:128
    ds_read_b64_tr_b16 v[186:187], v22 offset:128
    v_pk_fma_f32 v[96:97], v[146:147], v[98:99], v[74:75]
    v_pk_fma_f32 v[98:99], v[98:99], v[114:115], v[98:99]
    v_pk_fma_f32 v[74:75], v[96:97], v[116:117], v[96:97]
    v_pk_fma_f32 v[80:81], v[148:149], v[98:99], v[74:75]
    v_pk_fma_f32 v[82:83], v[98:99], v[116:117], v[98:99]
    v_pk_fma_f32 v[98:99], v[118:119], s[16:17], s[16:17]
    v_pk_mul_f32 v[96:97], v[150:151], s[16:17]
    v_pk_fma_f32 v[74:75], v[96:97], v[120:121], v[96:97]
    v_pk_fma_f32 v[96:97], v[152:153], v[98:99], v[74:75]
    v_pk_fma_f32 v[98:99], v[98:99], v[120:121], v[98:99]
    v_pk_fma_f32 v[74:75], v[96:97], v[122:123], v[96:97]
    v_pk_fma_f32 v[96:97], v[154:155], v[98:99], v[74:75]
    v_pk_fma_f32 v[98:99], v[98:99], v[122:123], v[98:99]
    v_mfma_f32_32x32x16_bf16 v[140:155], v[156:159], v[240:243], 0
    v_exp_f32 v108, v124
    v_exp_f32 v109, v125
    v_exp_f32 v110, v126
    v_mfma_f32_32x32x16_bf16 v[140:155], v[160:163], v[244:247], v[140:155]
    v_exp_f32 v111, v127
    v_exp_f32 v112, v128
    v_exp_f32 v113, v129
    v_mfma_f32_32x32x16_bf16 v[140:155], v[164:167], v[248:251], v[140:155]
    v_exp_f32 v114, v130
    v_exp_f32 v115, v131
    v_exp_f32 v116, v132
    v_mfma_f32_32x32x16_bf16 v[140:155], v[168:171], v[252:255], v[140:155]
    v_exp_f32 v117, v133
    v_exp_f32 v118, v134
    v_exp_f32 v119, v135
    v_mfma_f32_32x32x16_bf16 v[140:155], v[172:175], v[188:191], v[140:155]
    v_exp_f32 v120, v136
    v_exp_f32 v121, v137
    v_exp_f32 v122, v138
    v_exp_f32 v123, v139
    s_mov_b64 exec, s[12:13]
    ds_read_b128 v[172:175], v11
    s_mov_b64 exec, s[14:15]
    ds_read2_b64 v[172:175], v6 offset0:0 offset1:0
    s_mov_b64 exec, -1
    s_cmp_ge_u32 s4, s92
    v_pk_fma_f32 v[74:75], v[100:101], v[108:109], v[100:101]
    v_pk_fma_f32 v[100:101], v[124:125], v[102:103], v[74:75]
    ds_read_b64_tr_b16 v[188:189], v21 offset:192
    ds_read_b64_tr_b16 v[190:191], v22 offset:192
    v_pk_fma_f32 v[102:103], v[102:103], v[108:109], v[102:103]
    v_pk_fma_f32 v[74:75], v[100:101], v[110:111], v[100:101]
    s_waitcnt vmcnt(0)
    s_cbranch_scc1 NOLD5_0
    buffer_load_dwordx4 v[156:159], v13, s[28:31], 0 offen offset:0
    buffer_load_dwordx4 v[160:163], v13, s[28:31], 0 offen offset:16
    buffer_load_dwordx4 v[164:167], v13, s[28:31], 0 offen offset:32
    buffer_load_dwordx4 v[168:171], v13, s[28:31], 0 offen offset:48
NOLD5_0:
    v_pk_fma_f32 v[100:101], v[126:127], v[102:103], v[74:75]
    v_pk_fma_f32 v[102:103], v[102:103], v[110:111], v[102:103]
    v_pk_fma_f32 v[74:75], v[100:101], v[112:113], v[100:101]
    v_pk_fma_f32 v[100:101], v[128:129], v[102:103], v[74:75]
    v_pk_fma_f32 v[102:103], v[102:103], v[112:113], v[102:103]
    v_pk_fma_f32 v[74:75], v[100:101], v[114:115], v[100:101]
    v_pk_fma_f32 v[100:101], v[130:131], v[102:103], v[74:75]
    v_pk_fma_f32 v[102:103], v[102:103], v[114:115], v[102:103]
    v_pk_fma_f32 v[74:75], v[100:101], v[116:117], v[100:101]
    v_pk_fma_f32 v[84:85], v[132:133], v[102:103], v[74:75]
    v_pk_fma_f32 v[86:87], v[102:103], v[116:117], v[102:103]
    v_pk_fma_f32 v[102:103], v[118:119], s[16:17], s[16:17]
    v_pk_mul_f32 v[100:101], v[134:135], s[16:17]
    v_pk_fma_f32 v[74:75], v[100:101], v[120:121], v[100:101]
    v_pk_fma_f32 v[100:101], v[136:137], v[102:103], v[74:75]
    v_pk_fma_f32 v[102:103], v[102:103], v[120:121], v[102:103]
    v_pk_fma_f32 v[74:75], v[100:101], v[122:123], v[100:101]
    v_pk_fma_f32 v[100:101], v[138:139], v[102:103], v[74:75]
    v_pk_fma_f32 v[102:103], v[102:103], v[122:123], v[102:103]
    s_waitcnt lgkmcnt(0)
    s_cmp_ge_u32 s4, s88
    s_cbranch_scc1 LAST5_0
    v_mfma_f32_32x32x16_bf16 v[124:139], v[34:37], v[192:195], 0
    v_exp_f32 v108, v140
    v_exp_f32 v109, v141
    v_exp_f32 v110, v142
    v_mfma_f32_32x32x16_bf16 v[124:139], v[38:41], v[196:199], v[124:139]
    v_exp_f32 v111, v143
    v_exp_f32 v112, v144
    v_exp_f32 v113, v145
    v_mfma_f32_32x32x16_bf16 v[124:139], v[42:45], v[200:203], v[124:139]
    v_exp_f32 v114, v146
    v_exp_f32 v115, v147
    v_exp_f32 v116, v148
    v_mfma_f32_32x32x16_bf16 v[124:139], v[46:49], v[204:207], v[124:139]
    v_exp_f32 v117, v149
    v_exp_f32 v118, v150
    v_exp_f32 v119, v151
    v_mfma_f32_32x32x16_bf16 v[124:139], v[172:175], v[176:179], v[124:139]
    v_exp_f32 v120, v152
    v_exp_f32 v121, v153
    v_exp_f32 v122, v154
    v_exp_f32 v123, v155
    v_lshrrev_b32 v11, 16, v12
LASTJ5_0:
    v_pk_fma_f32 v[74:75], v[104:105], v[108:109], v[104:105]
    v_pk_fma_f32 v[104:105], v[140:141], v[106:107], v[74:75]
    v_pk_fma_f32 v[106:107], v[106:107], v[108:109], v[106:107]
    v_pk_fma_f32 v[74:75], v[104:105], v[110:111], v[104:105]
    v_pk_fma_f32 v[104:105], v[142:143], v[106:107], v[74:75]
    v_pk_fma_f32 v[106:107], v[106:107], v[110:111], v[106:107]
    v_pk_fma_f32 v[74:75], v[104:105], v[112:113], v[104:105]
    v_pk_fma_f32 v[104:105], v[144:145], v[106:107], v[74:75]
    v_pk_fma_f32 v[106:107], v[106:107], v[112:113], v[106:107]
    v_pk_fma_f32 v[74:75], v[104:105], v[114:115], v[104:105]
    v_pk_fma_f32 v[104:105], v[146:147], v[106:107], v[74:75]
    v_pk_fma_f32 v[106:107], v[106:107], v[114:115], v[106:107]
    v_pk_fma_f32 v[74:75], v[104:105], v[116:117], v[104:105]
    v_pk_fma_f32 v[88:89], v[148:149], v[106:107], v[74:75]
    v_pk_fma_f32 v[90:91], v[106:107], v[116:117], v[106:107]
    v_pk_fma_f32 v[106:107], v[118:119], s[16:17], s[16:17]
    v_pk_mul_f32 v[104:105], v[150:151], s[16:17]
    v_pk_fma_f32 v[74:75], v[104:105], v[120:121], v[104:105]
    v_pk_fma_f32 v[104:105], v[152:153], v[106:107], v[74:75]
    v_pk_fma_f32 v[106:107], v[106:107], v[120:121], v[106:107]
    v_pk_fma_f32 v[74:75], v[104:105], v[122:123], v[104:105]
    v_pk_fma_f32 v[104:105], v[154:155], v[106:107], v[74:75]
    v_pk_fma_f32 v[106:107], v[106:107], v[122:123], v[106:107]
    s_branch M_FLUSH0
    .p2align 6
M_V6_0:
    v_mfma_f32_32x32x16_bf16 v[140:155], v[156:159], v[208:211], 0
    v_exp_f32 v108, v124
    v_exp_f32 v109, v125
    v_exp_f32 v110, v126
    v_mfma_f32_32x32x16_bf16 v[140:155], v[160:163], v[212:215], v[140:155]
    v_exp_f32 v111, v127
    v_exp_f32 v112, v128
    v_exp_f32 v113, v129
    v_mfma_f32_32x32x16_bf16 v[140:155], v[164:167], v[216:219], v[140:155]
    v_exp_f32 v114, v130
    v_exp_f32 v115, v131
    v_exp_f32 v116, v132
    v_mfma_f32_32x32x16_bf16 v[140:155], v[168:171], v[220:223], v[140:155]
    v_exp_f32 v117, v133
    v_exp_f32 v118, v134
    v_exp_f32 v119, v135
    v_mfma_f32_32x32x16_bf16 v[140:155], v[172:175], v[180:183], v[140:155]
    v_exp_f32 v120, v136
    v_exp_f32 v121, v137
    v_exp_f32 v122, v138
    v_exp_f32 v123, v139
    v_pk_fma_f32 v[74:75], v[92:93], v[108:109], v[92:93]
    v_pk_fma_f32 v[92:93], v[124:125], v[94:95], v[74:75]
    ds_read_b32 v12, v8 offset:3328
    v_pk_fma_f32 v[94:95], v[94:95], v[108:109], v[94:95]
    v_pk_fma_f32 v[74:75], v[92:93], v[110:111], v[92:93]
    v_pk_fma_f32 v[92:93], v[126:127], v[94:95], v[74:75]
    v_pk_fma_f32 v[94:95], v[94:95], v[110:111], v[94:95]
    s_add_u32 s18, s6, 2
    s_and_b32 s18, s18, -2
    s_lshl_b32 s18, s18, 4
    s_add_u32 s19, s6, 1
    s_or_b32 s19, s19, 1
    s_lshl_b32 s19, s19, 4
    v_add_u32 v28, s18, v23
    v_add_u32 v29, s19, v23
    ds_read_b32 v28, v28
    ds_read_b32 v29, v29
    v_pk_fma_f32 v[74:75], v[92:93], v[112:113], v[92:93]
    v_pk_fma_f32 v[92:93], v[128:129], v[94:95], v[74:75]
    v_pk_fma_f32 v[94:95], v[94:95], v[112:113], v[94:95]
    v_pk_fma_f32 v[74:75], v[92:93], v[114:115], v[92:93]
    s_lshl_b32 s20, s6, 4
    v_add_u32 v26, s20, v24
    ds_read_b64 v[26:27], v26
    v_pk_fma_f32 v[92:93], v[130:131], v[94:95], v[74:75]
    v_pk_fma_f32 v[94:95], v[94:95], v[114:115], v[94:95]
    v_pk_fma_f32 v[74:75], v[92:93], v[116:117], v[92:93]
    v_pk_fma_f32 v[92:93], v[132:133], v[94:95], v[74:75]
    v_pk_fma_f32 v[94:95], v[94:95], v[116:117], v[94:95]
    v_pk_fma_f32 v[74:75], v[92:93], v[118:119], v[92:93]
    v_pk_fma_f32 v[76:77], v[134:135], v[94:95], v[74:75]
    v_pk_fma_f32 v[78:79], v[94:95], v[118:119], v[94:95]
    v_pk_fma_f32 v[94:95], v[120:121], s[16:17], s[16:17]
    v_pk_mul_f32 v[92:93], v[136:137], s[16:17]
    v_pk_fma_f32 v[74:75], v[92:93], v[122:123], v[92:93]
    v_pk_fma_f32 v[92:93], v[138:139], v[94:95], v[74:75]
    v_pk_fma_f32 v[94:95], v[94:95], v[122:123], v[94:95]
    s_waitcnt lgkmcnt(0)
    v_mfma_f32_32x32x16_bf16 v[124:139], v[156:159], v[224:227], 0
    v_exp_f32 v108, v140
    v_exp_f32 v109, v141
    v_exp_f32 v110, v142
    v_mfma_f32_32x32x16_bf16 v[124:139], v[160:163], v[228:231], v[124:139]
    v_exp_f32 v111, v143
    v_exp_f32 v112, v144
    v_exp_f32 v113, v145
    v_mfma_f32_32x32x16_bf16 v[124:139], v[164:167], v[232:235], v[124:139]
    v_exp_f32 v114, v146
    v_exp_f32 v115, v147
    v_exp_f32 v116, v148
    v_mfma_f32_32x32x16_bf16 v[124:139], v[168:171], v[236:239], v[124:139]
    v_exp_f32 v117, v149
    v_exp_f32 v118, v150
    v_exp_f32 v119, v151
    v_mfma_f32_32x32x16_bf16 v[124:139], v[172:175], v[184:187], v[124:139]
    v_exp_f32 v120, v152
    v_exp_f32 v121, v153
    v_exp_f32 v122, v154
    v_exp_f32 v123, v155
    v_mad_u32_u16 v13, v12, s11, v9
    v_pk_fma_f32 v[74:75], v[96:97], v[108:109], v[96:97]
    v_pk_fma_f32 v[96:97], v[140:141], v[98:99], v[74:75]
    s_mov_b64 exec, s[12:13]
    v_add_u32 v21, v28, v20
    v_add_u32 v22, v29, v20
    s_mov_b64 exec, -1
    v_pk_fma_f32 v[98:99], v[98:99], v[108:109], v[98:99]
    v_pk_fma_f32 v[74:75], v[96:97], v[110:111], v[96:97]
    ds_read_b64_tr_b16 v[176:177], v21 offset:0
    ds_read_b64_tr_b16 v[178:179], v22 offset:0
    v_pk_fma_f32 v[96:97], v[142:143], v[98:99], v[74:75]
    v_pk_fma_f32 v[98:99], v[98:99], v[110:111], v[98:99]
    v_pk_fma_f32 v[74:75], v[96:97], v[112:113], v[96:97]
    ds_read_b64_tr_b16 v[180:181], v21 offset:64
    ds_read_b64_tr_b16 v[182:183], v22 offset:64
    v_pk_fma_f32 v[96:97], v[144:145], v[98:99], v[74:75]
    v_pk_fma_f32 v[98:99], v[98:99], v[112:113], v[98:99]
    v_pk_fma_f32 v[74:75], v[96:97], v[114:115], v[96:97]
    ds_read_b64_tr_b16 v[184:185], v21 offset:128
    ds_read_b64_tr_b16 v[186:187], v22 offset:128
    v_pk_fma_f32 v[96:97], v[146:147], v[98:99], v[74:75]
    v_pk_fma_f32 v[98:99], v[98:99], v[114:115], v[98:99]
    v_pk_fma_f32 v[74:75], v[96:97], v[116:117], v[96:97]
    v_pk_fma_f32 v[96:97], v[148:149], v[98:99], v[74:75]
    v_pk_fma_f32 v[98:99], v[98:99], v[116:117], v[98:99]
    v_pk_fma_f32 v[74:75], v[96:97], v[118:119], v[96:97]
    v_pk_fma_f32 v[80:81], v[150:151], v[98:99], v[74:75]
    v_pk_fma_f32 v[82:83], v[98:99], v[118:119], v[98:99]
    v_pk_fma_f32 v[98:99], v[120:121], s[16:17], s[16:17]
    v_pk_mul_f32 v[96:97], v[152:153], s[16:17]
    v_pk_fma_f32 v[74:75], v[96:97], v[122:123], v[96:97]
    v_pk_fma_f32 v[96:97], v[154:155], v[98:99], v[74:75]
    v_pk_fma_f32 v[98:99], v[98:99], v[122:123], v[98:99]
    v_mfma_f32_32x32x16_bf16 v[140:155], v[156:159], v[240:243], 0
    v_exp_f32 v108, v124
    v_exp_f32 v109, v125
    v_exp_f32 v110, v126
    v_mfma_f32_32x32x16_bf16 v[140:155], v[160:163], v[244:247], v[140:155]
    v_exp_f32 v111, v127
    v_exp_f32 v112, v128
    v_exp_f32 v113, v129
    v_mfma_f32_32x32x16_bf16 v[140:155], v[164:167], v[248:251], v[140:155]
    v_exp_f32 v114, v130
    v_exp_f32 v115, v131
    v_exp_f32 v116, v132
    v_mfma_f32_32x32x16_bf16 v[140:155], v[168:171], v[252:255], v[140:155]
    v_exp_f32 v117, v133
    v_exp_f32 v118, v134
    v_exp_f32 v119, v135
    v_mfma_f32_32x32x16_bf16 v[140:155], v[172:175], v[188:191], v[140:155]
    v_exp_f32 v120, v136
    v_exp_f32 v121, v137
    v_exp_f32 v122, v138
    v_exp_f32 v123, v139
    s_mov_b64 exec, s[12:13]
    ds_read_b128 v[172:175], v11
    s_mov_b64 exec, s[14:15]
    ds_read2_b64 v[172:175], v6 offset0:0 offset1:0
    s_mov_b64 exec, -1
    s_cmp_ge_u32 s4, s92
    v_pk_fma_f32 v[74:75], v[100:101], v[108:109], v[100:101]
    v_pk_fma_f32 v[100:101], v[124:125], v[102:103], v[74:75]
    ds_read_b64_tr_b16 v[188:189], v21 offset:192
    ds_read_b64_tr_b16 v[190:191], v22 offset:192
    v_pk_fma_f32 v[102:103], v[102:103], v[108:109], v[102:103]
    v_pk_fma_f32 v[74:75], v[100:101], v[110:111], v[100:101]
    s_waitcnt vmcnt(0)
    s_cbranch_scc1 NOLD6_0
    buffer_load_dwordx4 v[156:159], v13, s[28:31], 0 offen offset:0
    buffer_load_dwordx4 v[160:163], v13, s[28:31], 0 offen offset:16
    buffer_load_dwordx4 v[164:167], v13, s[28:31], 0 offen offset:32
    buffer_load_dwordx4 v[168:171], v13, s[28:31], 0 offen offset:48
NOLD6_0:
    v_pk_fma_f32 v[100:101], v[126:127], v[102:103], v[74:75]
    v_pk_fma_f32 v[102:103], v[102:103], v[110:111], v[102:103]
    v_pk_fma_f32 v[74:75], v[100:101], v[112:113], v[100:101]
    v_pk_fma_f32 v[100:101], v[128:129], v[102:103], v[74:75]
    v_pk_fma_f32 v[102:103], v[102:103], v[112:113], v[102:103]
    v_pk_fma_f32 v[74:75], v[100:101], v[114:115], v[100:101]
    v_pk_fma_f32 v[100:101], v[130:131], v[102:103], v[74:75]
    v_pk_fma_f32 v[102:103], v[102:103], v[114:115], v[102:103]
    v_pk_fma_f32 v[74:75], v[100:101], v[116:117], v[100:101]
    v_pk_fma_f32 v[100:101], v[132:133], v[102:103], v[74:75]
    v_pk_fma_f32 v[102:103], v[102:103], v[116:117], v[102:103]
    v_pk_fma_f32 v[74:75], v[100:101], v[118:119], v[100:101]
    v_pk_fma_f32 v[84:85], v[134:135], v[102:103], v[74:75]
    v_pk_fma_f32 v[86:87], v[102:103], v[118:119], v[102:103]
    v_pk_fma_f32 v[102:103], v[120:121], s[16:17], s[16:17]
    v_pk_mul_f32 v[100:101], v[136:137], s[16:17]
    v_pk_fma_f32 v[74:75], v[100:101], v[122:123], v[100:101]
    v_pk_fma_f32 v[100:101], v[138:139], v[102:103], v[74:75]
    v_pk_fma_f32 v[102:103], v[102:103], v[122:123], v[102:103]
    s_waitcnt lgkmcnt(0)
    s_cmp_ge_u32 s4, s88
    s_cbranch_scc1 LAST6_0
    v_mfma_f32_32x32x16_bf16 v[124:139], v[34:37], v[192:195], 0
    v_exp_f32 v108, v140
    v_exp_f32 v109, v141
    v_exp_f32 v110, v142
    v_mfma_f32_32x32x16_bf16 v[124:139], v[38:41], v[196:199], v[124:139]
    v_exp_f32 v111, v143
    v_exp_f32 v112, v144
    v_exp_f32 v113, v145
    v_mfma_f32_32x32x16_bf16 v[124:139], v[42:45], v[200:203], v[124:139]
    v_exp_f32 v114, v146
    v_exp_f32 v115, v147
    v_exp_f32 v116, v148
    v_mfma_f32_32x32x16_bf16 v[124:139], v[46:49], v[204:207], v[124:139]
    v_exp_f32 v117, v149
    v_exp_f32 v118, v150
    v_exp_f32 v119, v151
    v_mfma_f32_32x32x16_bf16 v[124:139], v[172:175], v[176:179], v[124:139]
    v_exp_f32 v120, v152
    v_exp_f32 v121, v153
    v_exp_f32 v122, v154
    v_exp_f32 v123, v155
    v_lshrrev_b32 v11, 16, v12
LASTJ6_0:
    v_pk_fma_f32 v[74:75], v[104:105], v[108:109], v[104:105]
    v_pk_fma_f32 v[104:105], v[140:141], v[106:107], v[74:75]
    v_pk_fma_f32 v[106:107], v[106:107], v[108:109], v[106:107]
    v_pk_fma_f32 v[74:75], v[104:105], v[110:111], v[104:105]
    v_pk_fma_f32 v[104:105], v[142:143], v[106:107], v[74:75]
    v_pk_fma_f32 v[106:107], v[106:107], v[110:111], v[106:107]
    v_pk_fma_f32 v[74:75], v[104:105], v[112:113], v[104:105]
    v_pk_fma_f32 v[104:105], v[144:145], v[106:107], v[74:75]
    v_pk_fma_f32 v[106:107], v[106:107], v[112:113], v[106:107]
    v_pk_fma_f32 v[74:75], v[104:105], v[114:115], v[104:105]
    v_pk_fma_f32 v[104:105], v[146:147], v[106:107], v[74:75]
    v_pk_fma_f32 v[106:107], v[106:107], v[114:115], v[106:107]
    v_pk_fma_f32 v[74:75], v[104:105], v[116:117], v[104:105]
    v_pk_fma_f32 v[104:105], v[148:149], v[106:107], v[74:75]
    v_pk_fma_f32 v[106:107], v[106:107], v[116:117], v[106:107]
    v_pk_fma_f32 v[74:75], v[104:105], v[118:119], v[104:105]
    v_pk_fma_f32 v[88:89], v[150:151], v[106:107], v[74:75]
    v_pk_fma_f32 v[90:91], v[106:107], v[118:119], v[106:107]
    v_pk_fma_f32 v[106:107], v[120:121], s[16:17], s[16:17]
    v_pk_mul_f32 v[104:105], v[152:153], s[16:17]
    v_pk_fma_f32 v[74:75], v[104:105], v[122:123], v[104:105]
    v_pk_fma_f32 v[104:105], v[154:155], v[106:107], v[74:75]
    v_pk_fma_f32 v[106:107], v[106:107], v[122:123], v[106:107]
    s_branch M_FLUSH0
    .p2align 6
M_V7_0:
    v_mfma_f32_32x32x16_bf16 v[140:155], v[156:159], v[208:211], 0
    v_exp_f32 v108, v124
    v_exp_f32 v109, v125
    v_exp_f32 v110, v126
    v_mfma_f32_32x32x16_bf16 v[140:155], v[160:163], v[212:215], v[140:155]
    v_exp_f32 v111, v127
    v_exp_f32 v112, v128
    v_exp_f32 v113, v129
    v_mfma_f32_32x32x16_bf16 v[140:155], v[164:167], v[216:219], v[140:155]
    v_exp_f32 v114, v130
    v_exp_f32 v115, v131
    v_exp_f32 v116, v132
    v_mfma_f32_32x32x16_bf16 v[140:155], v[168:171], v[220:223], v[140:155]
    v_exp_f32 v117, v133
    v_exp_f32 v118, v134
    v_exp_f32 v119, v135
    v_mfma_f32_32x32x16_bf16 v[140:155], v[172:175], v[180:183], v[140:155]
    v_exp_f32 v120, v136
    v_exp_f32 v121, v137
    v_exp_f32 v122, v138
    v_exp_f32 v123, v139
    v_pk_fma_f32 v[74:75], v[92:93], v[108:109], v[92:93]
    v_pk_fma_f32 v[92:93], v[124:125], v[94:95], v[74:75]
    ds_read_b32 v12, v8 offset:3328
    v_pk_fma_f32 v[94:95], v[94:95], v[108:109], v[94:95]
    v_pk_fma_f32 v[74:75], v[92:93], v[110:111], v[92:93]
    v_pk_fma_f32 v[92:93], v[126:127], v[94:95], v[74:75]
    v_pk_fma_f32 v[94:95], v[94:95], v[110:111], v[94:95]
    s_add_u32 s18, s6, 2
    s_and_b32 s18, s18, -2
    s_lshl_b32 s18, s18, 4
    s_add_u32 s19, s6, 1
    s_or_b32 s19, s19, 1
    s_lshl_b32 s19, s19, 4
    v_add_u32 v28, s18, v23
    v_add_u32 v29, s19, v23
    ds_read_b32 v28, v28
    ds_read_b32 v29, v29
    v_pk_fma_f32 v[74:75], v[92:93], v[112:113], v[92:93]
    v_pk_fma_f32 v[92:93], v[128:129], v[94:95], v[74:75]
    v_pk_fma_f32 v[94:95], v[94:95], v[112:113], v[94:95]
    v_pk_fma_f32 v[74:75], v[92:93], v[114:115], v[92:93]
    s_lshl_b32 s20, s6, 4
    v_add_u32 v26, s20, v24
    ds_read_b64 v[26:27], v26
    v_pk_fma_f32 v[92:93], v[130:131], v[94:95], v[74:75]
    v_pk_fma_f32 v[94:95], v[94:95], v[114:115], v[94:95]
    v_pk_fma_f32 v[74:75], v[92:93], v[116:117], v[92:93]
    v_pk_fma_f32 v[92:93], v[132:133], v[94:95], v[74:75]
    v_pk_fma_f32 v[94:95], v[94:95], v[116:117], v[94:95]
    v_pk_fma_f32 v[74:75], v[92:93], v[118:119], v[92:93]
    v_pk_fma_f32 v[92:93], v[134:135], v[94:95], v[74:75]
    v_pk_fma_f32 v[94:95], v[94:95], v[118:119], v[94:95]
    v_pk_fma_f32 v[74:75], v[92:93], v[120:121], v[92:93]
    v_pk_fma_f32 v[76:77], v[136:137], v[94:95], v[74:75]
    v_pk_fma_f32 v[78:79], v[94:95], v[120:121], v[94:95]
    v_pk_fma_f32 v[94:95], v[122:123], s[16:17], s[16:17]
    v_pk_mul_f32 v[92:93], v[138:139], s[16:17]
    s_waitcnt lgkmcnt(0)
    v_mfma_f32_32x32x16_bf16 v[124:139], v[156:159], v[224:227], 0
    v_exp_f32 v108, v140
    v_exp_f32 v109, v141
    v_exp_f32 v110, v142
    v_mfma_f32_32x32x16_bf16 v[124:139], v[160:163], v[228:231], v[124:139]
    v_exp_f32 v111, v143
    v_exp_f32 v112, v144
    v_exp_f32 v113, v145
    v_mfma_f32_32x32x16_bf16 v[124:139], v[164:167], v[232:235], v[124:139]
    v_exp_f32 v114, v146
    v_exp_f32 v115, v147
    v_exp_f32 v116, v148
    v_mfma_f32_32x32x16_bf16 v[124:139], v[168:171], v[236:239], v[124:139]
    v_exp_f32 v117, v149
    v_exp_f32 v118, v150
    v_exp_f32 v119, v151
    v_mfma_f32_32x32x16_bf16 v[124:139], v[172:175], v[184:187], v[124:139]
    v_exp_f32 v120, v152
    v_exp_f32 v121, v153
    v_exp_f32 v122, v154
    v_exp_f32 v123, v155
    v_mad_u32_u16 v13, v12, s11, v9
    v_pk_fma_f32 v[74:75], v[96:97], v[108:109], v[96:97]
    v_pk_fma_f32 v[96:97], v[140:141], v[98:99], v[74:75]
    s_mov_b64 exec, s[12:13]
    v_add_u32 v21, v28, v20
    v_add_u32 v22, v29, v20
    s_mov_b64 exec, -1
    v_pk_fma_f32 v[98:99], v[98:99], v[108:109], v[98:99]
    v_pk_fma_f32 v[74:75], v[96:97], v[110:111], v[96:97]
    ds_read_b64_tr_b16 v[176:177], v21 offset:0
    ds_read_b64_tr_b16 v[178:179], v22 offset:0
    v_pk_fma_f32 v[96:97], v[142:143], v[98:99], v[74:75]
    v_pk_fma_f32 v[98:99], v[98:99], v[110:111], v[98:99]
    v_pk_fma_f32 v[74:75], v[96:97], v[112:113], v[96:97]
    ds_read_b64_tr_b16 v[180:181], v21 offset:64
    ds_read_b64_tr_b16 v[182:183], v22 offset:64
    v_pk_fma_f32 v[96:97], v[144:145], v[98:99], v[74:75]
    v_pk_fma_f32 v[98:99], v[98:99], v[112:113], v[98:99]
    v_pk_fma_f32 v[74:75], v[96:97], v[114:115], v[96:97]
    ds_read_b64_tr_b16 v[184:185], v21 offset:128
    ds_read_b64_tr_b16 v[186:187], v22 offset:128
    v_pk_fma_f32 v[96:97], v[146:147], v[98:99], v[74:75]
    v_pk_fma_f32 v[98:99], v[98:99], v[114:115], v[98:99]
    v_pk_fma_f32 v[74:75], v[96:97], v[116:117], v[96:97]
    v_pk_fma_f32 v[96:97], v[148:149], v[98:99], v[74:75]
    v_pk_fma_f32 v[98:99], v[98:99], v[116:117], v[98:99]
    v_pk_fma_f32 v[74:75], v[96:97], v[118:119], v[96:97]
    v_pk_fma_f32 v[96:97], v[150:151], v[98:99], v[74:75]
    v_pk_fma_f32 v[98:99], v[98:99], v[118:119], v[98:99]
    v_pk_fma_f32 v[74:75], v[96:97], v[120:121], v[96:97]
    v_pk_fma_f32 v[80:81], v[152:153], v[98:99], v[74:75]
    v_pk_fma_f32 v[82:83], v[98:99], v[120:121], v[98:99]
    v_pk_fma_f32 v[98:99], v[122:123], s[16:17], s[16:17]
    v_pk_mul_f32 v[96:97], v[154:155], s[16:17]
    v_mfma_f32_32x32x16_bf16 v[140:155], v[156:159], v[240:243], 0
    v_exp_f32 v108, v124
    v_exp_f32 v109, v125
    v_exp_f32 v110, v126
    v_mfma_f32_32x32x16_bf16 v[140:155], v[160:163], v[244:247], v[140:155]
    v_exp_f32 v111, v127
    v_exp_f32 v112, v128
    v_exp_f32 v113, v129
    v_mfma_f32_32x32x16_bf16 v[140:155], v[164:167], v[248:251], v[140:155]
    v_exp_f32 v114, v130
    v_exp_f32 v115, v131
    v_exp_f32 v116, v132
    v_mfma_f32_32x32x16_bf16 v[140:155], v[168:171], v[252:255], v[140:155]
    v_exp_f32 v117, v133
    v_exp_f32 v118, v134
    v_exp_f32 v119, v135
    v_mfma_f32_32x32x16_bf16 v[140:155], v[172:175], v[188:191], v[140:155]
    v_exp_f32 v120, v136
    v_exp_f32 v121, v137
    v_exp_f32 v122, v138
    v_exp_f32 v123, v139
    s_mov_b64 exec, s[12:13]
    ds_read_b128 v[172:175], v11
    s_mov_b64 exec, s[14:15]
    ds_read2_b64 v[172:175], v6 offset0:0 offset1:0
    s_mov_b64 exec, -1
    s_cmp_ge_u32 s4, s92
    v_pk_fma_f32 v[74:75], v[100:101], v[108:109], v[100:101]
    v_pk_fma_f32 v[100:101], v[124:125], v[102:103], v[74:75]
    ds_read_b64_tr_b16 v[188:189], v21 offset:192
    ds_read_b64_tr_b16 v[190:191], v22 offset:192
    v_pk_fma_f32 v[102:103], v[102:103], v[108:109], v[102:103]
    v_pk_fma_f32 v[74:75], v[100:101], v[110:111], v[100:101]
    s_waitcnt vmcnt(0)
    s_cbranch_scc1 NOLD7_0
    buffer_load_dwordx4 v[156:159], v13, s[28:31], 0 offen offset:0
    buffer_load_dwordx4 v[160:163], v13, s[28:31], 0 offen offset:16
    buffer_load_dwordx4 v[164:167], v13, s[28:31], 0 offen offset:32
    buffer_load_dwordx4 v[168:171], v13, s[28:31], 0 offen offset:48
NOLD7_0:
    v_pk_fma_f32 v[100:101], v[126:127], v[102:103], v[74:75]
    v_pk_fma_f32 v[102:103], v[102:103], v[110:111], v[102:103]
    v_pk_fma_f32 v[74:75], v[100:101], v[112:113], v[100:101]
    v_pk_fma_f32 v[100:101], v[128:129], v[102:103], v[74:75]
    v_pk_fma_f32 v[102:103], v[102:103], v[112:113], v[102:103]
    v_pk_fma_f32 v[74:75], v[100:101], v[114:115], v[100:101]
    v_pk_fma_f32 v[100:101], v[130:131], v[102:103], v[74:75]
    v_pk_fma_f32 v[102:103], v[102:103], v[114:115], v[102:103]
    v_pk_fma_f32 v[74:75], v[100:101], v[116:117], v[100:101]
    v_pk_fma_f32 v[100:101], v[132:133], v[102:103], v[74:75]
    v_pk_fma_f32 v[102:103], v[102:103], v[116:117], v[102:103]
    v_pk_fma_f32 v[74:75], v[100:101], v[118:119], v[100:101]
    v_pk_fma_f32 v[100:101], v[134:135], v[102:103], v[74:75]
    v_pk_fma_f32 v[102:103], v[102:103], v[118:119], v[102:103]
    v_pk_fma_f32 v[74:75], v[100:101], v[120:121], v[100:101]
    v_pk_fma_f32 v[84:85], v[136:137], v[102:103], v[74:75]
    v_pk_fma_f32 v[86:87], v[102:103], v[120:121], v[102:103]
    v_pk_fma_f32 v[102:103], v[122:123], s[16:17], s[16:17]
    v_pk_mul_f32 v[100:101], v[138:139], s[16:17]
    s_waitcnt lgkmcnt(0)
    s_cmp_ge_u32 s4, s88
    s_cbranch_scc1 LAST7_0
    v_mfma_f32_32x32x16_bf16 v[124:139], v[34:37], v[192:195], 0
    v_exp_f32 v108, v140
    v_exp_f32 v109, v141
    v_exp_f32 v110, v142
    v_mfma_f32_32x32x16_bf16 v[124:139], v[38:41], v[196:199], v[124:139]
    v_exp_f32 v111, v143
    v_exp_f32 v112, v144
    v_exp_f32 v113, v145
    v_mfma_f32_32x32x16_bf16 v[124:139], v[42:45], v[200:203], v[124:139]
    v_exp_f32 v114, v146
    v_exp_f32 v115, v147
    v_exp_f32 v116, v148
    v_mfma_f32_32x32x16_bf16 v[124:139], v[46:49], v[204:207], v[124:139]
    v_exp_f32 v117, v149
    v_exp_f32 v118, v150
    v_exp_f32 v119, v151
    v_mfma_f32_32x32x16_bf16 v[124:139], v[172:175], v[176:179], v[124:139]
    v_exp_f32 v120, v152
    v_exp_f32 v121, v153
    v_exp_f32 v122, v154
    v_exp_f32 v123, v155
    v_lshrrev_b32 v11, 16, v12
LASTJ7_0:
    v_pk_fma_f32 v[74:75], v[104:105], v[108:109], v[104:105]
    v_pk_fma_f32 v[104:105], v[140:141], v[106:107], v[74:75]
    v_pk_fma_f32 v[106:107], v[106:107], v[108:109], v[106:107]
    v_pk_fma_f32 v[74:75], v[104:105], v[110:111], v[104:105]
    v_pk_fma_f32 v[104:105], v[142:143], v[106:107], v[74:75]
    v_pk_fma_f32 v[106:107], v[106:107], v[110:111], v[106:107]
    v_pk_fma_f32 v[74:75], v[104:105], v[112:113], v[104:105]
    v_pk_fma_f32 v[104:105], v[144:145], v[106:107], v[74:75]
    v_pk_fma_f32 v[106:107], v[106:107], v[112:113], v[106:107]
    v_pk_fma_f32 v[74:75], v[104:105], v[114:115], v[104:105]
    v_pk_fma_f32 v[104:105], v[146:147], v[106:107], v[74:75]
    v_pk_fma_f32 v[106:107], v[106:107], v[114:115], v[106:107]
    v_pk_fma_f32 v[74:75], v[104:105], v[116:117], v[104:105]
    v_pk_fma_f32 v[104:105], v[148:149], v[106:107], v[74:75]
    v_pk_fma_f32 v[106:107], v[106:107], v[116:117], v[106:107]
    v_pk_fma_f32 v[74:75], v[104:105], v[118:119], v[104:105]
    v_pk_fma_f32 v[104:105], v[150:151], v[106:107], v[74:75]
    v_pk_fma_f32 v[106:107], v[106:107], v[118:119], v[106:107]
    v_pk_fma_f32 v[74:75], v[104:105], v[120:121], v[104:105]
    v_pk_fma_f32 v[88:89], v[152:153], v[106:107], v[74:75]
    v_pk_fma_f32 v[90:91], v[106:107], v[120:121], v[106:107]
    v_pk_fma_f32 v[106:107], v[122:123], s[16:17], s[16:17]
    v_pk_mul_f32 v[104:105], v[154:155], s[16:17]
    s_branch M_FLUSH0
    .p2align 6
M_V8_0:
    v_mfma_f32_32x32x16_bf16 v[140:155], v[156:159], v[208:211], 0
    v_exp_f32 v108, v124
    v_exp_f32 v109, v125
    v_exp_f32 v110, v126
    v_mfma_f32_32x32x16_bf16 v[140:155], v[160:163], v[212:215], v[140:155]
    v_exp_f32 v111, v127
    v_exp_f32 v112, v128
    v_exp_f32 v113, v129
    v_mfma_f32_32x32x16_bf16 v[140:155], v[164:167], v[216:219], v[140:155]
    v_exp_f32 v114, v130
    v_exp_f32 v115, v131
    v_exp_f32 v116, v132
    v_mfma_f32_32x32x16_bf16 v[140:155], v[168:171], v[220:223], v[140:155]
    v_exp_f32 v117, v133
    v_exp_f32 v118, v134
    v_exp_f32 v119, v135
    v_mfma_f32_32x32x16_bf16 v[140:155], v[172:175], v[180:183], v[140:155]
    v_exp_f32 v120, v136
    v_exp_f32 v121, v137
    v_exp_f32 v122, v138
    v_exp_f32 v123, v139
    v_pk_fma_f32 v[74:75], v[92:93], v[108:109], v[92:93]
    v_pk_fma_f32 v[92:93], v[124:125], v[94:95], v[74:75]
    ds_read_b32 v12, v8 offset:3328
    v_pk_fma_f32 v[94:95], v[94:95], v[108:109], v[94:95]
    v_pk_fma_f32 v[74:75], v[92:93], v[110:111], v[92:93]
    v_pk_fma_f32 v[92:93], v[126:127], v[94:95], v[74:75]
    v_pk_fma_f32 v[94:95], v[94:95], v[110:111], v[94:95]
    s_add_u32 s18, s6, 2
    s_and_b32 s18, s18, -2
    s_lshl_b32 s18, s18, 4
    s_add_u32 s19, s6, 1
    s_or_b32 s19, s19, 1
    s_lshl_b32 s19, s19, 4
    v_add_u32 v28, s18, v23
    v_add_u32 v29, s19, v23
    ds_read_b32 v28, v28
    ds_read_b32 v29, v29
    v_pk_fma_f32 v[74:75], v[92:93], v[112:113], v[92:93]
    v_pk_fma_f32 v[92:93], v[128:129], v[94:95], v[74:75]
    v_pk_fma_f32 v[94:95], v[94:95], v[112:113], v[94:95]
    v_pk_fma_f32 v[74:75], v[92:93], v[114:115], v[92:93]
    s_lshl_b32 s20, s6, 4
    v_add_u32 v26, s20, v24
    ds_read_b64 v[26:27], v26
    v_pk_fma_f32 v[92:93], v[130:131], v[94:95], v[74:75]
    v_pk_fma_f32 v[94:95], v[94:95], v[114:115], v[94:95]
    v_pk_fma_f32 v[74:75], v[92:93], v[116:117], v[92:93]
    v_pk_fma_f32 v[92:93], v[132:133], v[94:95], v[74:75]
    v_pk_fma_f32 v[94:95], v[94:95], v[116:117], v[94:95]
    v_pk_fma_f32 v[74:75], v[92:93], v[118:119], v[92:93]
    v_pk_fma_f32 v[92:93], v[134:135], v[94:95], v[74:75]
    v_pk_fma_f32 v[94:95], v[94:95], v[118:119], v[94:95]
    v_pk_fma_f32 v[74:75], v[92:93], v[120:121], v[92:93]
    v_pk_fma_f32 v[92:93], v[136:137], v[94:95], v[74:75]
    v_pk_fma_f32 v[94:95], v[94:95], v[120:121], v[94:95]
    v_pk_fma_f32 v[74:75], v[92:93], v[122:123], v[92:93]
    v_pk_fma_f32 v[76:77], v[138:139], v[94:95], v[74:75]
    v_pk_fma_f32 v[78:79], v[94:95], v[122:123], v[94:95]
    v_mov_b64 v[92:93], 0
    v_mov_b64 v[94:95], s[16:17]
    s_waitcnt lgkmcnt(0)
    v_mfma_f32_32x32x16_bf16 v[124:139], v[156:159], v[224:227], 0
    v_exp_f32 v108, v140
    v_exp_f32 v109, v141
    v_exp_f32 v110, v142
    v_mfma_f32_32x32x16_bf16 v[124:139], v[160:163], v[228:231], v[124:139]
    v_exp_f32 v111, v143
    v_exp_f32 v112, v144
    v_exp_f32 v113, v145
    v_mfma_f32_32x32x16_bf16 v[124:139], v[164:167], v[232:235], v[124:139]
    v_exp_f32 v114, v146
    v_exp_f32 v115, v147
    v_exp_f32 v116, v148
    v_mfma_f32_32x32x16_bf16 v[124:139], v[168:171], v[236:239], v[124:139]
    v_exp_f32 v117, v149
    v_exp_f32 v118, v150
    v_exp_f32 v119, v151
    v_mfma_f32_32x32x16_bf16 v[124:139], v[172:175], v[184:187], v[124:139]
    v_exp_f32 v120, v152
    v_exp_f32 v121, v153
    v_exp_f32 v122, v154
    v_exp_f32 v123, v155
    v_mad_u32_u16 v13, v12, s11, v9
    v_pk_fma_f32 v[74:75], v[96:97], v[108:109], v[96:97]
    v_pk_fma_f32 v[96:97], v[140:141], v[98:99], v[74:75]
    s_mov_b64 exec, s[12:13]
    v_add_u32 v21, v28, v20
    v_add_u32 v22, v29, v20
    s_mov_b64 exec, -1
    v_pk_fma_f32 v[98:99], v[98:99], v[108:109], v[98:99]
    v_pk_fma_f32 v[74:75], v[96:97], v[110:111], v[96:97]
    ds_read_b64_tr_b16 v[176:177], v21 offset:0
    ds_read_b64_tr_b16 v[178:179], v22 offset:0
    v_pk_fma_f32 v[96:97], v[142:143], v[98:99], v[74:75]
    v_pk_fma_f32 v[98:99], v[98:99], v[110:111], v[98:99]
    v_pk_fma_f32 v[74:75], v[96:97], v[112:113], v[96:97]
    ds_read_b64_tr_b16 v[180:181], v21 offset:64
    ds_read_b64_tr_b16 v[182:183], v22 offset:64
    v_pk_fma_f32 v[96:97], v[144:145], v[98:99], v[74:75]
    v_pk_fma_f32 v[98:99], v[98:99], v[112:113], v[98:99]
    v_pk_fma_f32 v[74:75], v[96:97], v[114:115], v[96:97]
    ds_read_b64_tr_b16 v[184:185], v21 offset:128
    ds_read_b64_tr_b16 v[186:187], v22 offset:128
    v_pk_fma_f32 v[96:97], v[146:147], v[98:99], v[74:75]
    v_pk_fma_f32 v[98:99], v[98:99], v[114:115], v[98:99]
    v_pk_fma_f32 v[74:75], v[96:97], v[116:117], v[96:97]
    v_pk_fma_f32 v[96:97], v[148:149], v[98:99], v[74:75]
    v_pk_fma_f32 v[98:99], v[98:99], v[116:117], v[98:99]
    v_pk_fma_f32 v[74:75], v[96:97], v[118:119], v[96:97]
    v_pk_fma_f32 v[96:97], v[150:151], v[98:99], v[74:75]
    v_pk_fma_f32 v[98:99], v[98:99], v[118:119], v[98:99]
    v_pk_fma_f32 v[74:75], v[96:97], v[120:121], v[96:97]
    v_pk_fma_f32 v[96:97], v[152:153], v[98:99], v[74:75]
    v_pk_fma_f32 v[98:99], v[98:99], v[120:121], v[98:99]
    v_pk_fma_f32 v[74:75], v[96:97], v[122:123], v[96:97]
    v_pk_fma_f32 v[80:81], v[154:155], v[98:99], v[74:75]
    v_pk_fma_f32 v[82:83], v[98:99], v[122:123], v[98:99]
    v_mov_b64 v[96:97], 0
    v_mov_b64 v[98:99], s[16:17]
    v_mfma_f32_32x32x16_bf16 v[140:155], v[156:159], v[240:243], 0
    v_exp_f32 v108, v124
    v_exp_f32 v109, v125
    v_exp_f32 v110, v126
    v_mfma_f32_32x32x16_bf16 v[140:155], v[160:163], v[244:247], v[140:155]
    v_exp_f32 v111, v127
    v_exp_f32 v112, v128
    v_exp_f32 v113, v129
    v_mfma_f32_32x32x16_bf16 v[140:155], v[164:167], v[248:251], v[140:155]
    v_exp_f32 v114, v130
    v_exp_f32 v115, v131
    v_exp_f32 v116, v132
    v_mfma_f32_32x32x16_bf16 v[140:155], v[168:171], v[252:255], v[140:155]
    v_exp_f32 v117, v133
    v_exp_f32 v118, v134
    v_exp_f32 v119, v135
    v_mfma_f32_32x32x16_bf16 v[140:155], v[172:175], v[188:191], v[140:155]
    v_exp_f32 v120, v136
    v_exp_f32 v121, v137
    v_exp_f32 v122, v138
    v_exp_f32 v123, v139
    s_mov_b64 exec, s[12:13]
    ds_read_b128 v[172:175], v11
    s_mov_b64 exec, s[14:15]
    ds_read2_b64 v[172:175], v6 offset0:0 offset1:0
    s_mov_b64 exec, -1
    s_cmp_ge_u32 s4, s92
    v_pk_fma_f32 v[74:75], v[100:101], v[108:109], v[100:101]
    v_pk_fma_f32 v[100:101], v[124:125], v[102:103], v[74:75]
    ds_read_b64_tr_b16 v[188:189], v21 offset:192
    ds_read_b64_tr_b16 v[190:191], v22 offset:192
    v_pk_fma_f32 v[102:103], v[102:103], v[108:109], v[102:103]
    v_pk_fma_f32 v[74:75], v[100:101], v[110:111], v[100:101]
    s_waitcnt vmcnt(0)
    s_cbranch_scc1 NOLD8_0
    buffer_load_dwordx4 v[156:159], v13, s[28:31], 0 offen offset:0
    buffer_load_dwordx4 v[160:163], v13, s[28:31], 0 offen offset:16
    buffer_load_dwordx4 v[164:167], v13, s[28:31], 0 offen offset:32
    buffer_load_dwordx4 v[168:171], v13, s[28:31], 0 offen offset:48
NOLD8_0:
    v_pk_fma_f32 v[100:101], v[126:127], v[102:103], v[74:75]
    v_pk_fma_f32 v[102:103], v[102:103], v[110:111], v[102:103]
    v_pk_fma_f32 v[74:75], v[100:101], v[112:113], v[100:101]
    v_pk_fma_f32 v[100:101], v[128:129], v[102:103], v[74:75]
    v_pk_fma_f32 v[102:103], v[102:103], v[112:113], v[102:103]
    v_pk_fma_f32 v[74:75], v[100:101], v[114:115], v[100:101]
    v_pk_fma_f32 v[100:101], v[130:131], v[102:103], v[74:75]
    v_pk_fma_f32 v[102:103], v[102:103], v[114:115], v[102:103]
    v_pk_fma_f32 v[74:75], v[100:101], v[116:117], v[100:101]
    v_pk_fma_f32 v[100:101], v[132:133], v[102:103], v[74:75]
    v_pk_fma_f32 v[102:103], v[102:103], v[116:117], v[102:103]
    v_pk_fma_f32 v[74:75], v[100:101], v[118:119], v[100:101]
    v_pk_fma_f32 v[100:101], v[134:135], v[102:103], v[74:75]
    v_pk_fma_f32 v[102:103], v[102:103], v[118:119], v[102:103]
    v_pk_fma_f32 v[74:75], v[100:101], v[120:121], v[100:101]
    v_pk_fma_f32 v[100:101], v[136:137], v[102:103], v[74:75]
    v_pk_fma_f32 v[102:103], v[102:103], v[120:121], v[102:103]
    v_pk_fma_f32 v[74:75], v[100:101], v[122:123], v[100:101]
    v_pk_fma_f32 v[84:85], v[138:139], v[102:103], v[74:75]
    v_pk_fma_f32 v[86:87], v[102:103], v[122:123], v[102:103]
    v_mov_b64 v[100:101], 0
    v_mov_b64 v[102:103], s[16:17]
    s_waitcnt lgkmcnt(0)
    s_cmp_ge_u32 s4, s88
    s_cbranch_scc1 LAST8_0
    v_mfma_f32_32x32x16_bf16 v[124:139], v[34:37], v[192:195], 0
    v_exp_f32 v108, v140
    v_exp_f32 v109, v141
    v_exp_f32 v110, v142
    v_mfma_f32_32x32x16_bf16 v[124:139], v[38:41], v[196:199], v[124:139]
    v_exp_f32 v111, v143
    v_exp_f32 v112, v144
    v_exp_f32 v113, v145
    v_mfma_f32_32x32x16_bf16 v[124:139], v[42:45], v[200:203], v[124:139]
    v_exp_f32 v114, v146
    v_exp_f32 v115, v147
    v_exp_f32 v116, v148
    v_mfma_f32_32x32x16_bf16 v[124:139], v[46:49], v[204:207], v[124:139]
    v_exp_f32 v117, v149
    v_exp_f32 v118, v150
    v_exp_f32 v119, v151
    v_mfma_f32_32x32x16_bf16 v[124:139], v[172:175], v[176:179], v[124:139]
    v_exp_f32 v120, v152
    v_exp_f32 v121, v153
    v_exp_f32 v122, v154
    v_exp_f32 v123, v155
    v_lshrrev_b32 v11, 16, v12
LASTJ8_0:
    v_pk_fma_f32 v[74:75], v[104:105], v[108:109], v[104:105]
    v_pk_fma_f32 v[104:105], v[140:141], v[106:107], v[74:75]
    v_pk_fma_f32 v[106:107], v[106:107], v[108:109], v[106:107]
    v_pk_fma_f32 v[74:75], v[104:105], v[110:111], v[104:105]
    v_pk_fma_f32 v[104:105], v[142:143], v[106:107], v[74:75]
    v_pk_fma_f32 v[106:107], v[106:107], v[110:111], v[106:107]
    v_pk_fma_f32 v[74:75], v[104:105], v[112:113], v[104:105]
    v_pk_fma_f32 v[104:105], v[144:145], v[106:107], v[74:75]
    v_pk_fma_f32 v[106:107], v[106:107], v[112:113], v[106:107]
    v_pk_fma_f32 v[74:75], v[104:105], v[114:115], v[104:105]
    v_pk_fma_f32 v[104:105], v[146:147], v[106:107], v[74:75]
    v_pk_fma_f32 v[106:107], v[106:107], v[114:115], v[106:107]
    v_pk_fma_f32 v[74:75], v[104:105], v[116:117], v[104:105]
    v_pk_fma_f32 v[104:105], v[148:149], v[106:107], v[74:75]
    v_pk_fma_f32 v[106:107], v[106:107], v[116:117], v[106:107]
    v_pk_fma_f32 v[74:75], v[104:105], v[118:119], v[104:105]
    v_pk_fma_f32 v[104:105], v[150:151], v[106:107], v[74:75]
    v_pk_fma_f32 v[106:107], v[106:107], v[118:119], v[106:107]
    v_pk_fma_f32 v[74:75], v[104:105], v[120:121], v[104:105]
    v_pk_fma_f32 v[104:105], v[152:153], v[106:107], v[74:75]
    v_pk_fma_f32 v[106:107], v[106:107], v[120:121], v[106:107]
    v_pk_fma_f32 v[74:75], v[104:105], v[122:123], v[104:105]
    v_pk_fma_f32 v[88:89], v[154:155], v[106:107], v[74:75]
    v_pk_fma_f32 v[90:91], v[106:107], v[122:123], v[106:107]
    v_mov_b64 v[104:105], 0
    v_mov_b64 v[106:107], s[16:17]
    s_branch M_FLUSH0
    .p2align 6
M_V1_1:
    v_mfma_f32_32x32x16_bf16 v[140:155], v[34:37], v[208:211], 0
    v_exp_f32 v108, v124
    v_exp_f32 v109, v125
    v_exp_f32 v110, v126
    v_mfma_f32_32x32x16_bf16 v[140:155], v[38:41], v[212:215], v[140:155]
    v_exp_f32 v111, v127
    v_exp_f32 v112, v128
    v_exp_f32 v113, v129
    v_mfma_f32_32x32x16_bf16 v[140:155], v[42:45], v[216:219], v[140:155]
    v_exp_f32 v114, v130
    v_exp_f32 v115, v131
    v_exp_f32 v116, v132
    v_mfma_f32_32x32x16_bf16 v[140:155], v[46:49], v[220:223], v[140:155]
    v_exp_f32 v117, v133
    v_exp_f32 v118, v134
    v_exp_f32 v119, v135
    v_mfma_f32_32x32x16_bf16 v[140:155], v[172:175], v[180:183], v[140:155]
    v_exp_f32 v120, v136
    v_exp_f32 v121, v137
    v_exp_f32 v122, v138
    v_exp_f32 v123, v139
    v_pk_fma_f32 v[74:75], v[92:93], v[108:109], v[92:93]
    v_pk_fma_f32 v[76:77], v[124:125], v[94:95], v[74:75]
    ds_read_b32 v12, v8 offset:3456
    v_pk_fma_f32 v[78:79], v[94:95], v[108:109], v[94:95]
    v_pk_fma_f32 v[94:95], v[110:111], s[16:17], s[16:17]
    v_pk_mul_f32 v[92:93], v[126:127], s[16:17]
    v_pk_fma_f32 v[74:75], v[92:93], v[112:113], v[92:93]
    s_add_u32 s18, s6, 2
    s_and_b32 s18, s18, -2
    s_lshl_b32 s18, s18, 4
    s_add_u32 s19, s6, 1
    s_or_b32 s19, s19, 1
    s_lshl_b32 s19, s19, 4
    v_add_u32 v28, s18, v23
    v_add_u32 v29, s19, v23
    ds_read_b32 v28, v28
    ds_read_b32 v29, v29
    v_pk_fma_f32 v[92:93], v[128:129], v[94:95], v[74:75]
    v_pk_fma_f32 v[94:95], v[94:95], v[112:113], v[94:95]
    v_pk_fma_f32 v[74:75], v[92:93], v[114:115], v[92:93]
    v_pk_fma_f32 v[92:93], v[130:131], v[94:95], v[74:75]
    s_lshl_b32 s20, s6, 4
    v_add_u32 v26, s20, v24
    ds_read_b64 v[26:27], v26
    v_pk_fma_f32 v[94:95], v[94:95], v[114:115], v[94:95]
    v_pk_fma_f32 v[74:75], v[92:93], v[116:117], v[92:93]
    v_pk_fma_f32 v[92:93], v[132:133], v[94:95], v[74:75]
    v_pk_fma_f32 v[94:95], v[94:95], v[116:117], v[94:95]
    v_pk_fma_f32 v[74:75], v[92:93], v[118:119], v[92:93]
    v_pk_fma_f32 v[92:93], v[134:135], v[94:95], v[74:75]
    v_pk_fma_f32 v[94:95], v[94:95], v[118:119], v[94:95]
    v_pk_fma_f32 v[74:75], v[92:93], v[120:121], v[92:93]
    v_pk_fma_f32 v[92:93], v[136:137], v[94:95], v[74:75]
    v_pk_fma_f32 v[94:95], v[94:95], v[120:121], v[94:95]
    v_pk_fma_f32 v[74:75], v[92:93], v[122:123], v[92:93]
    v_pk_fma_f32 v[92:93], v[138:139], v[94:95], v[74:75]
    v_pk_fma_f32 v[94:95], v[94:95], v[122:123], v[94:95]
    s_waitcnt lgkmcnt(0)
    v_mfma_f32_32x32x16_bf16 v[124:139], v[34:37], v[224:227], 0
    v_exp_f32 v108, v140
    v_exp_f32 v109, v141
    v_exp_f32 v110, v142
    v_mfma_f32_32x32x16_bf16 v[124:139], v[38:41], v[228:231], v[124:139]
    v_exp_f32 v111, v143
    v_exp_f32 v112, v144
    v_exp_f32 v113, v145
    v_mfma_f32_32x32x16_bf16 v[124:139], v[42:45], v[232:235], v[124:139]
    v_exp_f32 v114, v146
    v_exp_f32 v115, v147
    v_exp_f32 v116, v148
    v_mfma_f32_32x32x16_bf16 v[124:139], v[46:49], v[236:239], v[124:139]
    v_exp_f32 v117, v149
    v_exp_f32 v118, v150
    v_exp_f32 v119, v151
    v_mfma_f32_32x32x16_bf16 v[124:139], v[172:175], v[184:187], v[124:139]
    v_exp_f32 v120, v152
    v_exp_f32 v121, v153
    v_exp_f32 v122, v154
    v_exp_f32 v123, v155
    v_mad_u32_u16 v13, v12, s11, v9
    v_pk_fma_f32 v[74:75], v[96:97], v[108:109], v[96:97]
    v_pk_fma_f32 v[80:81], v[140:141], v[98:99], v[74:75]
    s_mov_b64 exec, s[12:13]
    v_add_u32 v21, v28, v20
    v_add_u32 v22, v29, v20
    s_mov_b64 exec, -1
    v_pk_fma_f32 v[82:83], v[98:99], v[108:109], v[98:99]
    v_pk_fma_f32 v[98:99], v[110:111], s[16:17], s[16:17]
    ds_read_b64_tr_b16 v[176:177], v21 offset:0
    ds_read_b64_tr_b16 v[178:179], v22 offset:0
    v_pk_mul_f32 v[96:97], v[142:143], s[16:17]
    v_pk_fma_f32 v[74:75], v[96:97], v[112:113], v[96:97]
    v_pk_fma_f32 v[96:97], v[144:145], v[98:99], v[74:75]
    ds_read_b64_tr_b16 v[180:181], v21 offset:64
    ds_read_b64_tr_b16 v[182:183], v22 offset:64
    v_pk_fma_f32 v[98:99], v[98:99], v[112:113], v[98:99]
    v_pk_fma_f32 v[74:75], v[96:97], v[114:115], v[96:97]
    v_pk_fma_f32 v[96:97], v[146:147], v[98:99], v[74:75]
    ds_read_b64_tr_b16 v[184:185], v21 offset:128
    ds_read_b64_tr_b16 v[186:187], v22 offset:128
    v_pk_fma_f32 v[98:99], v[98:99], v[114:115], v[98:99]
    v_pk_fma_f32 v[74:75], v[96:97], v[116:117], v[96:97]
    v_pk_fma_f32 v[96:97], v[148:149], v[98:99], v[74:75]
    v_pk_fma_f32 v[98:99], v[98:99], v[116:117], v[98:99]
    v_pk_fma_f32 v[74:75], v[96:97], v[118:119], v[96:97]
    v_pk_fma_f32 v[96:97], v[150:151], v[98:99], v[74:75]
    v_pk_fma_f32 v[98:99], v[98:99], v[118:119], v[98:99]
    v_pk_fma_f32 v[74:75], v[96:97], v[120:121], v[96:97]
    v_pk_fma_f32 v[96:97], v[152:153], v[98:99], v[74:75]
    v_pk_fma_f32 v[98:99], v[98:99], v[120:121], v[98:99]
    v_pk_fma_f32 v[74:75], v[96:97], v[122:123], v[96:97]
    v_pk_fma_f32 v[96:97], v[154:155], v[98:99], v[74:75]
    v_pk_fma_f32 v[98:99], v[98:99], v[122:123], v[98:99]
    v_mfma_f32_32x32x16_bf16 v[140:155], v[34:37], v[240:243], 0
    v_exp_f32 v108, v124
    v_exp_f32 v109, v125
    v_exp_f32 v110, v126
    v_mfma_f32_32x32x16_bf16 v[140:155], v[38:41], v[244:247], v[140:155]
    v_exp_f32 v111, v127
    v_exp_f32 v112, v128
    v_exp_f32 v113, v129
    v_mfma_f32_32x32x16_bf16 v[140:155], v[42:45], v[248:251], v[140:155]
    v_exp_f32 v114, v130
    v_exp_f32 v115, v131
    v_exp_f32 v116, v132
    v_mfma_f32_32x32x16_bf16 v[140:155], v[46:49], v[252:255], v[140:155]
    v_exp_f32 v117, v133
    v_exp_f32 v118, v134
    v_exp_f32 v119, v135
    v_mfma_f32_32x32x16_bf16 v[140:155], v[172:175], v[188:191], v[140:155]
    v_exp_f32 v120, v136
    v_exp_f32 v121, v137
    v_exp_f32 v122, v138
    v_exp_f32 v123, v139
    v_add_u32 v8, 256, v8
    s_mov_b64 exec, s[12:13]
    ds_read_b128 v[172:175], v11
    s_mov_b64 exec, s[14:15]
    ds_read2_b64 v[172:175], v6 offset0:32 offset1:32
    s_mov_b64 exec, -1
    s_cmp_ge_u32 s4, s92
    v_pk_fma_f32 v[74:75], v[100:101], v[108:109], v[100:101]
    v_pk_fma_f32 v[84:85], v[124:125], v[102:103], v[74:75]
    ds_read_b64_tr_b16 v[188:189], v21 offset:192
    ds_read_b64_tr_b16 v[190:191], v22 offset:192
    v_pk_fma_f32 v[86:87], v[102:103], v[108:109], v[102:103]
    v_pk_fma_f32 v[102:103], v[110:111], s[16:17], s[16:17]
    s_waitcnt vmcnt(0)
    s_cbranch_scc1 NOLD1_1
    buffer_load_dwordx4 v[34:37], v13, s[28:31], 0 offen offset:0
    buffer_load_dwordx4 v[38:41], v13, s[28:31], 0 offen offset:16
    buffer_load_dwordx4 v[42:45], v13, s[28:31], 0 offen offset:32
    buffer_load_dwordx4 v[46:49], v13, s[28:31], 0 offen offset:48
NOLD1_1:
    v_pk_mul_f32 v[100:101], v[126:127], s[16:17]
    v_pk_fma_f32 v[74:75], v[100:101], v[112:113], v[100:101]
    v_pk_fma_f32 v[100:101], v[128:129], v[102:103], v[74:75]
    v_pk_fma_f32 v[102:103], v[102:103], v[112:113], v[102:103]
    v_pk_fma_f32 v[74:75], v[100:101], v[114:115], v[100:101]
    v_pk_fma_f32 v[100:101], v[130:131], v[102:103], v[74:75]
    v_pk_fma_f32 v[102:103], v[102:103], v[114:115], v[102:103]
    v_pk_fma_f32 v[74:75], v[100:101], v[116:117], v[100:101]
    v_pk_fma_f32 v[100:101], v[132:133], v[102:103], v[74:75]
    v_pk_fma_f32 v[102:103], v[102:103], v[116:117], v[102:103]
    v_pk_fma_f32 v[74:75], v[100:101], v[118:119], v[100:101]
    v_pk_fma_f32 v[100:101], v[134:135], v[102:103], v[74:75]
    v_pk_fma_f32 v[102:103], v[102:103], v[118:119], v[102:103]
    v_pk_fma_f32 v[74:75], v[100:101], v[120:121], v[100:101]
    v_pk_fma_f32 v[100:101], v[136:137], v[102:103], v[74:75]
    v_pk_fma_f32 v[102:103], v[102:103], v[120:121], v[102:103]
    v_pk_fma_f32 v[74:75], v[100:101], v[122:123], v[100:101]
    v_pk_fma_f32 v[100:101], v[138:139], v[102:103], v[74:75]
    v_pk_fma_f32 v[102:103], v[102:103], v[122:123], v[102:103]
    s_waitcnt lgkmcnt(0)
    s_cmp_ge_u32 s4, s88
    s_cbranch_scc1 LAST1_1
    v_mfma_f32_32x32x16_bf16 v[124:139], v[156:159], v[192:195], 0
    v_exp_f32 v108, v140
    v_exp_f32 v109, v141
    v_exp_f32 v110, v142
    v_mfma_f32_32x32x16_bf16 v[124:139], v[160:163], v[196:199], v[124:139]
    v_exp_f32 v111, v143
    v_exp_f32 v112, v144
    v_exp_f32 v113, v145
    v_mfma_f32_32x32x16_bf16 v[124:139], v[164:167], v[200:203], v[124:139]
    v_exp_f32 v114, v146
    v_exp_f32 v115, v147
    v_exp_f32 v116, v148
    v_mfma_f32_32x32x16_bf16 v[124:139], v[168:171], v[204:207], v[124:139]
    v_exp_f32 v117, v149
    v_exp_f32 v118, v150
    v_exp_f32 v119, v151
    v_mfma_f32_32x32x16_bf16 v[124:139], v[172:175], v[176:179], v[124:139]
    v_exp_f32 v120, v152
    v_exp_f32 v121, v153
    v_exp_f32 v122, v154
    v_exp_f32 v123, v155
    v_lshrrev_b32 v11, 16, v12
    v_add_u32 v6, 512, v6
LASTJ1_1:
    v_pk_fma_f32 v[74:75], v[104:105], v[108:109], v[104:105]
    v_pk_fma_f32 v[88:89], v[140:141], v[106:107], v[74:75]
    v_pk_fma_f32 v[90:91], v[106:107], v[108:109], v[106:107]
    v_pk_fma_f32 v[106:107], v[110:111], s[16:17], s[16:17]
    v_pk_mul_f32 v[104:105], v[142:143], s[16:17]
    v_pk_fma_f32 v[74:75], v[104:105], v[112:113], v[104:105]
    v_pk_fma_f32 v[104:105], v[144:145], v[106:107], v[74:75]
    v_pk_fma_f32 v[106:107], v[106:107], v[112:113], v[106:107]
    v_pk_fma_f32 v[74:75], v[104:105], v[114:115], v[104:105]
    v_pk_fma_f32 v[104:105], v[146:147], v[106:107], v[74:75]
    v_pk_fma_f32 v[106:107], v[106:107], v[114:115], v[106:107]
    v_pk_fma_f32 v[74:75], v[104:105], v[116:117], v[104:105]
    v_pk_fma_f32 v[104:105], v[148:149], v[106:107], v[74:75]
    v_pk_fma_f32 v[106:107], v[106:107], v[116:117], v[106:107]
    v_pk_fma_f32 v[74:75], v[104:105], v[118:119], v[104:105]
    v_pk_fma_f32 v[104:105], v[150:151], v[106:107], v[74:75]
    v_pk_fma_f32 v[106:107], v[106:107], v[118:119], v[106:107]
    v_pk_fma_f32 v[74:75], v[104:105], v[120:121], v[104:105]
    v_pk_fma_f32 v[104:105], v[152:153], v[106:107], v[74:75]
    v_pk_fma_f32 v[106:107], v[106:107], v[120:121], v[106:107]
    v_pk_fma_f32 v[74:75], v[104:105], v[122:123], v[104:105]
    v_pk_fma_f32 v[104:105], v[154:155], v[106:107], v[74:75]
    v_pk_fma_f32 v[106:107], v[106:107], v[122:123], v[106:107]
    s_branch M_FLUSH1
    .p2align 6
M_V2_1:
    v_mfma_f32_32x32x16_bf16 v[140:155], v[34:37], v[208:211], 0
    v_exp_f32 v108, v124
    v_exp_f32 v109, v125
    v_exp_f32 v110, v126
    v_mfma_f32_32x32x16_bf16 v[140:155], v[38:41], v[212:215], v[140:155]
    v_exp_f32 v111, v127
    v_exp_f32 v112, v128
    v_exp_f32 v113, v129
    v_mfma_f32_32x32x16_bf16 v[140:155], v[42:45], v[216:219], v[140:155]
    v_exp_f32 v114, v130
    v_exp_f32 v115, v131
    v_exp_f32 v116, v132
    v_mfma_f32_32x32x16_bf16 v[140:155], v[46:49], v[220:223], v[140:155]
    v_exp_f32 v117, v133
    v_exp_f32 v118, v134
    v_exp_f32 v119, v135
    v_mfma_f32_32x32x16_bf16 v[140:155], v[172:175], v[180:183], v[140:155]
    v_exp_f32 v120, v136
    v_exp_f32 v121, v137
    v_exp_f32 v122, v138
    v_exp_f32 v123, v139
    v_pk_fma_f32 v[74:75], v[92:93], v[108:109], v[92:93]
    v_pk_fma_f32 v[92:93], v[124:125], v[94:95], v[74:75]
    ds_read_b32 v12, v8 offset:3456
    v_pk_fma_f32 v[94:95], v[94:95], v[108:109], v[94:95]
    v_pk_fma_f32 v[74:75], v[92:93], v[110:111], v[92:93]
    v_pk_fma_f32 v[76:77], v[126:127], v[94:95], v[74:75]
    v_pk_fma_f32 v[78:79], v[94:95], v[110:111], v[94:95]
    s_add_u32 s18, s6, 2
    s_and_b32 s18, s18, -2
    s_lshl_b32 s18, s18, 4
    s_add_u32 s19, s6, 1
    s_or_b32 s19, s19, 1
    s_lshl_b32 s19, s19, 4
    v_add_u32 v28, s18, v23
    v_add_u32 v29, s19, v23
    ds_read_b32 v28, v28
    ds_read_b32 v29, v29
    v_pk_fma_f32 v[94:95], v[112:113], s[16:17], s[16:17]
    v_pk_mul_f32 v[92:93], v[128:129], s[16:17]
    v_pk_fma_f32 v[74:75], v[92:93], v[114:115], v[92:93]
    v_pk_fma_f32 v[92:93], v[130:131], v[94:95], v[74:75]
    s_lshl_b32 s20, s6, 4
    v_add_u32 v26, s20, v24
    ds_read_b64 v[26:27], v26
    v_pk_fma_f32 v[94:95], v[94:95], v[114:115], v[94:95]
    v_pk_fma_f32 v[74:75], v[92:93], v[116:117], v[92:93]
    v_pk_fma_f32 v[92:93], v[132:133], v[94:95], v[74:75]
    v_pk_fma_f32 v[94:95], v[94:95], v[116:117], v[94:95]
    v_pk_fma_f32 v[74:75], v[92:93], v[118:119], v[92:93]
    v_pk_fma_f32 v[92:93], v[134:135], v[94:95], v[74:75]
    v_pk_fma_f32 v[94:95], v[94:95], v[118:119], v[94:95]
    v_pk_fma_f32 v[74:75], v[92:93], v[120:121], v[92:93]
    v_pk_fma_f32 v[92:93], v[136:137], v[94:95], v[74:75]
    v_pk_fma_f32 v[94:95], v[94:95], v[120:121], v[94:95]
    v_pk_fma_f32 v[74:75], v[92:93], v[122:123], v[92:93]
    v_pk_fma_f32 v[92:93], v[138:139], v[94:95], v[74:75]
    v_pk_fma_f32 v[94:95], v[94:95], v[122:123], v[94:95]
    s_waitcnt lgkmcnt(0)
    v_mfma_f32_32x32x16_bf16 v[124:139], v[34:37], v[224:227], 0
    v_exp_f32 v108, v140
    v_exp_f32 v109, v141
    v_exp_f32 v110, v142
    v_mfma_f32_32x32x16_bf16 v[124:139], v[38:41], v[228:231], v[124:139]
    v_exp_f32 v111, v143
    v_exp_f32 v112, v144
    v_exp_f32 v113, v145
    v_mfma_f32_32x32x16_bf16 v[124:139], v[42:45], v[232:235], v[124:139]
    v_exp_f32 v114, v146
    v_exp_f32 v115, v147
    v_exp_f32 v116, v148
    v_mfma_f32_32x32x16_bf16 v[124:139], v[46:49], v[236:239], v[124:139]
    v_exp_f32 v117, v149
    v_exp_f32 v118, v150
    v_exp_f32 v119, v151
    v_mfma_f32_32x32x16_bf16 v[124:139], v[172:175], v[184:187], v[124:139]
    v_exp_f32 v120, v152
    v_exp_f32 v121, v153
    v_exp_f32 v122, v154
    v_exp_f32 v123, v155
    v_mad_u32_u16 v13, v12, s11, v9
    v_pk_fma_f32 v[74:75], v[96:97], v[108:109], v[96:97]
    v_pk_fma_f32 v[96:97], v[140:141], v[98:99], v[74:75]
    s_mov_b64 exec, s[12:13]
    v_add_u32 v21, v28, v20
    v_add_u32 v22, v29, v20
    s_mov_b64 exec, -1
    v_pk_fma_f32 v[98:99], v[98:99], v[108:109], v[98:99]
    v_pk_fma_f32 v[74:75], v[96:97], v[110:111], v[96:97]
    ds_read_b64_tr_b16 v[176:177], v21 offset:0
    ds_read_b64_tr_b16 v[178:179], v22 offset:0
    v_pk_fma_f32 v[80:81], v[142:143], v[98:99], v[74:75]
    v_pk_fma_f32 v[82:83], v[98:99], v[110:111], v[98:99]
    v_pk_fma_f32 v[98:99], v[112:113], s[16:17], s[16:17]
    ds_read_b64_tr_b16 v[180:181], v21 offset:64
    ds_read_b64_tr_b16 v[182:183], v22 offset:64
    v_pk_mul_f32 v[96:97], v[144:145], s[16:17]
    v_pk_fma_f32 v[74:75], v[96:97], v[114:115], v[96:97]
    v_pk_fma_f32 v[96:97], v[146:147], v[98:99], v[74:75]
    ds_read_b64_tr_b16 v[184:185], v21 offset:128
    ds_read_b64_tr_b16 v[186:187], v22 offset:128
    v_pk_fma_f32 v[98:99], v[98:99], v[114:115], v[98:99]
    v_pk_fma_f32 v[74:75], v[96:97], v[116:117], v[96:97]
    v_pk_fma_f32 v[96:97], v[148:149], v[98:99], v[74:75]
    v_pk_fma_f32 v[98:99], v[98:99], v[116:117], v[98:99]
    v_pk_fma_f32 v[74:75], v[96:97], v[118:119], v[96:97]
    v_pk_fma_f32 v[96:97], v[150:151], v[98:99], v[74:75]
    v_pk_fma_f32 v[98:99], v[98:99], v[118:119], v[98:99]
    v_pk_fma_f32 v[74:75], v[96:97], v[120:121], v[96:97]
    v_pk_fma_f32 v[96:97], v[152:153], v[98:99], v[74:75]
    v_pk_fma_f32 v[98:99], v[98:99], v[120:121], v[98:99]
    v_pk_fma_f32 v[74:75], v[96:97], v[122:123], v[96:97]
    v_pk_fma_f32 v[96:97], v[154:155], v[98:99], v[74:75]
    v_pk_fma_f32 v[98:99], v[98:99], v[122:123], v[98:99]
    v_mfma_f32_32x32x16_bf16 v[140:155], v[34:37], v[240:243], 0
    v_exp_f32 v108, v124
    v_exp_f32 v109, v125
    v_exp_f32 v110, v126
    v_mfma_f32_32x32x16_bf16 v[140:155], v[38:41], v[244:247], v[140:155]
    v_exp_f32 v111, v127
    v_exp_f32 v112, v128
    v_exp_f32 v113, v129
    v_mfma_f32_32x32x16_bf16 v[140:155], v[42:45], v[248:251], v[140:155]
    v_exp_f32 v114, v130
    v_exp_f32 v115, v131
    v_exp_f32 v116, v132
    v_mfma_f32_32x32x16_bf16 v[140:155], v[46:49], v[252:255], v[140:155]
    v_exp_f32 v117, v133
    v_exp_f32 v118, v134
    v_exp_f32 v119, v135
    v_mfma_f32_32x32x16_bf16 v[140:155], v[172:175], v[188:191], v[140:155]
    v_exp_f32 v120, v136
    v_exp_f32 v121, v137
    v_exp_f32 v122, v138
    v_exp_f32 v123, v139
    v_add_u32 v8, 256, v8
    s_mov_b64 exec, s[12:13]
    ds_read_b128 v[172:175], v11
    s_mov_b64 exec, s[14:15]
    ds_read2_b64 v[172:175], v6 offset0:32 offset1:32
    s_mov_b64 exec, -1
    s_cmp_ge_u32 s4, s92
    v_pk_fma_f32 v[74:75], v[100:101], v[108:109], v[100:101]
    v_pk_fma_f32 v[100:101], v[124:125], v[102:103], v[74:75]
    ds_read_b64_tr_b16 v[188:189], v21 offset:192
    ds_read_b64_tr_b16 v[190:191], v22 offset:192
    v_pk_fma_f32 v[102:103], v[102:103], v[108:109], v[102:103]
    v_pk_fma_f32 v[74:75], v[100:101], v[110:111], v[100:101]
    s_waitcnt vmcnt(0)
    s_cbranch_scc1 NOLD2_1
    buffer_load_dwordx4 v[34:37], v13, s[28:31], 0 offen offset:0
    buffer_load_dwordx4 v[38:41], v13, s[28:31], 0 offen offset:16
    buffer_load_dwordx4 v[42:45], v13, s[28:31], 0 offen offset:32
    buffer_load_dwordx4 v[46:49], v13, s[28:31], 0 offen offset:48
NOLD2_1:
    v_pk_fma_f32 v[84:85], v[126:127], v[102:103], v[74:75]
    v_pk_fma_f32 v[86:87], v[102:103], v[110:111], v[102:103]
    v_pk_fma_f32 v[102:103], v[112:113], s[16:17], s[16:17]
    v_pk_mul_f32 v[100:101], v[128:129], s[16:17]
    v_pk_fma_f32 v[74:75], v[100:101], v[114:115], v[100:101]
    v_pk_fma_f32 v[100:101], v[130:131], v[102:103], v[74:75]
    v_pk_fma_f32 v[102:103], v[102:103], v[114:115], v[102:103]
    v_pk_fma_f32 v[74:75], v[100:101], v[116:117], v[100:101]
    v_pk_fma_f32 v[100:101], v[132:133], v[102:103], v[74:75]
    v_pk_fma_f32 v[102:103], v[102:103], v[116:117], v[102:103]
    v_pk_fma_f32 v[74:75], v[100:101], v[118:119], v[100:101]
    v_pk_fma_f32 v[100:101], v[134:135], v[102:103], v[74:75]
    v_pk_fma_f32 v[102:103], v[102:103], v[118:119], v[102:103]
    v_pk_fma_f32 v[74:75], v[100:101], v[120:121], v[100:101]
    v_pk_fma_f32 v[100:101], v[136:137], v[102:103], v[74:75]
    v_pk_fma_f32 v[102:103], v[102:103], v[120:121], v[102:103]
    v_pk_fma_f32 v[74:75], v[100:101], v[122:123], v[100:101]
    v_pk_fma_f32 v[100:101], v[138:139], v[102:103], v[74:75]
    v_pk_fma_f32 v[102:103], v[102:103], v[122:123], v[102:103]
    s_waitcnt lgkmcnt(0)
    s_cmp_ge_u32 s4, s88
    s_cbranch_scc1 LAST2_1
    v_mfma_f32_32x32x16_bf16 v[124:139], v[156:159], v[192:195], 0
    v_exp_f32 v108, v140
    v_exp_f32 v109, v141
    v_exp_f32 v110, v142
    v_mfma_f32_32x32x16_bf16 v[124:139], v[160:163], v[196:199], v[124:139]
    v_exp_f32 v111, v143
    v_exp_f32 v112, v144
    v_exp_f32 v113, v145
    v_mfma_f32_32x32x16_bf16 v[124:139], v[164:167], v[200:203], v[124:139]
    v_exp_f32 v114, v146
    v_exp_f32 v115, v147
    v_exp_f32 v116, v148
    v_mfma_f32_32x32x16_bf16 v[124:139], v[168:171], v[204:207], v[124:139]
    v_exp_f32 v117, v149
    v_exp_f32 v118, v150
    v_exp_f32 v119, v151
    v_mfma_f32_32x32x16_bf16 v[124:139], v[172:175], v[176:179], v[124:139]
    v_exp_f32 v120, v152
    v_exp_f32 v121, v153
    v_exp_f32 v122, v154
    v_exp_f32 v123, v155
    v_lshrrev_b32 v11, 16, v12
    v_add_u32 v6, 512, v6
LASTJ2_1:
    v_pk_fma_f32 v[74:75], v[104:105], v[108:109], v[104:105]
    v_pk_fma_f32 v[104:105], v[140:141], v[106:107], v[74:75]
    v_pk_fma_f32 v[106:107], v[106:107], v[108:109], v[106:107]
    v_pk_fma_f32 v[74:75], v[104:105], v[110:111], v[104:105]
    v_pk_fma_f32 v[88:89], v[142:143], v[106:107], v[74:75]
    v_pk_fma_f32 v[90:91], v[106:107], v[110:111], v[106:107]
    v_pk_fma_f32 v[106:107], v[112:113], s[16:17], s[16:17]
    v_pk_mul_f32 v[104:105], v[144:145], s[16:17]
    v_pk_fma_f32 v[74:75], v[104:105], v[114:115], v[104:105]
    v_pk_fma_f32 v[104:105], v[146:147], v[106:107], v[74:75]
    v_pk_fma_f32 v[106:107], v[106:107], v[114:115], v[106:107]
    v_pk_fma_f32 v[74:75], v[104:105], v[116:117], v[104:105]
    v_pk_fma_f32 v[104:105], v[148:149], v[106:107], v[74:75]
    v_pk_fma_f32 v[106:107], v[106:107], v[116:117], v[106:107]
    v_pk_fma_f32 v[74:75], v[104:105], v[118:119], v[104:105]
    v_pk_fma_f32 v[104:105], v[150:151], v[106:107], v[74:75]
    v_pk_fma_f32 v[106:107], v[106:107], v[118:119], v[106:107]
    v_pk_fma_f32 v[74:75], v[104:105], v[120:121], v[104:105]
    v_pk_fma_f32 v[104:105], v[152:153], v[106:107], v[74:75]
    v_pk_fma_f32 v[106:107], v[106:107], v[120:121], v[106:107]
    v_pk_fma_f32 v[74:75], v[104:105], v[122:123], v[104:105]
    v_pk_fma_f32 v[104:105], v[154:155], v[106:107], v[74:75]
    v_pk_fma_f32 v[106:107], v[106:107], v[122:123], v[106:107]
    s_branch M_FLUSH1
    .p2align 6
M_V3_1:
    v_mfma_f32_32x32x16_bf16 v[140:155], v[34:37], v[208:211], 0
    v_exp_f32 v108, v124
    v_exp_f32 v109, v125
    v_exp_f32 v110, v126
    v_mfma_f32_32x32x16_bf16 v[140:155], v[38:41], v[212:215], v[140:155]
    v_exp_f32 v111, v127
    v_exp_f32 v112, v128
    v_exp_f32 v113, v129
    v_mfma_f32_32x32x16_bf16 v[140:155], v[42:45], v[216:219], v[140:155]
    v_exp_f32 v114, v130
    v_exp_f32 v115, v131
    v_exp_f32 v116, v132
    v_mfma_f32_32x32x16_bf16 v[140:155], v[46:49], v[220:223], v[140:155]
    v_exp_f32 v117, v133
    v_exp_f32 v118, v134
    v_exp_f32 v119, v135
    v_mfma_f32_32x32x16_bf16 v[140:155], v[172:175], v[180:183], v[140:155]
    v_exp_f32 v120, v136
    v_exp_f32 v121, v137
    v_exp_f32 v122, v138
    v_exp_f32 v123, v139
    v_pk_fma_f32 v[74:75], v[92:93], v[108:109], v[92:93]
    v_pk_fma_f32 v[92:93], v[124:125], v[94:95], v[74:75]
    ds_read_b32 v12, v8 offset:3456
    v_pk_fma_f32 v[94:95], v[94:95], v[108:109], v[94:95]
    v_pk_fma_f32 v[74:75], v[92:93], v[110:111], v[92:93]
    v_pk_fma_f32 v[92:93], v[126:127], v[94:95], v[74:75]
    v_pk_fma_f32 v[94:95], v[94:95], v[110:111], v[94:95]
    s_add_u32 s18, s6, 2
    s_and_b32 s18, s18, -2
    s_lshl_b32 s18, s18, 4
    s_add_u32 s19, s6, 1
    s_or_b32 s19, s19, 1
    s_lshl_b32 s19, s19, 4
    v_add_u32 v28, s18, v23
    v_add_u32 v29, s19, v23
    ds_read_b32 v28, v28
    ds_read_b32 v29, v29
    v_pk_fma_f32 v[74:75], v[92:93], v[112:113], v[92:93]
    v_pk_fma_f32 v[76:77], v[128:129], v[94:95], v[74:75]
    v_pk_fma_f32 v[78:79], v[94:95], v[112:113], v[94:95]
    v_pk_fma_f32 v[94:95], v[114:115], s[16:17], s[16:17]
    s_lshl_b32 s20, s6, 4
    v_add_u32 v26, s20, v24
    ds_read_b64 v[26:27], v26
    v_pk_mul_f32 v[92:93], v[130:131], s[16:17]
    v_pk_fma_f32 v[74:75], v[92:93], v[116:117], v[92:93]
    v_pk_fma_f32 v[92:93], v[132:133], v[94:95], v[74:75]
    v_pk_fma_f32 v[94:95], v[94:95], v[116:117], v[94:95]
    v_pk_fma_f32 v[74:75], v[92:93], v[118:119], v[92:93]
    v_pk_fma_f32 v[92:93], v[134:135], v[94:95], v[74:75]
    v_pk_fma_f32 v[94:95], v[94:95], v[118:119], v[94:95]
    v_pk_fma_f32 v[74:75], v[92:93], v[120:121], v[92:93]
    v_pk_fma_f32 v[92:93], v[136:137], v[94:95], v[74:75]
    v_pk_fma_f32 v[94:95], v[94:95], v[120:121], v[94:95]
    v_pk_fma_f32 v[74:75], v[92:93], v[122:123], v[92:93]
    v_pk_fma_f32 v[92:93], v[138:139], v[94:95], v[74:75]
    v_pk_fma_f32 v[94:95], v[94:95], v[122:123], v[94:95]
    s_waitcnt lgkmcnt(0)
    v_mfma_f32_32x32x16_bf16 v[124:139], v[34:37], v[224:227], 0
    v_exp_f32 v108, v140
    v_exp_f32 v109, v141
    v_exp_f32 v110, v142
    v_mfma_f32_32x32x16_bf16 v[124:139], v[38:41], v[228:231], v[124:139]
    v_exp_f32 v111, v143
    v_exp_f32 v112, v144
    v_exp_f32 v113, v145
    v_mfma_f32_32x32x16_bf16 v[124:139], v[42:45], v[232:235], v[124:139]
    v_exp_f32 v114, v146
    v_exp_f32 v115, v147
    v_exp_f32 v116, v148
    v_mfma_f32_32x32x16_bf16 v[124:139], v[46:49], v[236:239], v[124:139]
    v_exp_f32 v117, v149
    v_exp_f32 v118, v150
    v_exp_f32 v119, v151
    v_mfma_f32_32x32x16_bf16 v[124:139], v[172:175], v[184:187], v[124:139]
    v_exp_f32 v120, v152
    v_exp_f32 v121, v153
    v_exp_f32 v122, v154
    v_exp_f32 v123, v155
    v_mad_u32_u16 v13, v12, s11, v9
    v_pk_fma_f32 v[74:75], v[96:97], v[108:109], v[96:97]
    v_pk_fma_f32 v[96:97], v[140:141], v[98:99], v[74:75]
    s_mov_b64 exec, s[12:13]
    v_add_u32 v21, v28, v20
    v_add_u32 v22, v29, v20
    s_mov_b64 exec, -1
    v_pk_fma_f32 v[98:99], v[98:99], v[108:109], v[98:99]
    v_pk_fma_f32 v[74:75], v[96:97], v[110:111], v[96:97]
    ds_read_b64_tr_b16 v[176:177], v21 offset:0
    ds_read_b64_tr_b16 v[178:179], v22 offset:0
    v_pk_fma_f32 v[96:97], v[142:143], v[98:99], v[74:75]
    v_pk_fma_f32 v[98:99], v[98:99], v[110:111], v[98:99]
    v_pk_fma_f32 v[74:75], v[96:97], v[112:113], v[96:97]
    ds_read_b64_tr_b16 v[180:181], v21 offset:64
    ds_read_b64_tr_b16 v[182:183], v22 offset:64
    v_pk_fma_f32 v[80:81], v[144:145], v[98:99], v[74:75]
    v_pk_fma_f32 v[82:83], v[98:99], v[112:113], v[98:99]
    v_pk_fma_f32 v[98:99], v[114:115], s[16:17], s[16:17]
    ds_read_b64_tr_b16 v[184:185], v21 offset:128
    ds_read_b64_tr_b16 v[186:187], v22 offset:128
    v_pk_mul_f32 v[96:97], v[146:147], s[16:17]
    v_pk_fma_f32 v[74:75], v[96:97], v[116:117], v[96:97]
    v_pk_fma_f32 v[96:97], v[148:149], v[98:99], v[74:75]
    v_pk_fma_f32 v[98:99], v[98:99], v[116:117], v[98:99]
    v_pk_fma_f32 v[74:75], v[96:97], v[118:119], v[96:97]
    v_pk_fma_f32 v[96:97], v[150:151], v[98:99], v[74:75]
    v_pk_fma_f32 v[98:99], v[98:99], v[118:119], v[98:99]
    v_pk_fma_f32 v[74:75], v[96:97], v[120:121], v[96:97]
    v_pk_fma_f32 v[96:97], v[152:153], v[98:99], v[74:75]
    v_pk_fma_f32 v[98:99], v[98:99], v[120:121], v[98:99]
    v_pk_fma_f32 v[74:75], v[96:97], v[122:123], v[96:97]
    v_pk_fma_f32 v[96:97], v[154:155], v[98:99], v[74:75]
    v_pk_fma_f32 v[98:99], v[98:99], v[122:123], v[98:99]
    v_mfma_f32_32x32x16_bf16 v[140:155], v[34:37], v[240:243], 0
    v_exp_f32 v108, v124
    v_exp_f32 v109, v125
    v_exp_f32 v110, v126
    v_mfma_f32_32x32x16_bf16 v[140:155], v[38:41], v[244:247], v[140:155]
    v_exp_f32 v111, v127
    v_exp_f32 v112, v128
    v_exp_f32 v113, v129
    v_mfma_f32_32x32x16_bf16 v[140:155], v[42:45], v[248:251], v[140:155]
    v_exp_f32 v114, v130
    v_exp_f32 v115, v131
    v_exp_f32 v116, v132
    v_mfma_f32_32x32x16_bf16 v[140:155], v[46:49], v[252:255], v[140:155]
    v_exp_f32 v117, v133
    v_exp_f32 v118, v134
    v_exp_f32 v119, v135
    v_mfma_f32_32x32x16_bf16 v[140:155], v[172:175], v[188:191], v[140:155]
    v_exp_f32 v120, v136
    v_exp_f32 v121, v137
    v_exp_f32 v122, v138
    v_exp_f32 v123, v139
    v_add_u32 v8, 256, v8
    s_mov_b64 exec, s[12:13]
    ds_read_b128 v[172:175], v11
    s_mov_b64 exec, s[14:15]
    ds_read2_b64 v[172:175], v6 offset0:32 offset1:32
    s_mov_b64 exec, -1
    s_cmp_ge_u32 s4, s92
    v_pk_fma_f32 v[74:75], v[100:101], v[108:109], v[100:101]
    v_pk_fma_f32 v[100:101], v[124:125], v[102:103], v[74:75]
    ds_read_b64_tr_b16 v[188:189], v21 offset:192
    ds_read_b64_tr_b16 v[190:191], v22 offset:192
    v_pk_fma_f32 v[102:103], v[102:103], v[108:109], v[102:103]
    v_pk_fma_f32 v[74:75], v[100:101], v[110:111], v[100:101]
    s_waitcnt vmcnt(0)
    s_cbranch_scc1 NOLD3_1
    buffer_load_dwordx4 v[34:37], v13, s[28:31], 0 offen offset:0
    buffer_load_dwordx4 v[38:41], v13, s[28:31], 0 offen offset:16
    buffer_load_dwordx4 v[42:45], v13, s[28:31], 0 offen offset:32
    buffer_load_dwordx4 v[46:49], v13, s[28:31], 0 offen offset:48
NOLD3_1:
    v_pk_fma_f32 v[100:101], v[126:127], v[102:103], v[74:75]
    v_pk_fma_f32 v[102:103], v[102:103], v[110:111], v[102:103]
    v_pk_fma_f32 v[74:75], v[100:101], v[112:113], v[100:101]
    v_pk_fma_f32 v[84:85], v[128:129], v[102:103], v[74:75]
    v_pk_fma_f32 v[86:87], v[102:103], v[112:113], v[102:103]
    v_pk_fma_f32 v[102:103], v[114:115], s[16:17], s[16:17]
    v_pk_mul_f32 v[100:101], v[130:131], s[16:17]
    v_pk_fma_f32 v[74:75], v[100:101], v[116:117], v[100:101]
    v_pk_fma_f32 v[100:101], v[132:133], v[102:103], v[74:75]
    v_pk_fma_f32 v[102:103], v[102:103], v[116:117], v[102:103]
    v_pk_fma_f32 v[74:75], v[100:101], v[118:119], v[100:101]
    v_pk_fma_f32 v[100:101], v[134:135], v[102:103], v[74:75]
    v_pk_fma_f32 v[102:103], v[102:103], v[118:119], v[102:103]
    v_pk_fma_f32 v[74:75], v[100:101], v[120:121], v[100:101]
    v_pk_fma_f32 v[100:101], v[136:137], v[102:103], v[74:75]
    v_pk_fma_f32 v[102:103], v[102:103], v[120:121], v[102:103]
    v_pk_fma_f32 v[74:75], v[100:101], v[122:123], v[100:101]
    v_pk_fma_f32 v[100:101], v[138:139], v[102:103], v[74:75]
    v_pk_fma_f32 v[102:103], v[102:103], v[122:123], v[102:103]
    s_waitcnt lgkmcnt(0)
    s_cmp_ge_u32 s4, s88
    s_cbranch_scc1 LAST3_1
    v_mfma_f32_32x32x16_bf16 v[124:139], v[156:159], v[192:195], 0
    v_exp_f32 v108, v140
    v_exp_f32 v109, v141
    v_exp_f32 v110, v142
    v_mfma_f32_32x32x16_bf16 v[124:139], v[160:163], v[196:199], v[124:139]
    v_exp_f32 v111, v143
    v_exp_f32 v112, v144
    v_exp_f32 v113, v145
    v_mfma_f32_32x32x16_bf16 v[124:139], v[164:167], v[200:203], v[124:139]
    v_exp_f32 v114, v146
    v_exp_f32 v115, v147
    v_exp_f32 v116, v148
    v_mfma_f32_32x32x16_bf16 v[124:139], v[168:171], v[204:207], v[124:139]
    v_exp_f32 v117, v149
    v_exp_f32 v118, v150
    v_exp_f32 v119, v151
    v_mfma_f32_32x32x16_bf16 v[124:139], v[172:175], v[176:179], v[124:139]
    v_exp_f32 v120, v152
    v_exp_f32 v121, v153
    v_exp_f32 v122, v154
    v_exp_f32 v123, v155
    v_lshrrev_b32 v11, 16, v12
    v_add_u32 v6, 512, v6
LASTJ3_1:
    v_pk_fma_f32 v[74:75], v[104:105], v[108:109], v[104:105]
    v_pk_fma_f32 v[104:105], v[140:141], v[106:107], v[74:75]
    v_pk_fma_f32 v[106:107], v[106:107], v[108:109], v[106:107]
    v_pk_fma_f32 v[74:75], v[104:105], v[110:111], v[104:105]
    v_pk_fma_f32 v[104:105], v[142:143], v[106:107], v[74:75]
    v_pk_fma_f32 v[106:107], v[106:107], v[110:111], v[106:107]
    v_pk_fma_f32 v[74:75], v[104:105], v[112:113], v[104:105]
    v_pk_fma_f32 v[88:89], v[144:145], v[106:107], v[74:75]
    v_pk_fma_f32 v[90:91], v[106:107], v[112:113], v[106:107]
    v_pk_fma_f32 v[106:107], v[114:115], s[16:17], s[16:17]
    v_pk_mul_f32 v[104:105], v[146:147], s[16:17]
    v_pk_fma_f32 v[74:75], v[104:105], v[116:117], v[104:105]
    v_pk_fma_f32 v[104:105], v[148:149], v[106:107], v[74:75]
    v_pk_fma_f32 v[106:107], v[106:107], v[116:117], v[106:107]
    v_pk_fma_f32 v[74:75], v[104:105], v[118:119], v[104:105]
    v_pk_fma_f32 v[104:105], v[150:151], v[106:107], v[74:75]
    v_pk_fma_f32 v[106:107], v[106:107], v[118:119], v[106:107]
    v_pk_fma_f32 v[74:75], v[104:105], v[120:121], v[104:105]
    v_pk_fma_f32 v[104:105], v[152:153], v[106:107], v[74:75]
    v_pk_fma_f32 v[106:107], v[106:107], v[120:121], v[106:107]
    v_pk_fma_f32 v[74:75], v[104:105], v[122:123], v[104:105]
    v_pk_fma_f32 v[104:105], v[154:155], v[106:107], v[74:75]
    v_pk_fma_f32 v[106:107], v[106:107], v[122:123], v[106:107]
    s_branch M_FLUSH1
    .p2align 6
M_V4_1:
    v_mfma_f32_32x32x16_bf16 v[140:155], v[34:37], v[208:211], 0
    v_exp_f32 v108, v124
    v_exp_f32 v109, v125
    v_exp_f32 v110, v126
    v_mfma_f32_32x32x16_bf16 v[140:155], v[38:41], v[212:215], v[140:155]
    v_exp_f32 v111, v127
    v_exp_f32 v112, v128
    v_exp_f32 v113, v129
    v_mfma_f32_32x32x16_bf16 v[140:155], v[42:45], v[216:219], v[140:155]
    v_exp_f32 v114, v130
    v_exp_f32 v115, v131
    v_exp_f32 v116, v132
    v_mfma_f32_32x32x16_bf16 v[140:155], v[46:49], v[220:223], v[140:155]
    v_exp_f32 v117, v133
    v_exp_f32 v118, v134
    v_exp_f32 v119, v135
    v_mfma_f32_32x32x16_bf16 v[140:155], v[172:175], v[180:183], v[140:155]
    v_exp_f32 v120, v136
    v_exp_f32 v121, v137
    v_exp_f32 v122, v138
    v_exp_f32 v123, v139
    v_pk_fma_f32 v[74:75], v[92:93], v[108:109], v[92:93]
    v_pk_fma_f32 v[92:93], v[124:125], v[94:95], v[74:75]
    ds_read_b32 v12, v8 offset:3456
    v_pk_fma_f32 v[94:95], v[94:95], v[108:109], v[94:95]
    v_pk_fma_f32 v[74:75], v[92:93], v[110:111], v[92:93]
    v_pk_fma_f32 v[92:93], v[126:127], v[94:95], v[74:75]
    v_pk_fma_f32 v[94:95], v[94:95], v[110:111], v[94:95]
    s_add_u32 s18, s6, 2
    s_and_b32 s18, s18, -2
    s_lshl_b32 s18, s18, 4
    s_add_u32 s19, s6, 1
    s_or_b32 s19, s19, 1
    s_lshl_b32 s19, s19, 4
    v_add_u32 v28, s18, v23
    v_add_u32 v29, s19, v23
    ds_read_b32 v28, v28
    ds_read_b32 v29, v29
    v_pk_fma_f32 v[74:75], v[92:93], v[112:113], v[92:93]
    v_pk_fma_f32 v[92:93], v[128:129], v[94:95], v[74:75]
    v_pk_fma_f32 v[94:95], v[94:95], v[112:113], v[94:95]
    v_pk_fma_f32 v[74:75], v[92:93], v[114:115], v[92:93]
    s_lshl_b32 s20, s6, 4
    v_add_u32 v26, s20, v24
    ds_read_b64 v[26:27], v26
    v_pk_fma_f32 v[76:77], v[130:131], v[94:95], v[74:75]
    v_pk_fma_f32 v[78:79], v[94:95], v[114:115], v[94:95]
    v_pk_fma_f32 v[94:95], v[116:117], s[16:17], s[16:17]
    v_pk_mul_f32 v[92:93], v[132:133], s[16:17]
    v_pk_fma_f32 v[74:75], v[92:93], v[118:119], v[92:93]
    v_pk_fma_f32 v[92:93], v[134:135], v[94:95], v[74:75]
    v_pk_fma_f32 v[94:95], v[94:95], v[118:119], v[94:95]
    v_pk_fma_f32 v[74:75], v[92:93], v[120:121], v[92:93]
    v_pk_fma_f32 v[92:93], v[136:137], v[94:95], v[74:75]
    v_pk_fma_f32 v[94:95], v[94:95], v[120:121], v[94:95]
    v_pk_fma_f32 v[74:75], v[92:93], v[122:123], v[92:93]
    v_pk_fma_f32 v[92:93], v[138:139], v[94:95], v[74:75]
    v_pk_fma_f32 v[94:95], v[94:95], v[122:123], v[94:95]
    s_waitcnt lgkmcnt(0)
    v_mfma_f32_32x32x16_bf16 v[124:139], v[34:37], v[224:227], 0
    v_exp_f32 v108, v140
    v_exp_f32 v109, v141
    v_exp_f32 v110, v142
    v_mfma_f32_32x32x16_bf16 v[124:139], v[38:41], v[228:231], v[124:139]
    v_exp_f32 v111, v143
    v_exp_f32 v112, v144
    v_exp_f32 v113, v145
    v_mfma_f32_32x32x16_bf16 v[124:139], v[42:45], v[232:235], v[124:139]
    v_exp_f32 v114, v146
    v_exp_f32 v115, v147
    v_exp_f32 v116, v148
    v_mfma_f32_32x32x16_bf16 v[124:139], v[46:49], v[236:239], v[124:139]
    v_exp_f32 v117, v149
    v_exp_f32 v118, v150
    v_exp_f32 v119, v151
    v_mfma_f32_32x32x16_bf16 v[124:139], v[172:175], v[184:187], v[124:139]
    v_exp_f32 v120, v152
    v_exp_f32 v121, v153
    v_exp_f32 v122, v154
    v_exp_f32 v123, v155
    v_mad_u32_u16 v13, v12, s11, v9
    v_pk_fma_f32 v[74:75], v[96:97], v[108:109], v[96:97]
    v_pk_fma_f32 v[96:97], v[140:141], v[98:99], v[74:75]
    s_mov_b64 exec, s[12:13]
    v_add_u32 v21, v28, v20
    v_add_u32 v22, v29, v20
    s_mov_b64 exec, -1
    v_pk_fma_f32 v[98:99], v[98:99], v[108:109], v[98:99]
    v_pk_fma_f32 v[74:75], v[96:97], v[110:111], v[96:97]
    ds_read_b64_tr_b16 v[176:177], v21 offset:0
    ds_read_b64_tr_b16 v[178:179], v22 offset:0
    v_pk_fma_f32 v[96:97], v[142:143], v[98:99], v[74:75]
    v_pk_fma_f32 v[98:99], v[98:99], v[110:111], v[98:99]
    v_pk_fma_f32 v[74:75], v[96:97], v[112:113], v[96:97]
    ds_read_b64_tr_b16 v[180:181], v21 offset:64
    ds_read_b64_tr_b16 v[182:183], v22 offset:64
    v_pk_fma_f32 v[96:97], v[144:145], v[98:99], v[74:75]
    v_pk_fma_f32 v[98:99], v[98:99], v[112:113], v[98:99]
    v_pk_fma_f32 v[74:75], v[96:97], v[114:115], v[96:97]
    ds_read_b64_tr_b16 v[184:185], v21 offset:128
    ds_read_b64_tr_b16 v[186:187], v22 offset:128
    v_pk_fma_f32 v[80:81], v[146:147], v[98:99], v[74:75]
    v_pk_fma_f32 v[82:83], v[98:99], v[114:115], v[98:99]
    v_pk_fma_f32 v[98:99], v[116:117], s[16:17], s[16:17]
    v_pk_mul_f32 v[96:97], v[148:149], s[16:17]
    v_pk_fma_f32 v[74:75], v[96:97], v[118:119], v[96:97]
    v_pk_fma_f32 v[96:97], v[150:151], v[98:99], v[74:75]
    v_pk_fma_f32 v[98:99], v[98:99], v[118:119], v[98:99]
    v_pk_fma_f32 v[74:75], v[96:97], v[120:121], v[96:97]
    v_pk_fma_f32 v[96:97], v[152:153], v[98:99], v[74:75]
    v_pk_fma_f32 v[98:99], v[98:99], v[120:121], v[98:99]
    v_pk_fma_f32 v[74:75], v[96:97], v[122:123], v[96:97]
    v_pk_fma_f32 v[96:97], v[154:155], v[98:99], v[74:75]
    v_pk_fma_f32 v[98:99], v[98:99], v[122:123], v[98:99]
    v_mfma_f32_32x32x16_bf16 v[140:155], v[34:37], v[240:243], 0
    v_exp_f32 v108, v124
    v_exp_f32 v109, v125
    v_exp_f32 v110, v126
    v_mfma_f32_32x32x16_bf16 v[140:155], v[38:41], v[244:247], v[140:155]
    v_exp_f32 v111, v127
    v_exp_f32 v112, v128
    v_exp_f32 v113, v129
    v_mfma_f32_32x32x16_bf16 v[140:155], v[42:45], v[248:251], v[140:155]
    v_exp_f32 v114, v130
    v_exp_f32 v115, v131
    v_exp_f32 v116, v132
    v_mfma_f32_32x32x16_bf16 v[140:155], v[46:49], v[252:255], v[140:155]
    v_exp_f32 v117, v133
    v_exp_f32 v118, v134
    v_exp_f32 v119, v135
    v_mfma_f32_32x32x16_bf16 v[140:155], v[172:175], v[188:191], v[140:155]
    v_exp_f32 v120, v136
    v_exp_f32 v121, v137
    v_exp_f32 v122, v138
    v_exp_f32 v123, v139
    v_add_u32 v8, 256, v8
    s_mov_b64 exec, s[12:13]
    ds_read_b128 v[172:175], v11
    s_mov_b64 exec, s[14:15]
    ds_read2_b64 v[172:175], v6 offset0:32 offset1:32
    s_mov_b64 exec, -1
    s_cmp_ge_u32 s4, s92
    v_pk_fma_f32 v[74:75], v[100:101], v[108:109], v[100:101]
    v_pk_fma_f32 v[100:101], v[124:125], v[102:103], v[74:75]
    ds_read_b64_tr_b16 v[188:189], v21 offset:192
    ds_read_b64_tr_b16 v[190:191], v22 offset:192
    v_pk_fma_f32 v[102:103], v[102:103], v[108:109], v[102:103]
    v_pk_fma_f32 v[74:75], v[100:101], v[110:111], v[100:101]
    s_waitcnt vmcnt(0)
    s_cbranch_scc1 NOLD4_1
    buffer_load_dwordx4 v[34:37], v13, s[28:31], 0 offen offset:0
    buffer_load_dwordx4 v[38:41], v13, s[28:31], 0 offen offset:16
    buffer_load_dwordx4 v[42:45], v13, s[28:31], 0 offen offset:32
    buffer_load_dwordx4 v[46:49], v13, s[28:31], 0 offen offset:48
NOLD4_1:
    v_pk_fma_f32 v[100:101], v[126:127], v[102:103], v[74:75]
    v_pk_fma_f32 v[102:103], v[102:103], v[110:111], v[102:103]
    v_pk_fma_f32 v[74:75], v[100:101], v[112:113], v[100:101]
    v_pk_fma_f32 v[100:101], v[128:129], v[102:103], v[74:75]
    v_pk_fma_f32 v[102:103], v[102:103], v[112:113], v[102:103]
    v_pk_fma_f32 v[74:75], v[100:101], v[114:115], v[100:101]
    v_pk_fma_f32 v[84:85], v[130:131], v[102:103], v[74:75]
    v_pk_fma_f32 v[86:87], v[102:103], v[114:115], v[102:103]
    v_pk_fma_f32 v[102:103], v[116:117], s[16:17], s[16:17]
    v_pk_mul_f32 v[100:101], v[132:133], s[16:17]
    v_pk_fma_f32 v[74:75], v[100:101], v[118:119], v[100:101]
    v_pk_fma_f32 v[100:101], v[134:135], v[102:103], v[74:75]
    v_pk_fma_f32 v[102:103], v[102:103], v[118:119], v[102:103]
    v_pk_fma_f32 v[74:75], v[100:101], v[120:121], v[100:101]
    v_pk_fma_f32 v[100:101], v[136:137], v[102:103], v[74:75]
    v_pk_fma_f32 v[102:103], v[102:103], v[120:121], v[102:103]
    v_pk_fma_f32 v[74:75], v[100:101], v[122:123], v[100:101]
    v_pk_fma_f32 v[100:101], v[138:139], v[102:103], v[74:75]
    v_pk_fma_f32 v[102:103], v[102:103], v[122:123], v[102:103]
    s_waitcnt lgkmcnt(0)
    s_cmp_ge_u32 s4, s88
    s_cbranch_scc1 LAST4_1
    v_mfma_f32_32x32x16_bf16 v[124:139], v[156:159], v[192:195], 0
    v_exp_f32 v108, v140
    v_exp_f32 v109, v141
    v_exp_f32 v110, v142
    v_mfma_f32_32x32x16_bf16 v[124:139], v[160:163], v[196:199], v[124:139]
    v_exp_f32 v111, v143
    v_exp_f32 v112, v144
    v_exp_f32 v113, v145
    v_mfma_f32_32x32x16_bf16 v[124:139], v[164:167], v[200:203], v[124:139]
    v_exp_f32 v114, v146
    v_exp_f32 v115, v147
    v_exp_f32 v116, v148
    v_mfma_f32_32x32x16_bf16 v[124:139], v[168:171], v[204:207], v[124:139]
    v_exp_f32 v117, v149
    v_exp_f32 v118, v150
    v_exp_f32 v119, v151
    v_mfma_f32_32x32x16_bf16 v[124:139], v[172:175], v[176:179], v[124:139]
    v_exp_f32 v120, v152
    v_exp_f32 v121, v153
    v_exp_f32 v122, v154
    v_exp_f32 v123, v155
    v_lshrrev_b32 v11, 16, v12
    v_add_u32 v6, 512, v6
LASTJ4_1:
    v_pk_fma_f32 v[74:75], v[104:105], v[108:109], v[104:105]
    v_pk_fma_f32 v[104:105], v[140:141], v[106:107], v[74:75]
    v_pk_fma_f32 v[106:107], v[106:107], v[108:109], v[106:107]
    v_pk_fma_f32 v[74:75], v[104:105], v[110:111], v[104:105]
    v_pk_fma_f32 v[104:105], v[142:143], v[106:107], v[74:75]
    v_pk_fma_f32 v[106:107], v[106:107], v[110:111], v[106:107]
    v_pk_fma_f32 v[74:75], v[104:105], v[112:113], v[104:105]
    v_pk_fma_f32 v[104:105], v[144:145], v[106:107], v[74:75]
    v_pk_fma_f32 v[106:107], v[106:107], v[112:113], v[106:107]
    v_pk_fma_f32 v[74:75], v[104:105], v[114:115], v[104:105]
    v_pk_fma_f32 v[88:89], v[146:147], v[106:107], v[74:75]
    v_pk_fma_f32 v[90:91], v[106:107], v[114:115], v[106:107]
    v_pk_fma_f32 v[106:107], v[116:117], s[16:17], s[16:17]
    v_pk_mul_f32 v[104:105], v[148:149], s[16:17]
    v_pk_fma_f32 v[74:75], v[104:105], v[118:119], v[104:105]
    v_pk_fma_f32 v[104:105], v[150:151], v[106:107], v[74:75]
    v_pk_fma_f32 v[106:107], v[106:107], v[118:119], v[106:107]
    v_pk_fma_f32 v[74:75], v[104:105], v[120:121], v[104:105]
    v_pk_fma_f32 v[104:105], v[152:153], v[106:107], v[74:75]
    v_pk_fma_f32 v[106:107], v[106:107], v[120:121], v[106:107]
    v_pk_fma_f32 v[74:75], v[104:105], v[122:123], v[104:105]
    v_pk_fma_f32 v[104:105], v[154:155], v[106:107], v[74:75]
    v_pk_fma_f32 v[106:107], v[106:107], v[122:123], v[106:107]
    s_branch M_FLUSH1
    .p2align 6
M_V5_1:
    v_mfma_f32_32x32x16_bf16 v[140:155], v[34:37], v[208:211], 0
    v_exp_f32 v108, v124
    v_exp_f32 v109, v125
    v_exp_f32 v110, v126
    v_mfma_f32_32x32x16_bf16 v[140:155], v[38:41], v[212:215], v[140:155]
    v_exp_f32 v111, v127
    v_exp_f32 v112, v128
    v_exp_f32 v113, v129
    v_mfma_f32_32x32x16_bf16 v[140:155], v[42:45], v[216:219], v[140:155]
    v_exp_f32 v114, v130
    v_exp_f32 v115, v131
    v_exp_f32 v116, v132
    v_mfma_f32_32x32x16_bf16 v[140:155], v[46:49], v[220:223], v[140:155]
    v_exp_f32 v117, v133
    v_exp_f32 v118, v134
    v_exp_f32 v119, v135
    v_mfma_f32_32x32x16_bf16 v[140:155], v[172:175], v[180:183], v[140:155]
    v_exp_f32 v120, v136
    v_exp_f32 v121, v137
    v_exp_f32 v122, v138
    v_exp_f32 v123, v139
    v_pk_fma_f32 v[74:75], v[92:93], v[108:109], v[92:93]
    v_pk_fma_f32 v[92:93], v[124:125], v[94:95], v[74:75]
    ds_read_b32 v12, v8 offset:3456
    v_pk_fma_f32 v[94:95], v[94:95], v[108:109], v[94:95]
    v_pk_fma_f32 v[74:75], v[92:93], v[110:111], v[92:93]
    v_pk_fma_f32 v[92:93], v[126:127], v[94:95], v[74:75]
    v_pk_fma_f32 v[94:95], v[94:95], v[110:111], v[94:95]
    s_add_u32 s18, s6, 2
    s_and_b32 s18, s18, -2
    s_lshl_b32 s18, s18, 4
    s_add_u32 s19, s6, 1
    s_or_b32 s19, s19, 1
    s_lshl_b32 s19, s19, 4
    v_add_u32 v28, s18, v23
    v_add_u32 v29, s19, v23
    ds_read_b32 v28, v28
    ds_read_b32 v29, v29
    v_pk_fma_f32 v[74:75], v[92:93], v[112:113], v[92:93]
    v_pk_fma_f32 v[92:93], v[128:129], v[94:95], v[74:75]
    v_pk_fma_f32 v[94:95], v[94:95], v[112:113], v[94:95]
    v_pk_fma_f32 v[74:75], v[92:93], v[114:115], v[92:93]
    s_lshl_b32 s20, s6, 4
    v_add_u32 v26, s20, v24
    ds_read_b64 v[26:27], v26
    v_pk_fma_f32 v[92:93], v[130:131], v[94:95], v[74:75]
    v_pk_fma_f32 v[94:95], v[94:95], v[114:115], v[94:95]
    v_pk_fma_f32 v[74:75], v[92:93], v[116:117], v[92:93]
    v_pk_fma_f32 v[76:77], v[132:133], v[94:95], v[74:75]
    v_pk_fma_f32 v[78:79], v[94:95], v[116:117], v[94:95]
    v_pk_fma_f32 v[94:95], v[118:119], s[16:17], s[16:17]
    v_pk_mul_f32 v[92:93], v[134:135], s[16:17]
    v_pk_fma_f32 v[74:75], v[92:93], v[120:121], v[92:93]
    v_pk_fma_f32 v[92:93], v[136:137], v[94:95], v[74:75]
    v_pk_fma_f32 v[94:95], v[94:95], v[120:121], v[94:95]
    v_pk_fma_f32 v[74:75], v[92:93], v[122:123], v[92:93]
    v_pk_fma_f32 v[92:93], v[138:139], v[94:95], v[74:75]
    v_pk_fma_f32 v[94:95], v[94:95], v[122:123], v[94:95]
    s_waitcnt lgkmcnt(0)
    v_mfma_f32_32x32x16_bf16 v[124:139], v[34:37], v[224:227], 0
    v_exp_f32 v108, v140
    v_exp_f32 v109, v141
    v_exp_f32 v110, v142
    v_mfma_f32_32x32x16_bf16 v[124:139], v[38:41], v[228:231], v[124:139]
    v_exp_f32 v111, v143
    v_exp_f32 v112, v144
    v_exp_f32 v113, v145
    v_mfma_f32_32x32x16_bf16 v[124:139], v[42:45], v[232:235], v[124:139]
    v_exp_f32 v114, v146
    v_exp_f32 v115, v147
    v_exp_f32 v116, v148
    v_mfma_f32_32x32x16_bf16 v[124:139], v[46:49], v[236:239], v[124:139]
    v_exp_f32 v117, v149
    v_exp_f32 v118, v150
    v_exp_f32 v119, v151
    v_mfma_f32_32x32x16_bf16 v[124:139], v[172:175], v[184:187], v[124:139]
    v_exp_f32 v120, v152
    v_exp_f32 v121, v153
    v_exp_f32 v122, v154
    v_exp_f32 v123, v155
    v_mad_u32_u16 v13, v12, s11, v9
    v_pk_fma_f32 v[74:75], v[96:97], v[108:109], v[96:97]
    v_pk_fma_f32 v[96:97], v[140:141], v[98:99], v[74:75]
    s_mov_b64 exec, s[12:13]
    v_add_u32 v21, v28, v20
    v_add_u32 v22, v29, v20
    s_mov_b64 exec, -1
    v_pk_fma_f32 v[98:99], v[98:99], v[108:109], v[98:99]
    v_pk_fma_f32 v[74:75], v[96:97], v[110:111], v[96:97]
    ds_read_b64_tr_b16 v[176:177], v21 offset:0
    ds_read_b64_tr_b16 v[178:179], v22 offset:0
    v_pk_fma_f32 v[96:97], v[142:143], v[98:99], v[74:75]
    v_pk_fma_f32 v[98:99], v[98:99], v[110:111], v[98:99]
    v_pk_fma_f32 v[74:75], v[96:97], v[112:113], v[96:97]
    ds_read_b64_tr_b16 v[180:181], v21 offset:64
    ds_read_b64_tr_b16 v[182:183], v22 offset:64
    v_pk_fma_f32 v[96:97], v[144:145], v[98:99], v[74:75]
    v_pk_fma_f32 v[98:99], v[98:99], v[112:113], v[98:99]
    v_pk_fma_f32 v[74:75], v[96:97], v[114:115], v[96:97]
    ds_read_b64_tr_b16 v[184:185], v21 offset:128
    ds_read_b64_tr_b16 v[186:187], v22 offset:128
    v_pk_fma_f32 v[96:97], v[146:147], v[98:99], v[74:75]
    v_pk_fma_f32 v[98:99], v[98:99], v[114:115], v[98:99]
    v_pk_fma_f32 v[74:75], v[96:97], v[116:117], v[96:97]
    v_pk_fma_f32 v[80:81], v[148:149], v[98:99], v[74:75]
    v_pk_fma_f32 v[82:83], v[98:99], v[116:117], v[98:99]
    v_pk_fma_f32 v[98:99], v[118:119], s[16:17], s[16:17]
    v_pk_mul_f32 v[96:97], v[150:151], s[16:17]
    v_pk_fma_f32 v[74:75], v[96:97], v[120:121], v[96:97]
    v_pk_fma_f32 v[96:97], v[152:153], v[98:99], v[74:75]
    v_pk_fma_f32 v[98:99], v[98:99], v[120:121], v[98:99]
    v_pk_fma_f32 v[74:75], v[96:97], v[122:123], v[96:97]
    v_pk_fma_f32 v[96:97], v[154:155], v[98:99], v[74:75]
    v_pk_fma_f32 v[98:99], v[98:99], v[122:123], v[98:99]
    v_mfma_f32_32x32x16_bf16 v[140:155], v[34:37], v[240:243], 0
    v_exp_f32 v108, v124
    v_exp_f32 v109, v125
    v_exp_f32 v110, v126
    v_mfma_f32_32x32x16_bf16 v[140:155], v[38:41], v[244:247], v[140:155]
    v_exp_f32 v111, v127
    v_exp_f32 v112, v128
    v_exp_f32 v113, v129
    v_mfma_f32_32x32x16_bf16 v[140:155], v[42:45], v[248:251], v[140:155]
    v_exp_f32 v114, v130
    v_exp_f32 v115, v131
    v_exp_f32 v116, v132
    v_mfma_f32_32x32x16_bf16 v[140:155], v[46:49], v[252:255], v[140:155]
    v_exp_f32 v117, v133
    v_exp_f32 v118, v134
    v_exp_f32 v119, v135
    v_mfma_f32_32x32x16_bf16 v[140:155], v[172:175], v[188:191], v[140:155]
    v_exp_f32 v120, v136
    v_exp_f32 v121, v137
    v_exp_f32 v122, v138
    v_exp_f32 v123, v139
    v_add_u32 v8, 256, v8
    s_mov_b64 exec, s[12:13]
    ds_read_b128 v[172:175], v11
    s_mov_b64 exec, s[14:15]
    ds_read2_b64 v[172:175], v6 offset0:32 offset1:32
    s_mov_b64 exec, -1
    s_cmp_ge_u32 s4, s92
    v_pk_fma_f32 v[74:75], v[100:101], v[108:109], v[100:101]
    v_pk_fma_f32 v[100:101], v[124:125], v[102:103], v[74:75]
    ds_read_b64_tr_b16 v[188:189], v21 offset:192
    ds_read_b64_tr_b16 v[190:191], v22 offset:192
    v_pk_fma_f32 v[102:103], v[102:103], v[108:109], v[102:103]
    v_pk_fma_f32 v[74:75], v[100:101], v[110:111], v[100:101]
    s_waitcnt vmcnt(0)
    s_cbranch_scc1 NOLD5_1
    buffer_load_dwordx4 v[34:37], v13, s[28:31], 0 offen offset:0
    buffer_load_dwordx4 v[38:41], v13, s[28:31], 0 offen offset:16
    buffer_load_dwordx4 v[42:45], v13, s[28:31], 0 offen offset:32
    buffer_load_dwordx4 v[46:49], v13, s[28:31], 0 offen offset:48
NOLD5_1:
    v_pk_fma_f32 v[100:101], v[126:127], v[102:103], v[74:75]
    v_pk_fma_f32 v[102:103], v[102:103], v[110:111], v[102:103]
    v_pk_fma_f32 v[74:75], v[100:101], v[112:113], v[100:101]
    v_pk_fma_f32 v[100:101], v[128:129], v[102:103], v[74:75]
    v_pk_fma_f32 v[102:103], v[102:103], v[112:113], v[102:103]
    v_pk_fma_f32 v[74:75], v[100:101], v[114:115], v[100:101]
    v_pk_fma_f32 v[100:101], v[130:131], v[102:103], v[74:75]
    v_pk_fma_f32 v[102:103], v[102:103], v[114:115], v[102:103]
    v_pk_fma_f32 v[74:75], v[100:101], v[116:117], v[100:101]
    v_pk_fma_f32 v[84:85], v[132:133], v[102:103], v[74:75]
    v_pk_fma_f32 v[86:87], v[102:103], v[116:117], v[102:103]
    v_pk_fma_f32 v[102:103], v[118:119], s[16:17], s[16:17]
    v_pk_mul_f32 v[100:101], v[134:135], s[16:17]
    v_pk_fma_f32 v[74:75], v[100:101], v[120:121], v[100:101]
    v_pk_fma_f32 v[100:101], v[136:137], v[102:103], v[74:75]
    v_pk_fma_f32 v[102:103], v[102:103], v[120:121], v[102:103]
    v_pk_fma_f32 v[74:75], v[100:101], v[122:123], v[100:101]
    v_pk_fma_f32 v[100:101], v[138:139], v[102:103], v[74:75]
    v_pk_fma_f32 v[102:103], v[102:103], v[122:123], v[102:103]
    s_waitcnt lgkmcnt(0)
    s_cmp_ge_u32 s4, s88
    s_cbranch_scc1 LAST5_1
    v_mfma_f32_32x32x16_bf16 v[124:139], v[156:159], v[192:195], 0
    v_exp_f32 v108, v140
    v_exp_f32 v109, v141
    v_exp_f32 v110, v142
    v_mfma_f32_32x32x16_bf16 v[124:139], v[160:163], v[196:199], v[124:139]
    v_exp_f32 v111, v143
    v_exp_f32 v112, v144
    v_exp_f32 v113, v145
    v_mfma_f32_32x32x16_bf16 v[124:139], v[164:167], v[200:203], v[124:139]
    v_exp_f32 v114, v146
    v_exp_f32 v115, v147
    v_exp_f32 v116, v148
    v_mfma_f32_32x32x16_bf16 v[124:139], v[168:171], v[204:207], v[124:139]
    v_exp_f32 v117, v149
    v_exp_f32 v118, v150
    v_exp_f32 v119, v151
    v_mfma_f32_32x32x16_bf16 v[124:139], v[172:175], v[176:179], v[124:139]
    v_exp_f32 v120, v152
    v_exp_f32 v121, v153
    v_exp_f32 v122, v154
    v_exp_f32 v123, v155
    v_lshrrev_b32 v11, 16, v12
    v_add_u32 v6, 512, v6
LASTJ5_1:
    v_pk_fma_f32 v[74:75], v[104:105], v[108:109], v[104:105]
    v_pk_fma_f32 v[104:105], v[140:141], v[106:107], v[74:75]
    v_pk_fma_f32 v[106:107], v[106:107], v[108:109], v[106:107]
    v_pk_fma_f32 v[74:75], v[104:105], v[110:111], v[104:105]
    v_pk_fma_f32 v[104:105], v[142:143], v[106:107], v[74:75]
    v_pk_fma_f32 v[106:107], v[106:107], v[110:111], v[106:107]
    v_pk_fma_f32 v[74:75], v[104:105], v[112:113], v[104:105]
    v_pk_fma_f32 v[104:105], v[144:145], v[106:107], v[74:75]
    v_pk_fma_f32 v[106:107], v[106:107], v[112:113], v[106:107]
    v_pk_fma_f32 v[74:75], v[104:105], v[114:115], v[104:105]
    v_pk_fma_f32 v[104:105], v[146:147], v[106:107], v[74:75]
    v_pk_fma_f32 v[106:107], v[106:107], v[114:115], v[106:107]
    v_pk_fma_f32 v[74:75], v[104:105], v[116:117], v[104:105]
    v_pk_fma_f32 v[88:89], v[148:149], v[106:107], v[74:75]
    v_pk_fma_f32 v[90:91], v[106:107], v[116:117], v[106:107]
    v_pk_fma_f32 v[106:107], v[118:119], s[16:17], s[16:17]
    v_pk_mul_f32 v[104:105], v[150:151], s[16:17]
    v_pk_fma_f32 v[74:75], v[104:105], v[120:121], v[104:105]
    v_pk_fma_f32 v[104:105], v[152:153], v[106:107], v[74:75]
    v_pk_fma_f32 v[106:107], v[106:107], v[120:121], v[106:107]
    v_pk_fma_f32 v[74:75], v[104:105], v[122:123], v[104:105]
    v_pk_fma_f32 v[104:105], v[154:155], v[106:107], v[74:75]
    v_pk_fma_f32 v[106:107], v[106:107], v[122:123], v[106:107]
    s_branch M_FLUSH1
    .p2align 6
M_V6_1:
    v_mfma_f32_32x32x16_bf16 v[140:155], v[34:37], v[208:211], 0
    v_exp_f32 v108, v124
    v_exp_f32 v109, v125
    v_exp_f32 v110, v126
    v_mfma_f32_32x32x16_bf16 v[140:155], v[38:41], v[212:215], v[140:155]
    v_exp_f32 v111, v127
    v_exp_f32 v112, v128
    v_exp_f32 v113, v129
    v_mfma_f32_32x32x16_bf16 v[140:155], v[42:45], v[216:219], v[140:155]
    v_exp_f32 v114, v130
    v_exp_f32 v115, v131
    v_exp_f32 v116, v132
    v_mfma_f32_32x32x16_bf16 v[140:155], v[46:49], v[220:223], v[140:155]
    v_exp_f32 v117, v133
    v_exp_f32 v118, v134
    v_exp_f32 v119, v135
    v_mfma_f32_32x32x16_bf16 v[140:155], v[172:175], v[180:183], v[140:155]
    v_exp_f32 v120, v136
    v_exp_f32 v121, v137
    v_exp_f32 v122, v138
    v_exp_f32 v123, v139
    v_pk_fma_f32 v[74:75], v[92:93], v[108:109], v[92:93]
    v_pk_fma_f32 v[92:93], v[124:125], v[94:95], v[74:75]
    ds_read_b32 v12, v8 offset:3456
    v_pk_fma_f32 v[94:95], v[94:95], v[108:109], v[94:95]
    v_pk_fma_f32 v[74:75], v[92:93], v[110:111], v[92:93]
    v_pk_fma_f32 v[92:93], v[126:127], v[94:95], v[74:75]
    v_pk_fma_f32 v[94:95], v[94:95], v[110:111], v[94:95]
    s_add_u32 s18, s6, 2
    s_and_b32 s18, s18, -2
    s_lshl_b32 s18, s18, 4
    s_add_u32 s19, s6, 1
    s_or_b32 s19, s19, 1
    s_lshl_b32 s19, s19, 4
    v_add_u32 v28, s18, v23
    v_add_u32 v29, s19, v23
    ds_read_b32 v28, v28
    ds_read_b32 v29, v29
    v_pk_fma_f32 v[74:75], v[92:93], v[112:113], v[92:93]
    v_pk_fma_f32 v[92:93], v[128:129], v[94:95], v[74:75]
    v_pk_fma_f32 v[94:95], v[94:95], v[112:113], v[94:95]
    v_pk_fma_f32 v[74:75], v[92:93], v[114:115], v[92:93]
    s_lshl_b32 s20, s6, 4
    v_add_u32 v26, s20, v24
    ds_read_b64 v[26:27], v26
    v_pk_fma_f32 v[92:93], v[130:131], v[94:95], v[74:75]
    v_pk_fma_f32 v[94:95], v[94:95], v[114:115], v[94:95]
    v_pk_fma_f32 v[74:75], v[92:93], v[116:117], v[92:93]
    v_pk_fma_f32 v[92:93], v[132:133], v[94:95], v[74:75]
    v_pk_fma_f32 v[94:95], v[94:95], v[116:117], v[94:95]
    v_pk_fma_f32 v[74:75], v[92:93], v[118:119], v[92:93]
    v_pk_fma_f32 v[76:77], v[134:135], v[94:95], v[74:75]
    v_pk_fma_f32 v[78:79], v[94:95], v[118:119], v[94:95]
    v_pk_fma_f32 v[94:95], v[120:121], s[16:17], s[16:17]
    v_pk_mul_f32 v[92:93], v[136:137], s[16:17]
    v_pk_fma_f32 v[74:75], v[92:93], v[122:123], v[92:93]
    v_pk_fma_f32 v[92:93], v[138:139], v[94:95], v[74:75]
    v_pk_fma_f32 v[94:95], v[94:95], v[122:123], v[94:95]
    s_waitcnt lgkmcnt(0)
    v_mfma_f32_32x32x16_bf16 v[124:139], v[34:37], v[224:227], 0
    v_exp_f32 v108, v140
    v_exp_f32 v109, v141
    v_exp_f32 v110, v142
    v_mfma_f32_32x32x16_bf16 v[124:139], v[38:41], v[228:231], v[124:139]
    v_exp_f32 v111, v143
    v_exp_f32 v112, v144
    v_exp_f32 v113, v145
    v_mfma_f32_32x32x16_bf16 v[124:139], v[42:45], v[232:235], v[124:139]
    v_exp_f32 v114, v146
    v_exp_f32 v115, v147
    v_exp_f32 v116, v148
    v_mfma_f32_32x32x16_bf16 v[124:139], v[46:49], v[236:239], v[124:139]
    v_exp_f32 v117, v149
    v_exp_f32 v118, v150
    v_exp_f32 v119, v151
    v_mfma_f32_32x32x16_bf16 v[124:139], v[172:175], v[184:187], v[124:139]
    v_exp_f32 v120, v152
    v_exp_f32 v121, v153
    v_exp_f32 v122, v154
    v_exp_f32 v123, v155
    v_mad_u32_u16 v13, v12, s11, v9
    v_pk_fma_f32 v[74:75], v[96:97], v[108:109], v[96:97]
    v_pk_fma_f32 v[96:97], v[140:141], v[98:99], v[74:75]
    s_mov_b64 exec, s[12:13]
    v_add_u32 v21, v28, v20
    v_add_u32 v22, v29, v20
    s_mov_b64 exec, -1
    v_pk_fma_f32 v[98:99], v[98:99], v[108:109], v[98:99]
    v_pk_fma_f32 v[74:75], v[96:97], v[110:111], v[96:97]
    ds_read_b64_tr_b16 v[176:177], v21 offset:0
    ds_read_b64_tr_b16 v[178:179], v22 offset:0
    v_pk_fma_f32 v[96:97], v[142:143], v[98:99], v[74:75]
    v_pk_fma_f32 v[98:99], v[98:99], v[110:111], v[98:99]
    v_pk_fma_f32 v[74:75], v[96:97], v[112:113], v[96:97]
    ds_read_b64_tr_b16 v[180:181], v21 offset:64
    ds_read_b64_tr_b16 v[182:183], v22 offset:64
    v_pk_fma_f32 v[96:97], v[144:145], v[98:99], v[74:75]
    v_pk_fma_f32 v[98:99], v[98:99], v[112:113], v[98:99]
    v_pk_fma_f32 v[74:75], v[96:97], v[114:115], v[96:97]
    ds_read_b64_tr_b16 v[184:185], v21 offset:128
    ds_read_b64_tr_b16 v[186:187], v22 offset:128
    v_pk_fma_f32 v[96:97], v[146:147], v[98:99], v[74:75]
    v_pk_fma_f32 v[98:99], v[98:99], v[114:115], v[98:99]
    v_pk_fma_f32 v[74:75], v[96:97], v[116:117], v[96:97]
    v_pk_fma_f32 v[96:97], v[148:149], v[98:99], v[74:75]
    v_pk_fma_f32 v[98:99], v[98:99], v[116:117], v[98:99]
    v_pk_fma_f32 v[74:75], v[96:97], v[118:119], v[96:97]
    v_pk_fma_f32 v[80:81], v[150:151], v[98:99], v[74:75]
    v_pk_fma_f32 v[82:83], v[98:99], v[118:119], v[98:99]
    v_pk_fma_f32 v[98:99], v[120:121], s[16:17], s[16:17]
    v_pk_mul_f32 v[96:97], v[152:153], s[16:17]
    v_pk_fma_f32 v[74:75], v[96:97], v[122:123], v[96:97]
    v_pk_fma_f32 v[96:97], v[154:155], v[98:99], v[74:75]
    v_pk_fma_f32 v[98:99], v[98:99], v[122:123], v[98:99]
    v_mfma_f32_32x32x16_bf16 v[140:155], v[34:37], v[240:243], 0
    v_exp_f32 v108, v124
    v_exp_f32 v109, v125
    v_exp_f32 v110, v126
    v_mfma_f32_32x32x16_bf16 v[140:155], v[38:41], v[244:247], v[140:155]
    v_exp_f32 v111, v127
    v_exp_f32 v112, v128
    v_exp_f32 v113, v129
    v_mfma_f32_32x32x16_bf16 v[140:155], v[42:45], v[248:251], v[140:155]
    v_exp_f32 v114, v130
    v_exp_f32 v115, v131
    v_exp_f32 v116, v132
    v_mfma_f32_32x32x16_bf16 v[140:155], v[46:49], v[252:255], v[140:155]
    v_exp_f32 v117, v133
    v_exp_f32 v118, v134
    v_exp_f32 v119, v135
    v_mfma_f32_32x32x16_bf16 v[140:155], v[172:175], v[188:191], v[140:155]
    v_exp_f32 v120, v136
    v_exp_f32 v121, v137
    v_exp_f32 v122, v138
    v_exp_f32 v123, v139
    v_add_u32 v8, 256, v8
    s_mov_b64 exec, s[12:13]
    ds_read_b128 v[172:175], v11
    s_mov_b64 exec, s[14:15]
    ds_read2_b64 v[172:175], v6 offset0:32 offset1:32
    s_mov_b64 exec, -1
    s_cmp_ge_u32 s4, s92
    v_pk_fma_f32 v[74:75], v[100:101], v[108:109], v[100:101]
    v_pk_fma_f32 v[100:101], v[124:125], v[102:103], v[74:75]
    ds_read_b64_tr_b16 v[188:189], v21 offset:192
    ds_read_b64_tr_b16 v[190:191], v22 offset:192
    v_pk_fma_f32 v[102:103], v[102:103], v[108:109], v[102:103]
    v_pk_fma_f32 v[74:75], v[100:101], v[110:111], v[100:101]
    s_waitcnt vmcnt(0)
    s_cbranch_scc1 NOLD6_1
    buffer_load_dwordx4 v[34:37], v13, s[28:31], 0 offen offset:0
    buffer_load_dwordx4 v[38:41], v13, s[28:31], 0 offen offset:16
    buffer_load_dwordx4 v[42:45], v13, s[28:31], 0 offen offset:32
    buffer_load_dwordx4 v[46:49], v13, s[28:31], 0 offen offset:48
NOLD6_1:
    v_pk_fma_f32 v[100:101], v[126:127], v[102:103], v[74:75]
    v_pk_fma_f32 v[102:103], v[102:103], v[110:111], v[102:103]
    v_pk_fma_f32 v[74:75], v[100:101], v[112:113], v[100:101]
    v_pk_fma_f32 v[100:101], v[128:129], v[102:103], v[74:75]
    v_pk_fma_f32 v[102:103], v[102:103], v[112:113], v[102:103]
    v_pk_fma_f32 v[74:75], v[100:101], v[114:115], v[100:101]
    v_pk_fma_f32 v[100:101], v[130:131], v[102:103], v[74:75]
    v_pk_fma_f32 v[102:103], v[102:103], v[114:115], v[102:103]
    v_pk_fma_f32 v[74:75], v[100:101], v[116:117], v[100:101]
    v_pk_fma_f32 v[100:101], v[132:133], v[102:103], v[74:75]
    v_pk_fma_f32 v[102:103], v[102:103], v[116:117], v[102:103]
    v_pk_fma_f32 v[74:75], v[100:101], v[118:119], v[100:101]
    v_pk_fma_f32 v[84:85], v[134:135], v[102:103], v[74:75]
    v_pk_fma_f32 v[86:87], v[102:103], v[118:119], v[102:103]
    v_pk_fma_f32 v[102:103], v[120:121], s[16:17], s[16:17]
    v_pk_mul_f32 v[100:101], v[136:137], s[16:17]
    v_pk_fma_f32 v[74:75], v[100:101], v[122:123], v[100:101]
    v_pk_fma_f32 v[100:101], v[138:139], v[102:103], v[74:75]
    v_pk_fma_f32 v[102:103], v[102:103], v[122:123], v[102:103]
    s_waitcnt lgkmcnt(0)
    s_cmp_ge_u32 s4, s88
    s_cbranch_scc1 LAST6_1
    v_mfma_f32_32x32x16_bf16 v[124:139], v[156:159], v[192:195], 0
    v_exp_f32 v108, v140
    v_exp_f32 v109, v141
    v_exp_f32 v110, v142
    v_mfma_f32_32x32x16_bf16 v[124:139], v[160:163], v[196:199], v[124:139]
    v_exp_f32 v111, v143
    v_exp_f32 v112, v144
    v_exp_f32 v113, v145
    v_mfma_f32_32x32x16_bf16 v[124:139], v[164:167], v[200:203], v[124:139]
    v_exp_f32 v114, v146
    v_exp_f32 v115, v147
    v_exp_f32 v116, v148
    v_mfma_f32_32x32x16_bf16 v[124:139], v[168:171], v[204:207], v[124:139]
    v_exp_f32 v117, v149
    v_exp_f32 v118, v150
    v_exp_f32 v119, v151
    v_mfma_f32_32x32x16_bf16 v[124:139], v[172:175], v[176:179], v[124:139]
    v_exp_f32 v120, v152
    v_exp_f32 v121, v153
    v_exp_f32 v122, v154
    v_exp_f32 v123, v155
    v_lshrrev_b32 v11, 16, v12
    v_add_u32 v6, 512, v6
LASTJ6_1:
    v_pk_fma_f32 v[74:75], v[104:105], v[108:109], v[104:105]
    v_pk_fma_f32 v[104:105], v[140:141], v[106:107], v[74:75]
    v_pk_fma_f32 v[106:107], v[106:107], v[108:109], v[106:107]
    v_pk_fma_f32 v[74:75], v[104:105], v[110:111], v[104:105]
    v_pk_fma_f32 v[104:105], v[142:143], v[106:107], v[74:75]
    v_pk_fma_f32 v[106:107], v[106:107], v[110:111], v[106:107]
    v_pk_fma_f32 v[74:75], v[104:105], v[112:113], v[104:105]
    v_pk_fma_f32 v[104:105], v[144:145], v[106:107], v[74:75]
    v_pk_fma_f32 v[106:107], v[106:107], v[112:113], v[106:107]
    v_pk_fma_f32 v[74:75], v[104:105], v[114:115], v[104:105]
    v_pk_fma_f32 v[104:105], v[146:147], v[106:107], v[74:75]
    v_pk_fma_f32 v[106:107], v[106:107], v[114:115], v[106:107]
    v_pk_fma_f32 v[74:75], v[104:105], v[116:117], v[104:105]
    v_pk_fma_f32 v[104:105], v[148:149], v[106:107], v[74:75]
    v_pk_fma_f32 v[106:107], v[106:107], v[116:117], v[106:107]
    v_pk_fma_f32 v[74:75], v[104:105], v[118:119], v[104:105]
    v_pk_fma_f32 v[88:89], v[150:151], v[106:107], v[74:75]
    v_pk_fma_f32 v[90:91], v[106:107], v[118:119], v[106:107]
    v_pk_fma_f32 v[106:107], v[120:121], s[16:17], s[16:17]
    v_pk_mul_f32 v[104:105], v[152:153], s[16:17]
    v_pk_fma_f32 v[74:75], v[104:105], v[122:123], v[104:105]
    v_pk_fma_f32 v[104:105], v[154:155], v[106:107], v[74:75]
    v_pk_fma_f32 v[106:107], v[106:107], v[122:123], v[106:107]
    s_branch M_FLUSH1
    .p2align 6
M_V7_1:
    v_mfma_f32_32x32x16_bf16 v[140:155], v[34:37], v[208:211], 0
    v_exp_f32 v108, v124
    v_exp_f32 v109, v125
    v_exp_f32 v110, v126
    v_mfma_f32_32x32x16_bf16 v[140:155], v[38:41], v[212:215], v[140:155]
    v_exp_f32 v111, v127
    v_exp_f32 v112, v128
    v_exp_f32 v113, v129
    v_mfma_f32_32x32x16_bf16 v[140:155], v[42:45], v[216:219], v[140:155]
    v_exp_f32 v114, v130
    v_exp_f32 v115, v131
    v_exp_f32 v116, v132
    v_mfma_f32_32x32x16_bf16 v[140:155], v[46:49], v[220:223], v[140:155]
    v_exp_f32 v117, v133
    v_exp_f32 v118, v134
    v_exp_f32 v119, v135
    v_mfma_f32_32x32x16_bf16 v[140:155], v[172:175], v[180:183], v[140:155]
    v_exp_f32 v120, v136
    v_exp_f32 v121, v137
    v_exp_f32 v122, v138
    v_exp_f32 v123, v139
    v_pk_fma_f32 v[74:75], v[92:93], v[108:109], v[92:93]
    v_pk_fma_f32 v[92:93], v[124:125], v[94:95], v[74:75]
    ds_read_b32 v12, v8 offset:3456
    v_pk_fma_f32 v[94:95], v[94:95], v[108:109], v[94:95]
    v_pk_fma_f32 v[74:75], v[92:93], v[110:111], v[92:93]
    v_pk_fma_f32 v[92:93], v[126:127], v[94:95], v[74:75]
    v_pk_fma_f32 v[94:95], v[94:95], v[110:111], v[94:95]
    s_add_u32 s18, s6, 2
    s_and_b32 s18, s18, -2
    s_lshl_b32 s18, s18, 4
    s_add_u32 s19, s6, 1
    s_or_b32 s19, s19, 1
    s_lshl_b32 s19, s19, 4
    v_add_u32 v28, s18, v23
    v_add_u32 v29, s19, v23
    ds_read_b32 v28, v28
    ds_read_b32 v29, v29
    v_pk_fma_f32 v[74:75], v[92:93], v[112:113], v[92:93]
    v_pk_fma_f32 v[92:93], v[128:129], v[94:95], v[74:75]
    v_pk_fma_f32 v[94:95], v[94:95], v[112:113], v[94:95]
    v_pk_fma_f32 v[74:75], v[92:93], v[114:115], v[92:93]
    s_lshl_b32 s20, s6, 4
    v_add_u32 v26, s20, v24
    ds_read_b64 v[26:27], v26
    v_pk_fma_f32 v[92:93], v[130:131], v[94:95], v[74:75]
    v_pk_fma_f32 v[94:95], v[94:95], v[114:115], v[94:95]
    v_pk_fma_f32 v[74:75], v[92:93], v[116:117], v[92:93]
    v_pk_fma_f32 v[92:93], v[132:133], v[94:95], v[74:75]
    v_pk_fma_f32 v[94:95], v[94:95], v[116:117], v[94:95]
    v_pk_fma_f32 v[74:75], v[92:93], v[118:119], v[92:93]
    v_pk_fma_f32 v[92:93], v[134:135], v[94:95], v[74:75]
    v_pk_fma_f32 v[94:95], v[94:95], v[118:119], v[94:95]
    v_pk_fma_f32 v[74:75], v[92:93], v[120:121], v[92:93]
    v_pk_fma_f32 v[76:77], v[136:137], v[94:95], v[74:75]
    v_pk_fma_f32 v[78:79], v[94:95], v[120:121], v[94:95]
    v_pk_fma_f32 v[94:95], v[122:123], s[16:17], s[16:17]
    v_pk_mul_f32 v[92:93], v[138:139], s[16:17]
    s_waitcnt lgkmcnt(0)
    v_mfma_f32_32x32x16_bf16 v[124:139], v[34:37], v[224:227], 0
    v_exp_f32 v108, v140
    v_exp_f32 v109, v141
    v_exp_f32 v110, v142
    v_mfma_f32_32x32x16_bf16 v[124:139], v[38:41], v[228:231], v[124:139]
    v_exp_f32 v111, v143
    v_exp_f32 v112, v144
    v_exp_f32 v113, v145
    v_mfma_f32_32x32x16_bf16 v[124:139], v[42:45], v[232:235], v[124:139]
    v_exp_f32 v114, v146
    v_exp_f32 v115, v147
    v_exp_f32 v116, v148
    v_mfma_f32_32x32x16_bf16 v[124:139], v[46:49], v[236:239], v[124:139]
    v_exp_f32 v117, v149
    v_exp_f32 v118, v150
    v_exp_f32 v119, v151
    v_mfma_f32_32x32x16_bf16 v[124:139], v[172:175], v[184:187], v[124:139]
    v_exp_f32 v120, v152
    v_exp_f32 v121, v153
    v_exp_f32 v122, v154
    v_exp_f32 v123, v155
    v_mad_u32_u16 v13, v12, s11, v9
    v_pk_fma_f32 v[74:75], v[96:97], v[108:109], v[96:97]
    v_pk_fma_f32 v[96:97], v[140:141], v[98:99], v[74:75]
    s_mov_b64 exec, s[12:13]
    v_add_u32 v21, v28, v20
    v_add_u32 v22, v29, v20
    s_mov_b64 exec, -1
    v_pk_fma_f32 v[98:99], v[98:99], v[108:109], v[98:99]
    v_pk_fma_f32 v[74:75], v[96:97], v[110:111], v[96:97]
    ds_read_b64_tr_b16 v[176:177], v21 offset:0
    ds_read_b64_tr_b16 v[178:179], v22 offset:0
    v_pk_fma_f32 v[96:97], v[142:143], v[98:99], v[74:75]
    v_pk_fma_f32 v[98:99], v[98:99], v[110:111], v[98:99]
    v_pk_fma_f32 v[74:75], v[96:97], v[112:113], v[96:97]
    ds_read_b64_tr_b16 v[180:181], v21 offset:64
    ds_read_b64_tr_b16 v[182:183], v22 offset:64
    v_pk_fma_f32 v[96:97], v[144:145], v[98:99], v[74:75]
    v_pk_fma_f32 v[98:99], v[98:99], v[112:113], v[98:99]
    v_pk_fma_f32 v[74:75], v[96:97], v[114:115], v[96:97]
    ds_read_b64_tr_b16 v[184:185], v21 offset:128
    ds_read_b64_tr_b16 v[186:187], v22 offset:128
    v_pk_fma_f32 v[96:97], v[146:147], v[98:99], v[74:75]
    v_pk_fma_f32 v[98:99], v[98:99], v[114:115], v[98:99]
    v_pk_fma_f32 v[74:75], v[96:97], v[116:117], v[96:97]
    v_pk_fma_f32 v[96:97], v[148:149], v[98:99], v[74:75]
    v_pk_fma_f32 v[98:99], v[98:99], v[116:117], v[98:99]
    v_pk_fma_f32 v[74:75], v[96:97], v[118:119], v[96:97]
    v_pk_fma_f32 v[96:97], v[150:151], v[98:99], v[74:75]
    v_pk_fma_f32 v[98:99], v[98:99], v[118:119], v[98:99]
    v_pk_fma_f32 v[74:75], v[96:97], v[120:121], v[96:97]
    v_pk_fma_f32 v[80:81], v[152:153], v[98:99], v[74:75]
    v_pk_fma_f32 v[82:83], v[98:99], v[120:121], v[98:99]
    v_pk_fma_f32 v[98:99], v[122:123], s[16:17], s[16:17]
    v_pk_mul_f32 v[96:97], v[154:155], s[16:17]
    v_mfma_f32_32x32x16_bf16 v[140:155], v[34:37], v[240:243], 0
    v_exp_f32 v108, v124
    v_exp_f32 v109, v125
    v_exp_f32 v110, v126
    v_mfma_f32_32x32x16_bf16 v[140:155], v[38:41], v[244:247], v[140:155]
    v_exp_f32 v111, v127
    v_exp_f32 v112, v128
    v_exp_f32 v113, v129
    v_mfma_f32_32x32x16_bf16 v[140:155], v[42:45], v[248:251], v[140:155]
    v_exp_f32 v114, v130
    v_exp_f32 v115, v131
    v_exp_f32 v116, v132
    v_mfma_f32_32x32x16_bf16 v[140:155], v[46:49], v[252:255], v[140:155]
    v_exp_f32 v117, v133
    v_exp_f32 v118, v134
    v_exp_f32 v119, v135
    v_mfma_f32_32x32x16_bf16 v[140:155], v[172:175], v[188:191], v[140:155]
    v_exp_f32 v120, v136
    v_exp_f32 v121, v137
    v_exp_f32 v122, v138
    v_exp_f32 v123, v139
    v_add_u32 v8, 256, v8
    s_mov_b64 exec, s[12:13]
    ds_read_b128 v[172:175], v11
    s_mov_b64 exec, s[14:15]
    ds_read2_b64 v[172:175], v6 offset0:32 offset1:32
    s_mov_b64 exec, -1
    s_cmp_ge_u32 s4, s92
    v_pk_fma_f32 v[74:75], v[100:101], v[108:109], v[100:101]
    v_pk_fma_f32 v[100:101], v[124:125], v[102:103], v[74:75]
    ds_read_b64_tr_b16 v[188:189], v21 offset:192
    ds_read_b64_tr_b16 v[190:191], v22 offset:192
    v_pk_fma_f32 v[102:103], v[102:103], v[108:109], v[102:103]
    v_pk_fma_f32 v[74:75], v[100:101], v[110:111], v[100:101]
    s_waitcnt vmcnt(0)
    s_cbranch_scc1 NOLD7_1
    buffer_load_dwordx4 v[34:37], v13, s[28:31], 0 offen offset:0
    buffer_load_dwordx4 v[38:41], v13, s[28:31], 0 offen offset:16
    buffer_load_dwordx4 v[42:45], v13, s[28:31], 0 offen offset:32
    buffer_load_dwordx4 v[46:49], v13, s[28:31], 0 offen offset:48
NOLD7_1:
    v_pk_fma_f32 v[100:101], v[126:127], v[102:103], v[74:75]
    v_pk_fma_f32 v[102:103], v[102:103], v[110:111], v[102:103]
    v_pk_fma_f32 v[74:75], v[100:101], v[112:113], v[100:101]
    v_pk_fma_f32 v[100:101], v[128:129], v[102:103], v[74:75]
    v_pk_fma_f32 v[102:103], v[102:103], v[112:113], v[102:103]
    v_pk_fma_f32 v[74:75], v[100:101], v[114:115], v[100:101]
    v_pk_fma_f32 v[100:101], v[130:131], v[102:103], v[74:75]
    v_pk_fma_f32 v[102:103], v[102:103], v[114:115], v[102:103]
    v_pk_fma_f32 v[74:75], v[100:101], v[116:117], v[100:101]
    v_pk_fma_f32 v[100:101], v[132:133], v[102:103], v[74:75]
    v_pk_fma_f32 v[102:103], v[102:103], v[116:117], v[102:103]
    v_pk_fma_f32 v[74:75], v[100:101], v[118:119], v[100:101]
    v_pk_fma_f32 v[100:101], v[134:135], v[102:103], v[74:75]
    v_pk_fma_f32 v[102:103], v[102:103], v[118:119], v[102:103]
    v_pk_fma_f32 v[74:75], v[100:101], v[120:121], v[100:101]
    v_pk_fma_f32 v[84:85], v[136:137], v[102:103], v[74:75]
    v_pk_fma_f32 v[86:87], v[102:103], v[120:121], v[102:103]
    v_pk_fma_f32 v[102:103], v[122:123], s[16:17], s[16:17]
    v_pk_mul_f32 v[100:101], v[138:139], s[16:17]
    s_waitcnt lgkmcnt(0)
    s_cmp_ge_u32 s4, s88
    s_cbranch_scc1 LAST7_1
    v_mfma_f32_32x32x16_bf16 v[124:139], v[156:159], v[192:195], 0
    v_exp_f32 v108, v140
    v_exp_f32 v109, v141
    v_exp_f32 v110, v142
    v_mfma_f32_32x32x16_bf16 v[124:139], v[160:163], v[196:199], v[124:139]
    v_exp_f32 v111, v143
    v_exp_f32 v112, v144
    v_exp_f32 v113, v145
    v_mfma_f32_32x32x16_bf16 v[124:139], v[164:167], v[200:203], v[124:139]
    v_exp_f32 v114, v146
    v_exp_f32 v115, v147
    v_exp_f32 v116, v148
    v_mfma_f32_32x32x16_bf16 v[124:139], v[168:171], v[204:207], v[124:139]
    v_exp_f32 v117, v149
    v_exp_f32 v118, v150
    v_exp_f32 v119, v151
    v_mfma_f32_32x32x16_bf16 v[124:139], v[172:175], v[176:179], v[124:139]
    v_exp_f32 v120, v152
    v_exp_f32 v121, v153
    v_exp_f32 v122, v154
    v_exp_f32 v123, v155
    v_lshrrev_b32 v11, 16, v12
    v_add_u32 v6, 512, v6
LASTJ7_1:
    v_pk_fma_f32 v[74:75], v[104:105], v[108:109], v[104:105]
    v_pk_fma_f32 v[104:105], v[140:141], v[106:107], v[74:75]
    v_pk_fma_f32 v[106:107], v[106:107], v[108:109], v[106:107]
    v_pk_fma_f32 v[74:75], v[104:105], v[110:111], v[104:105]
    v_pk_fma_f32 v[104:105], v[142:143], v[106:107], v[74:75]
    v_pk_fma_f32 v[106:107], v[106:107], v[110:111], v[106:107]
    v_pk_fma_f32 v[74:75], v[104:105], v[112:113], v[104:105]
    v_pk_fma_f32 v[104:105], v[144:145], v[106:107], v[74:75]
    v_pk_fma_f32 v[106:107], v[106:107], v[112:113], v[106:107]
    v_pk_fma_f32 v[74:75], v[104:105], v[114:115], v[104:105]
    v_pk_fma_f32 v[104:105], v[146:147], v[106:107], v[74:75]
    v_pk_fma_f32 v[106:107], v[106:107], v[114:115], v[106:107]
    v_pk_fma_f32 v[74:75], v[104:105], v[116:117], v[104:105]
    v_pk_fma_f32 v[104:105], v[148:149], v[106:107], v[74:75]
    v_pk_fma_f32 v[106:107], v[106:107], v[116:117], v[106:107]
    v_pk_fma_f32 v[74:75], v[104:105], v[118:119], v[104:105]
    v_pk_fma_f32 v[104:105], v[150:151], v[106:107], v[74:75]
    v_pk_fma_f32 v[106:107], v[106:107], v[118:119], v[106:107]
    v_pk_fma_f32 v[74:75], v[104:105], v[120:121], v[104:105]
    v_pk_fma_f32 v[88:89], v[152:153], v[106:107], v[74:75]
    v_pk_fma_f32 v[90:91], v[106:107], v[120:121], v[106:107]
    v_pk_fma_f32 v[106:107], v[122:123], s[16:17], s[16:17]
    v_pk_mul_f32 v[104:105], v[154:155], s[16:17]
    s_branch M_FLUSH1
    .p2align 6
M_V8_1:
    v_mfma_f32_32x32x16_bf16 v[140:155], v[34:37], v[208:211], 0
    v_exp_f32 v108, v124
    v_exp_f32 v109, v125
    v_exp_f32 v110, v126
    v_mfma_f32_32x32x16_bf16 v[140:155], v[38:41], v[212:215], v[140:155]
    v_exp_f32 v111, v127
    v_exp_f32 v112, v128
    v_exp_f32 v113, v129
    v_mfma_f32_32x32x16_bf16 v[140:155], v[42:45], v[216:219], v[140:155]
    v_exp_f32 v114, v130
    v_exp_f32 v115, v131
    v_exp_f32 v116, v132
    v_mfma_f32_32x32x16_bf16 v[140:155], v[46:49], v[220:223], v[140:155]
    v_exp_f32 v117, v133
    v_exp_f32 v118, v134
    v_exp_f32 v119, v135
    v_mfma_f32_32x32x16_bf16 v[140:155], v[172:175], v[180:183], v[140:155]
    v_exp_f32 v120, v136
    v_exp_f32 v121, v137
    v_exp_f32 v122, v138
    v_exp_f32 v123, v139
    v_pk_fma_f32 v[74:75], v[92:93], v[108:109], v[92:93]
    v_pk_fma_f32 v[92:93], v[124:125], v[94:95], v[74:75]
    ds_read_b32 v12, v8 offset:3456
    v_pk_fma_f32 v[94:95], v[94:95], v[108:109], v[94:95]
    v_pk_fma_f32 v[74:75], v[92:93], v[110:111], v[92:93]
    v_pk_fma_f32 v[92:93], v[126:127], v[94:95], v[74:75]
    v_pk_fma_f32 v[94:95], v[94:95], v[110:111], v[94:95]
    s_add_u32 s18, s6, 2
    s_and_b32 s18, s18, -2
    s_lshl_b32 s18, s18, 4
    s_add_u32 s19, s6, 1
    s_or_b32 s19, s19, 1
    s_lshl_b32 s19, s19, 4
    v_add_u32 v28, s18, v23
    v_add_u32 v29, s19, v23
    ds_read_b32 v28, v28
    ds_read_b32 v29, v29
    v_pk_fma_f32 v[74:75], v[92:93], v[112:113], v[92:93]
    v_pk_fma_f32 v[92:93], v[128:129], v[94:95], v[74:75]
    v_pk_fma_f32 v[94:95], v[94:95], v[112:113], v[94:95]
    v_pk_fma_f32 v[74:75], v[92:93], v[114:115], v[92:93]
    s_lshl_b32 s20, s6, 4
    v_add_u32 v26, s20, v24
    ds_read_b64 v[26:27], v26
    v_pk_fma_f32 v[92:93], v[130:131], v[94:95], v[74:75]
    v_pk_fma_f32 v[94:95], v[94:95], v[114:115], v[94:95]
    v_pk_fma_f32 v[74:75], v[92:93], v[116:117], v[92:93]
    v_pk_fma_f32 v[92:93], v[132:133], v[94:95], v[74:75]
    v_pk_fma_f32 v[94:95], v[94:95], v[116:117], v[94:95]
    v_pk_fma_f32 v[74:75], v[92:93], v[118:119], v[92:93]
    v_pk_fma_f32 v[92:93], v[134:135], v[94:95], v[74:75]
    v_pk_fma_f32 v[94:95], v[94:95], v[118:119], v[94:95]
    v_pk_fma_f32 v[74:75], v[92:93], v[120:121], v[92:93]
    v_pk_fma_f32 v[92:93], v[136:137], v[94:95], v[74:75]
    v_pk_fma_f32 v[94:95], v[94:95], v[120:121], v[94:95]
    v_pk_fma_f32 v[74:75], v[92:93], v[122:123], v[92:93]
    v_pk_fma_f32 v[76:77], v[138:139], v[94:95], v[74:75]
    v_pk_fma_f32 v[78:79], v[94:95], v[122:123], v[94:95]
    v_mov_b64 v[92:93], 0
    v_mov_b64 v[94:95], s[16:17]
    s_waitcnt lgkmcnt(0)
    v_mfma_f32_32x32x16_bf16 v[124:139], v[34:37], v[224:227], 0
    v_exp_f32 v108, v140
    v_exp_f32 v109, v141
    v_exp_f32 v110, v142
    v_mfma_f32_32x32x16_bf16 v[124:139], v[38:41], v[228:231], v[124:139]
    v_exp_f32 v111, v143
    v_exp_f32 v112, v144
    v_exp_f32 v113, v145
    v_mfma_f32_32x32x16_bf16 v[124:139], v[42:45], v[232:235], v[124:139]
    v_exp_f32 v114, v146
    v_exp_f32 v115, v147
    v_exp_f32 v116, v148
    v_mfma_f32_32x32x16_bf16 v[124:139], v[46:49], v[236:239], v[124:139]
    v_exp_f32 v117, v149
    v_exp_f32 v118, v150
    v_exp_f32 v119, v151
    v_mfma_f32_32x32x16_bf16 v[124:139], v[172:175], v[184:187], v[124:139]
    v_exp_f32 v120, v152
    v_exp_f32 v121, v153
    v_exp_f32 v122, v154
    v_exp_f32 v123, v155
    v_mad_u32_u16 v13, v12, s11, v9
    v_pk_fma_f32 v[74:75], v[96:97], v[108:109], v[96:97]
    v_pk_fma_f32 v[96:97], v[140:141], v[98:99], v[74:75]
    s_mov_b64 exec, s[12:13]
    v_add_u32 v21, v28, v20
    v_add_u32 v22, v29, v20
    s_mov_b64 exec, -1
    v_pk_fma_f32 v[98:99], v[98:99], v[108:109], v[98:99]
    v_pk_fma_f32 v[74:75], v[96:97], v[110:111], v[96:97]
    ds_read_b64_tr_b16 v[176:177], v21 offset:0
    ds_read_b64_tr_b16 v[178:179], v22 offset:0
    v_pk_fma_f32 v[96:97], v[142:143], v[98:99], v[74:75]
    v_pk_fma_f32 v[98:99], v[98:99], v[110:111], v[98:99]
    v_pk_fma_f32 v[74:75], v[96:97], v[112:113], v[96:97]
    ds_read_b64_tr_b16 v[180:181], v21 offset:64
    ds_read_b64_tr_b16 v[182:183], v22 offset:64
    v_pk_fma_f32 v[96:97], v[144:145], v[98:99], v[74:75]
    v_pk_fma_f32 v[98:99], v[98:99], v[112:113], v[98:99]
    v_pk_fma_f32 v[74:75], v[96:97], v[114:115], v[96:97]
    ds_read_b64_tr_b16 v[184:185], v21 offset:128
    ds_read_b64_tr_b16 v[186:187], v22 offset:128
    v_pk_fma_f32 v[96:97], v[146:147], v[98:99], v[74:75]
    v_pk_fma_f32 v[98:99], v[98:99], v[114:115], v[98:99]
    v_pk_fma_f32 v[74:75], v[96:97], v[116:117], v[96:97]
    v_pk_fma_f32 v[96:97], v[148:149], v[98:99], v[74:75]
    v_pk_fma_f32 v[98:99], v[98:99], v[116:117], v[98:99]
    v_pk_fma_f32 v[74:75], v[96:97], v[118:119], v[96:97]
    v_pk_fma_f32 v[96:97], v[150:151], v[98:99], v[74:75]
    v_pk_fma_f32 v[98:99], v[98:99], v[118:119], v[98:99]
    v_pk_fma_f32 v[74:75], v[96:97], v[120:121], v[96:97]
    v_pk_fma_f32 v[96:97], v[152:153], v[98:99], v[74:75]
    v_pk_fma_f32 v[98:99], v[98:99], v[120:121], v[98:99]
    v_pk_fma_f32 v[74:75], v[96:97], v[122:123], v[96:97]
    v_pk_fma_f32 v[80:81], v[154:155], v[98:99], v[74:75]
    v_pk_fma_f32 v[82:83], v[98:99], v[122:123], v[98:99]
    v_mov_b64 v[96:97], 0
    v_mov_b64 v[98:99], s[16:17]
    v_mfma_f32_32x32x16_bf16 v[140:155], v[34:37], v[240:243], 0
    v_exp_f32 v108, v124
    v_exp_f32 v109, v125
    v_exp_f32 v110, v126
    v_mfma_f32_32x32x16_bf16 v[140:155], v[38:41], v[244:247], v[140:155]
    v_exp_f32 v111, v127
    v_exp_f32 v112, v128
    v_exp_f32 v113, v129
    v_mfma_f32_32x32x16_bf16 v[140:155], v[42:45], v[248:251], v[140:155]
    v_exp_f32 v114, v130
    v_exp_f32 v115, v131
    v_exp_f32 v116, v132
    v_mfma_f32_32x32x16_bf16 v[140:155], v[46:49], v[252:255], v[140:155]
    v_exp_f32 v117, v133
    v_exp_f32 v118, v134
    v_exp_f32 v119, v135
    v_mfma_f32_32x32x16_bf16 v[140:155], v[172:175], v[188:191], v[140:155]
    v_exp_f32 v120, v136
    v_exp_f32 v121, v137
    v_exp_f32 v122, v138
    v_exp_f32 v123, v139
    v_add_u32 v8, 256, v8
    s_mov_b64 exec, s[12:13]
    ds_read_b128 v[172:175], v11
    s_mov_b64 exec, s[14:15]
    ds_read2_b64 v[172:175], v6 offset0:32 offset1:32
    s_mov_b64 exec, -1
    s_cmp_ge_u32 s4, s92
    v_pk_fma_f32 v[74:75], v[100:101], v[108:109], v[100:101]
    v_pk_fma_f32 v[100:101], v[124:125], v[102:103], v[74:75]
    ds_read_b64_tr_b16 v[188:189], v21 offset:192
    ds_read_b64_tr_b16 v[190:191], v22 offset:192
    v_pk_fma_f32 v[102:103], v[102:103], v[108:109], v[102:103]
    v_pk_fma_f32 v[74:75], v[100:101], v[110:111], v[100:101]
    s_waitcnt vmcnt(0)
    s_cbranch_scc1 NOLD8_1
    buffer_load_dwordx4 v[34:37], v13, s[28:31], 0 offen offset:0
    buffer_load_dwordx4 v[38:41], v13, s[28:31], 0 offen offset:16
    buffer_load_dwordx4 v[42:45], v13, s[28:31], 0 offen offset:32
    buffer_load_dwordx4 v[46:49], v13, s[28:31], 0 offen offset:48
NOLD8_1:
    v_pk_fma_f32 v[100:101], v[126:127], v[102:103], v[74:75]
    v_pk_fma_f32 v[102:103], v[102:103], v[110:111], v[102:103]
    v_pk_fma_f32 v[74:75], v[100:101], v[112:113], v[100:101]
    v_pk_fma_f32 v[100:101], v[128:129], v[102:103], v[74:75]
    v_pk_fma_f32 v[102:103], v[102:103], v[112:113], v[102:103]
    v_pk_fma_f32 v[74:75], v[100:101], v[114:115], v[100:101]
    v_pk_fma_f32 v[100:101], v[130:131], v[102:103], v[74:75]
    v_pk_fma_f32 v[102:103], v[102:103], v[114:115], v[102:103]
    v_pk_fma_f32 v[74:75], v[100:101], v[116:117], v[100:101]
    v_pk_fma_f32 v[100:101], v[132:133], v[102:103], v[74:75]
    v_pk_fma_f32 v[102:103], v[102:103], v[116:117], v[102:103]
    v_pk_fma_f32 v[74:75], v[100:101], v[118:119], v[100:101]
    v_pk_fma_f32 v[100:101], v[134:135], v[102:103], v[74:75]
    v_pk_fma_f32 v[102:103], v[102:103], v[118:119], v[102:103]
    v_pk_fma_f32 v[74:75], v[100:101], v[120:121], v[100:101]
    v_pk_fma_f32 v[100:101], v[136:137], v[102:103], v[74:75]
    v_pk_fma_f32 v[102:103], v[102:103], v[120:121], v[102:103]
    v_pk_fma_f32 v[74:75], v[100:101], v[122:123], v[100:101]
    v_pk_fma_f32 v[84:85], v[138:139], v[102:103], v[74:75]
    v_pk_fma_f32 v[86:87], v[102:103], v[122:123], v[102:103]
    v_mov_b64 v[100:101], 0
    v_mov_b64 v[102:103], s[16:17]
    s_waitcnt lgkmcnt(0)
    s_cmp_ge_u32 s4, s88
    s_cbranch_scc1 LAST8_1
    v_mfma_f32_32x32x16_bf16 v[124:139], v[156:159], v[192:195], 0
    v_exp_f32 v108, v140
    v_exp_f32 v109, v141
    v_exp_f32 v110, v142
    v_mfma_f32_32x32x16_bf16 v[124:139], v[160:163], v[196:199], v[124:139]
    v_exp_f32 v111, v143
    v_exp_f32 v112, v144
    v_exp_f32 v113, v145
    v_mfma_f32_32x32x16_bf16 v[124:139], v[164:167], v[200:203], v[124:139]
    v_exp_f32 v114, v146
    v_exp_f32 v115, v147
    v_exp_f32 v116, v148
    v_mfma_f32_32x32x16_bf16 v[124:139], v[168:171], v[204:207], v[124:139]
    v_exp_f32 v117, v149
    v_exp_f32 v118, v150
    v_exp_f32 v119, v151
    v_mfma_f32_32x32x16_bf16 v[124:139], v[172:175], v[176:179], v[124:139]
    v_exp_f32 v120, v152
    v_exp_f32 v121, v153
    v_exp_f32 v122, v154
    v_exp_f32 v123, v155
    v_lshrrev_b32 v11, 16, v12
    v_add_u32 v6, 512, v6
LASTJ8_1:
    v_pk_fma_f32 v[74:75], v[104:105], v[108:109], v[104:105]
    v_pk_fma_f32 v[104:105], v[140:141], v[106:107], v[74:75]
    v_pk_fma_f32 v[106:107], v[106:107], v[108:109], v[106:107]
    v_pk_fma_f32 v[74:75], v[104:105], v[110:111], v[104:105]
    v_pk_fma_f32 v[104:105], v[142:143], v[106:107], v[74:75]
    v_pk_fma_f32 v[106:107], v[106:107], v[110:111], v[106:107]
    v_pk_fma_f32 v[74:75], v[104:105], v[112:113], v[104:105]
    v_pk_fma_f32 v[104:105], v[144:145], v[106:107], v[74:75]
    v_pk_fma_f32 v[106:107], v[106:107], v[112:113], v[106:107]
    v_pk_fma_f32 v[74:75], v[104:105], v[114:115], v[104:105]
    v_pk_fma_f32 v[104:105], v[146:147], v[106:107], v[74:75]
    v_pk_fma_f32 v[106:107], v[106:107], v[114:115], v[106:107]
    v_pk_fma_f32 v[74:75], v[104:105], v[116:117], v[104:105]
    v_pk_fma_f32 v[104:105], v[148:149], v[106:107], v[74:75]
    v_pk_fma_f32 v[106:107], v[106:107], v[116:117], v[106:107]
    v_pk_fma_f32 v[74:75], v[104:105], v[118:119], v[104:105]
    v_pk_fma_f32 v[104:105], v[150:151], v[106:107], v[74:75]
    v_pk_fma_f32 v[106:107], v[106:107], v[118:119], v[106:107]
    v_pk_fma_f32 v[74:75], v[104:105], v[120:121], v[104:105]
    v_pk_fma_f32 v[104:105], v[152:153], v[106:107], v[74:75]
    v_pk_fma_f32 v[106:107], v[106:107], v[120:121], v[106:107]
    v_pk_fma_f32 v[74:75], v[104:105], v[122:123], v[104:105]
    v_pk_fma_f32 v[88:89], v[154:155], v[106:107], v[74:75]
    v_pk_fma_f32 v[90:91], v[106:107], v[122:123], v[106:107]
    v_mov_b64 v[104:105], 0
    v_mov_b64 v[106:107], s[16:17]
    s_branch M_FLUSH1
LAST0_0:
    v_exp_f32 v108, v140
    v_exp_f32 v109, v141
    v_exp_f32 v110, v142
    v_exp_f32 v111, v143
    v_exp_f32 v112, v144
    v_exp_f32 v113, v145
    v_exp_f32 v114, v146
    v_exp_f32 v115, v147
    v_exp_f32 v116, v148
    v_exp_f32 v117, v149
    v_exp_f32 v118, v150
    v_exp_f32 v119, v151
    v_exp_f32 v120, v152
    v_exp_f32 v121, v153
    v_exp_f32 v122, v154
    v_exp_f32 v123, v155
    s_branch LASTJ0_0
LAST0_1:
    v_exp_f32 v108, v140
    v_exp_f32 v109, v141
    v_exp_f32 v110, v142
    v_exp_f32 v111, v143
    v_exp_f32 v112, v144
    v_exp_f32 v113, v145
    v_exp_f32 v114, v146
    v_exp_f32 v115, v147
    v_exp_f32 v116, v148
    v_exp_f32 v117, v149
    v_exp_f32 v118, v150
    v_exp_f32 v119, v151
    v_exp_f32 v120, v152
    v_exp_f32 v121, v153
    v_exp_f32 v122, v154
    v_exp_f32 v123, v155
    s_branch LASTJ0_1
LAST1_0:
    v_exp_f32 v108, v140
    v_exp_f32 v109, v141
    v_exp_f32 v110, v142
    v_exp_f32 v111, v143
    v_exp_f32 v112, v144
    v_exp_f32 v113, v145
    v_exp_f32 v114, v146
    v_exp_f32 v115, v147
    v_exp_f32 v116, v148
    v_exp_f32 v117, v149
    v_exp_f32 v118, v150
    v_exp_f32 v119, v151
    v_exp_f32 v120, v152
    v_exp_f32 v121, v153
    v_exp_f32 v122, v154
    v_exp_f32 v123, v155
    s_branch LASTJ1_0
LAST2_0:
    v_exp_f32 v108, v140
    v_exp_f32 v109, v141
    v_exp_f32 v110, v142
    v_exp_f32 v111, v143
    v_exp_f32 v112, v144
    v_exp_f32 v113, v145
    v_exp_f32 v114, v146
    v_exp_f32 v115, v147
    v_exp_f32 v116, v148
    v_exp_f32 v117, v149
    v_exp_f32 v118, v150
    v_exp_f32 v119, v151
    v_exp_f32 v120, v152
    v_exp_f32 v121, v153
    v_exp_f32 v122, v154
    v_exp_f32 v123, v155
    s_branch LASTJ2_0
LAST3_0:
    v_exp_f32 v108, v140
    v_exp_f32 v109, v141
    v_exp_f32 v110, v142
    v_exp_f32 v111, v143
    v_exp_f32 v112, v144
    v_exp_f32 v113, v145
    v_exp_f32 v114, v146
    v_exp_f32 v115, v147
    v_exp_f32 v116, v148
    v_exp_f32 v117, v149
    v_exp_f32 v118, v150
    v_exp_f32 v119, v151
    v_exp_f32 v120, v152
    v_exp_f32 v121, v153
    v_exp_f32 v122, v154
    v_exp_f32 v123, v155
    s_branch LASTJ3_0
LAST4_0:
    v_exp_f32 v108, v140
    v_exp_f32 v109, v141
    v_exp_f32 v110, v142
    v_exp_f32 v111, v143
    v_exp_f32 v112, v144
    v_exp_f32 v113, v145
    v_exp_f32 v114, v146
    v_exp_f32 v115, v147
    v_exp_f32 v116, v148
    v_exp_f32 v117, v149
    v_exp_f32 v118, v150
    v_exp_f32 v119, v151
    v_exp_f32 v120, v152
    v_exp_f32 v121, v153
    v_exp_f32 v122, v154
    v_exp_f32 v123, v155
    s_branch LASTJ4_0
LAST5_0:
    v_exp_f32 v108, v140
    v_exp_f32 v109, v141
    v_exp_f32 v110, v142
    v_exp_f32 v111, v143
    v_exp_f32 v112, v144
    v_exp_f32 v113, v145
    v_exp_f32 v114, v146
    v_exp_f32 v115, v147
    v_exp_f32 v116, v148
    v_exp_f32 v117, v149
    v_exp_f32 v118, v150
    v_exp_f32 v119, v151
    v_exp_f32 v120, v152
    v_exp_f32 v121, v153
    v_exp_f32 v122, v154
    v_exp_f32 v123, v155
    s_branch LASTJ5_0
LAST6_0:
    v_exp_f32 v108, v140
    v_exp_f32 v109, v141
    v_exp_f32 v110, v142
    v_exp_f32 v111, v143
    v_exp_f32 v112, v144
    v_exp_f32 v113, v145
    v_exp_f32 v114, v146
    v_exp_f32 v115, v147
    v_exp_f32 v116, v148
    v_exp_f32 v117, v149
    v_exp_f32 v118, v150
    v_exp_f32 v119, v151
    v_exp_f32 v120, v152
    v_exp_f32 v121, v153
    v_exp_f32 v122, v154
    v_exp_f32 v123, v155
    s_branch LASTJ6_0
LAST7_0:
    v_exp_f32 v108, v140
    v_exp_f32 v109, v141
    v_exp_f32 v110, v142
    v_exp_f32 v111, v143
    v_exp_f32 v112, v144
    v_exp_f32 v113, v145
    v_exp_f32 v114, v146
    v_exp_f32 v115, v147
    v_exp_f32 v116, v148
    v_exp_f32 v117, v149
    v_exp_f32 v118, v150
    v_exp_f32 v119, v151
    v_exp_f32 v120, v152
    v_exp_f32 v121, v153
    v_exp_f32 v122, v154
    v_exp_f32 v123, v155
    s_branch LASTJ7_0
LAST8_0:
    v_exp_f32 v108, v140
    v_exp_f32 v109, v141
    v_exp_f32 v110, v142
    v_exp_f32 v111, v143
    v_exp_f32 v112, v144
    v_exp_f32 v113, v145
    v_exp_f32 v114, v146
    v_exp_f32 v115, v147
    v_exp_f32 v116, v148
    v_exp_f32 v117, v149
    v_exp_f32 v118, v150
    v_exp_f32 v119, v151
    v_exp_f32 v120, v152
    v_exp_f32 v121, v153
    v_exp_f32 v122, v154
    v_exp_f32 v123, v155
    s_branch LASTJ8_0
LAST1_1:
    v_exp_f32 v108, v140
    v_exp_f32 v109, v141
    v_exp_f32 v110, v142
    v_exp_f32 v111, v143
    v_exp_f32 v112, v144
    v_exp_f32 v113, v145
    v_exp_f32 v114, v146
    v_exp_f32 v115, v147
    v_exp_f32 v116, v148
    v_exp_f32 v117, v149
    v_exp_f32 v118, v150
    v_exp_f32 v119, v151
    v_exp_f32 v120, v152
    v_exp_f32 v121, v153
    v_exp_f32 v122, v154
    v_exp_f32 v123, v155
    s_branch LASTJ1_1
LAST2_1:
    v_exp_f32 v108, v140
    v_exp_f32 v109, v141
    v_exp_f32 v110, v142
    v_exp_f32 v111, v143
    v_exp_f32 v112, v144
    v_exp_f32 v113, v145
    v_exp_f32 v114, v146
    v_exp_f32 v115, v147
    v_exp_f32 v116, v148
    v_exp_f32 v117, v149
    v_exp_f32 v118, v150
    v_exp_f32 v119, v151
    v_exp_f32 v120, v152
    v_exp_f32 v121, v153
    v_exp_f32 v122, v154
    v_exp_f32 v123, v155
    s_branch LASTJ2_1
LAST3_1:
    v_exp_f32 v108, v140
    v_exp_f32 v109, v141
    v_exp_f32 v110, v142
    v_exp_f32 v111, v143
    v_exp_f32 v112, v144
    v_exp_f32 v113, v145
    v_exp_f32 v114, v146
    v_exp_f32 v115, v147
    v_exp_f32 v116, v148
    v_exp_f32 v117, v149
    v_exp_f32 v118, v150
    v_exp_f32 v119, v151
    v_exp_f32 v120, v152
    v_exp_f32 v121, v153
    v_exp_f32 v122, v154
    v_exp_f32 v123, v155
    s_branch LASTJ3_1
LAST4_1:
    v_exp_f32 v108, v140
    v_exp_f32 v109, v141
    v_exp_f32 v110, v142
    v_exp_f32 v111, v143
    v_exp_f32 v112, v144
    v_exp_f32 v113, v145
    v_exp_f32 v114, v146
    v_exp_f32 v115, v147
    v_exp_f32 v116, v148
    v_exp_f32 v117, v149
    v_exp_f32 v118, v150
    v_exp_f32 v119, v151
    v_exp_f32 v120, v152
    v_exp_f32 v121, v153
    v_exp_f32 v122, v154
    v_exp_f32 v123, v155
    s_branch LASTJ4_1
LAST5_1:
    v_exp_f32 v108, v140
    v_exp_f32 v109, v141
    v_exp_f32 v110, v142
    v_exp_f32 v111, v143
    v_exp_f32 v112, v144
    v_exp_f32 v113, v145
    v_exp_f32 v114, v146
    v_exp_f32 v115, v147
    v_exp_f32 v116, v148
    v_exp_f32 v117, v149
    v_exp_f32 v118, v150
    v_exp_f32 v119, v151
    v_exp_f32 v120, v152
    v_exp_f32 v121, v153
    v_exp_f32 v122, v154
    v_exp_f32 v123, v155
    s_branch LASTJ5_1
LAST6_1:
    v_exp_f32 v108, v140
    v_exp_f32 v109, v141
    v_exp_f32 v110, v142
    v_exp_f32 v111, v143
    v_exp_f32 v112, v144
    v_exp_f32 v113, v145
    v_exp_f32 v114, v146
    v_exp_f32 v115, v147
    v_exp_f32 v116, v148
    v_exp_f32 v117, v149
    v_exp_f32 v118, v150
    v_exp_f32 v119, v151
    v_exp_f32 v120, v152
    v_exp_f32 v121, v153
    v_exp_f32 v122, v154
    v_exp_f32 v123, v155
    s_branch LASTJ6_1
LAST7_1:
    v_exp_f32 v108, v140
    v_exp_f32 v109, v141
    v_exp_f32 v110, v142
    v_exp_f32 v111, v143
    v_exp_f32 v112, v144
    v_exp_f32 v113, v145
    v_exp_f32 v114, v146
    v_exp_f32 v115, v147
    v_exp_f32 v116, v148
    v_exp_f32 v117, v149
    v_exp_f32 v118, v150
    v_exp_f32 v119, v151
    v_exp_f32 v120, v152
    v_exp_f32 v121, v153
    v_exp_f32 v122, v154
    v_exp_f32 v123, v155
    s_branch LASTJ7_1
LAST8_1:
    v_exp_f32 v108, v140
    v_exp_f32 v109, v141
    v_exp_f32 v110, v142
    v_exp_f32 v111, v143
    v_exp_f32 v112, v144
    v_exp_f32 v113, v145
    v_exp_f32 v114, v146
    v_exp_f32 v115, v147
    v_exp_f32 v116, v148
    v_exp_f32 v117, v149
    v_exp_f32 v118, v150
    v_exp_f32 v119, v151
    v_exp_f32 v120, v152
    v_exp_f32 v121, v153
    v_exp_f32 v122, v154
    v_exp_f32 v123, v155
    s_branch LASTJ8_1
M_LOOPEXIT:
    s_waitcnt vmcnt(0)
    ds_read_b64_tr_b16 v[34:35], v2 offset:0
    ds_read_b64_tr_b16 v[36:37], v3 offset:0
    ds_read_b64_tr_b16 v[38:39], v2 offset:512
    ds_read_b64_tr_b16 v[40:41], v3 offset:512
    ds_read_b64_tr_b16 v[42:43], v2 offset:1024
    ds_read_b64_tr_b16 v[44:45], v3 offset:1024
    ds_read_b64_tr_b16 v[46:47], v2 offset:1536
    ds_read_b64_tr_b16 v[48:49], v3 offset:1536
    ds_read_b64_tr_b16 v[176:177], v2 offset:2048
    ds_read_b64_tr_b16 v[178:179], v3 offset:2048
    ds_read_b64_tr_b16 v[180:181], v2 offset:2560
    ds_read_b64_tr_b16 v[182:183], v3 offset:2560
    ds_read_b64_tr_b16 v[184:185], v2 offset:3072
    ds_read_b64_tr_b16 v[186:187], v3 offset:3072
    ds_read_b64_tr_b16 v[188:189], v2 offset:3584
    ds_read_b64_tr_b16 v[190:191], v3 offset:3584
    s_cmp_ge_u32 s6, s90
    s_cbranch_scc1 M_LOOPDONE
    v_readlane_b32 s19, v16, s6
    s_lshl_b32 s20, s6, 4
    v_add_u32 v26, s20, v24
    ds_read_b64 v[26:27], v26
    s_cmp_ge_u32 s19, s5
    s_cbranch_scc1 M_LOOPDONE
    s_lshl_b32 s18, s3, 2
    v_mov_b32 v32, s18
    ds_read_b32 v33, v32 offset:164
    ds_read_b128 v[76:79], v30 offset:2048
    ds_read_b128 v[80:83], v30 offset:2064
    v_rcp_f32 v116, v94
    v_rcp_f32 v117, v95
    v_rcp_f32 v118, v98
    v_rcp_f32 v119, v99
    v_rcp_f32 v120, v102
    v_rcp_f32 v121, v103
    v_rcp_f32 v122, v106
    v_rcp_f32 v123, v107
    v_max3_f32 v17, v17, v94, v95
    v_max3_f32 v17, v17, v98, v99
    v_max3_f32 v17, v17, v102, v103
    v_max3_f32 v17, v17, v106, v107
    v_pk_mul_f32 v[108:109], v[92:93], v[116:117]
    v_pk_mul_f32 v[110:111], v[96:97], v[118:119]
    v_pk_mul_f32 v[112:113], v[100:101], v[120:121]
    v_pk_mul_f32 v[114:115], v[104:105], v[122:123]
M_TWAIT:
    s_waitcnt lgkmcnt(0)
    v_readfirstlane_b32 s18, v33
    s_cmp_lg_u32 s18, 0
    s_cbranch_scc1 M_TGOT
    ds_read_b32 v33, v32 offset:164
    ds_read_b128 v[76:79], v30 offset:2048
    ds_read_b128 v[80:83], v30 offset:2064
    s_sub_u32 s93, s93, 1
    s_cmp_lg_u32 s93, 0
    s_cbranch_scc1 M_TWAIT
    s_endpgm
M_TGOT:
    v_pk_add_f32 v[108:109], v[108:109], v[76:77]
    v_pk_add_f32 v[110:111], v[110:111], v[78:79]
    v_pk_add_f32 v[112:113], v[112:113], v[80:81]
    v_pk_add_f32 v[114:115], v[114:115], v[82:83]
    v_pk_fma_f32 v[18:19], v[108:109], 0, v[18:19] op_sel_hi:[1,0,1]
    v_pk_fma_f32 v[18:19], v[110:111], 0, v[18:19] op_sel_hi:[1,0,1]
    v_pk_fma_f32 v[18:19], v[112:113], 0, v[18:19] op_sel_hi:[1,0,1]
    v_pk_fma_f32 v[18:19], v[114:115], 0, v[18:19] op_sel_hi:[1,0,1]
    v_cvt_pk_bf16_f32 v116, v108, v110
    v_cvt_pk_bf16_f32 v117, v112, v114
    v_add_u32 v26, v26, v25
    ds_write_b64 v26, v[116:117]
    v_cvt_pk_bf16_f32 v118, v109, v111
    v_cvt_pk_bf16_f32 v119, v113, v115
    v_add_u32 v27, v27, v25
    ds_write_b64 v27, v[118:119]
M_LOOPDONE:
    v_add_f32 v18, v18, v19
    v_add_f32 v18, v18, v17
    v_mov_b32 v32, 192
    v_mov_b32 v33, 1
    s_mov_b32 s18, 0x7b800000
    v_cmpx_ngt_f32 vcc, s18, v18
    ds_write_b32 v32, v33
    s_mov_b64 exec, -1
    ds_read_b32 v70, v68 offset:512
    ds_read_b128 v[108:111], v71 offset:256
    ds_read_b128 v[112:115], v71 offset:272
    ds_read_b128 v[116:119], v71 offset:288
    ds_read_b128 v[120:123], v71 offset:304
    s_waitcnt lgkmcnt(5)
    s_barrier
    ds_read_b32 v33, v32
    ds_read_b128 v[124:127], v67 offset:0
    ds_read_b128 v[128:131], v67 offset:32
    ds_read_b128 v[132:135], v67 offset:64
    ds_read_b128 v[136:139], v67 offset:96
    ds_read_b128 v[140:143], v67 offset:128
    ds_read_b128 v[144:147], v67 offset:160
    ds_read_b128 v[148:151], v67 offset:192
    ds_read_b128 v[152:155], v67 offset:224
    s_waitcnt lgkmcnt(8)
    v_readfirstlane_b32 s18, v33
    s_cmp_lg_u32 s18, 0
    s_cbranch_scc1 M_FALLBACK
M_EPI:
    s_waitcnt lgkmcnt(7)
    v_mfma_f32_32x32x16_bf16 v[156:171], v[34:37], v[124:127], 0
    v_lshrrev_b32 v70, 4, v70
    v_cvt_f32_u32 v70, v70
    s_waitcnt lgkmcnt(6)
    v_mfma_f32_32x32x16_bf16 v[156:171], v[38:41], v[128:131], v[156:171]
    v_mul_f32 v108, v70, v108
    v_mul_f32 v109, v70, v109
    v_mul_f32 v110, v70, v110
    v_mul_f32 v111, v70, v111
    s_waitcnt lgkmcnt(5)
    v_mfma_f32_32x32x16_bf16 v[156:171], v[42:45], v[132:135], v[156:171]
    v_mul_f32 v112, v70, v112
    v_mul_f32 v113, v70, v113
    v_mul_f32 v114, v70, v114
    v_mul_f32 v115, v70, v115
    s_waitcnt lgkmcnt(4)
    v_mfma_f32_32x32x16_bf16 v[156:171], v[46:49], v[136:139], v[156:171]
    v_mul_f32 v116, v70, v116
    v_mul_f32 v117, v70, v117
    v_mul_f32 v118, v70, v118
    v_mul_f32 v119, v70, v119
    s_waitcnt lgkmcnt(3)
    v_mfma_f32_32x32x16_bf16 v[156:171], v[176:179], v[140:143], v[156:171]
    v_mul_f32 v120, v70, v120
    v_mul_f32 v121, v70, v121
    v_mul_f32 v122, v70, v122
    v_mul_f32 v123, v70, v123
    s_waitcnt lgkmcnt(2)
    v_mfma_f32_32x32x16_bf16 v[156:171], v[180:183], v[144:147], v[156:171]
    v_lshrrev_b32 v68, 2, v1
    v_and_b32 v71, 3, v1
    v_mul_u32_u24 v70, 80, v68
    v_lshl_add_u32 v70, v71, 4, v70
    v_add_u32 v70, s9, v70
    s_waitcnt lgkmcnt(1)
    v_mfma_f32_32x32x16_bf16 v[156:171], v[184:187], v[148:151], v[156:171]
    s_lshr_b32 s20, s3, 1
    s_lshl_b32 s20, s20, 5
    s_sub_u32 s20, s89, s20
    s_sub_u32 s21, s20, 16
    v_cmp_gt_i32 vcc, s20, v68
    v_cmp_gt_i32 s[22:23], s21, v68
    s_waitcnt lgkmcnt(0)
    v_mfma_f32_32x32x16_bf16 v[156:171], v[188:191], v[152:155], v[156:171]
    s_mov_b32 s18, 0xbf317218
    s_mov_b32 s19, s18
    v_bfrev_b32 v71, 2
    v_add_u32 v68, 2048, v69
    v_cndmask_b32 v69, v71, v69, vcc
    v_cndmask_b32 v68, v71, v68, s[22:23]
    s_waitcnt vmcnt(0)
    s_nop 4
    v_pk_fma_f32 v[108:109], v[156:157], s[18:19], v[108:109]
    v_pk_fma_f32 v[110:111], v[158:159], s[18:19], v[110:111]
    v_pk_fma_f32 v[112:113], v[160:161], s[18:19], v[112:113]
    v_pk_fma_f32 v[114:115], v[162:163], s[18:19], v[114:115]
    v_cvt_pk_bf16_f32 v108, v108, v109
    v_cvt_pk_bf16_f32 v109, v110, v111
    v_cvt_pk_bf16_f32 v110, v112, v113
    v_cvt_pk_bf16_f32 v111, v114, v115
    ds_write_b128 v66, v[108:111] offset:0
    v_pk_fma_f32 v[116:117], v[164:165], s[18:19], v[116:117]
    v_pk_fma_f32 v[118:119], v[166:167], s[18:19], v[118:119]
    v_pk_fma_f32 v[120:121], v[168:169], s[18:19], v[120:121]
    v_pk_fma_f32 v[122:123], v[170:171], s[18:19], v[122:123]
    v_cvt_pk_bf16_f32 v116, v116, v117
    v_cvt_pk_bf16_f32 v117, v118, v119
    v_cvt_pk_bf16_f32 v118, v120, v121
    v_cvt_pk_bf16_f32 v119, v122, v123
    ds_write_b128 v66, v[116:119] offset:16
    ds_read_b128 v[124:127], v70
    ds_read_b128 v[128:131], v70 offset:1280
    s_waitcnt lgkmcnt(1)
    buffer_store_dwordx4 v[124:127], v69, s[32:35], 0 offen sc1
    s_waitcnt lgkmcnt(0)
    buffer_store_dwordx4 v[128:131], v68, s[32:35], 0 offen sc1
    s_endpgm
E_CHK:
    v_cmp_eq_u32 vcc, s92, v113
    s_andn2_b32 s87, vcc_lo, s86
    s_or_b32 s86, s86, vcc_lo
    s_movk_i32 s22, 4096
    v_lshrrev_b32 v139, v134, s87
    v_and_b32 v139, 1, v139
    v_cmpx_eq_u32 vcc, 1, v139
    s_cbranch_execz EPL_0
    buffer_load_dwordx4 v[76:79], v108, s[40:43], 0 offen offset:0 sc1
EPL_0:
    s_mov_b64 exec, -1
    v_lshrrev_b32 v139, v135, s87
    v_and_b32 v139, 1, v139
    v_cmpx_eq_u32 vcc, 1, v139
    s_cbranch_execz EPL_1
    buffer_load_dwordx4 v[80:83], v109, s[40:43], 0 offen offset:1024 sc1
EPL_1:
    s_mov_b64 exec, -1
    v_lshrrev_b32 v139, v136, s87
    v_and_b32 v139, 1, v139
    v_cmpx_eq_u32 vcc, 1, v139
    s_cbranch_execz EPL_2
    buffer_load_dwordx4 v[84:87], v110, s[40:43], 0 offen offset:2048 sc1
EPL_2:
    s_mov_b64 exec, -1
    v_lshrrev_b32 v139, v137, s87
    v_and_b32 v139, 1, v139
    v_cmpx_eq_u32 vcc, 1, v139
    s_cbranch_execz EPL_3
    buffer_load_dwordx4 v[88:91], v111, s[40:43], 0 offen offset:3072 sc1
EPL_3:
    s_mov_b64 exec, -1
    v_lshrrev_b32 v139, v138, s87
    v_and_b32 v139, 1, v139
    v_cmpx_eq_u32 vcc, 1, v139
    s_cbranch_execz EPL_4
    buffer_load_dwordx4 v[92:95], v112, s[40:43], s22 offen offset:0 sc1
EPL_4:
    s_mov_b64 exec, -1
    s_not_b32 exec_lo, s86
    s_cmp_eq_u32 s86, -1
    s_cbranch_scc1 E_GOT
    buffer_load_dword v113, v74, s[44:47], s97 offen sc1
    s_mov_b64 exec, -1
    s_waitcnt vmcnt(0)
    s_sub_u32 s93, s93, 1
    s_cmp_lg_u32 s93, 0
    s_cbranch_scc1 E_CHK
    s_endpgm
E_GOT:
    s_mov_b64 exec, -1
    s_waitcnt vmcnt(0)
    s_branch E_HAVE
OVF:
    v_mov_b32 v12, 192
    v_mov_b32 v13, 1
    ds_write_b32 v12, v13
    s_movk_i32 s80, 0
    s_branch NOOVF
R5_k:
    ds_read_b32 v112, v185 offset:1024
    s_sub_u32 s22, s80, 256
    v_cmp_gt_i32 s[76:77], s22, v1
    s_waitcnt lgkmcnt(0)
    s_nop 1
    v_max_u32_dpp v112, v112, v112 row_shr:1 row_mask:0xf bank_mask:0xf
    s_nop 1
    v_max_u32_dpp v112, v112, v112 row_shr:2 row_mask:0xf bank_mask:0xf
    s_nop 1
    v_max_u32_dpp v112, v112, v112 row_shr:4 row_mask:0xf bank_mask:0xf
    s_nop 1
    v_max_u32_dpp v112, v112, v112 row_shr:8 row_mask:0xf bank_mask:0xf
    s_nop 1
    v_max_u32_dpp v112, v112, v112 row_bcast:15 row_mask:0xa bank_mask:0xf
    s_nop 1
    v_max_u32_dpp v112, v112, v112 row_bcast:31 row_mask:0xc bank_mask:0xf
    v_max_u32 v112, s81, v112
    v_add_u32 v112, v112, v186
    v_cndmask_b32 v112, v187, v112, s[76:77]
    buffer_load_dwordx2 v[122:123], v112, s[36:39], 0 offen offset:2048 sc1
    v_lshlrev_b32 v112, 1, v112
    s_waitcnt vmcnt(0)
    s_mov_b64 exec, s[76:77]
    v_mad_u32_u16 v148, v122, 4, s18 op_sel:[1,0,0,0]
    v_mad_u32_u16 v149, v123, 4, s18 op_sel:[1,0,0,0]
    ds_add_rtn_u32 v104, v148, v12
    v_cmpx_gt_u32 s[78:79], s19, v149
    ds_add_rtn_u32 v105, v149, v12
    s_mov_b64 exec, -1
    s_branch R5J_k
R5_e1:
    s_movk_i32 s22, 4096
    buffer_load_dwordx4 v[92:95], v112, s[40:43], s22 offen sc1
    s_mov_b64 exec, -1
    s_branch R5J_e1
E_NOTYETw0:
    s_mov_b32 s86, vcc_lo
    s_mov_b32 s87, vcc_lo
    s_mov_b32 s22, 171197
    v_add_u32 v134, 0, v108
    v_mul_hi_u32 v134, v134, s22
    v_add_u32 v135, 1024, v109
    v_mul_hi_u32 v135, v135, s22
    v_add_u32 v136, 2048, v110
    v_mul_hi_u32 v136, v136, s22
    v_add_u32 v137, 3072, v111
    v_mul_hi_u32 v137, v137, s22
    v_add_u32 v138, 4096, v112
    v_mul_hi_u32 v138, v138, s22
    s_movk_i32 s22, 4096
    v_lshrrev_b32 v139, v134, s87
    v_and_b32 v139, 1, v139
    v_cmpx_eq_u32 vcc, 1, v139
    s_cbranch_execz EPw0_0
    buffer_load_dwordx4 v[76:79], v108, s[40:43], 0 offen offset:0 sc1
EPw0_0:
    s_mov_b64 exec, -1
    v_lshrrev_b32 v139, v135, s87
    v_and_b32 v139, 1, v139
    v_cmpx_eq_u32 vcc, 1, v139
    s_cbranch_execz EPw0_1
    buffer_load_dwordx4 v[80:83], v109, s[40:43], 0 offen offset:1024 sc1
EPw0_1:
    s_mov_b64 exec, -1
    v_lshrrev_b32 v139, v136, s87
    v_and_b32 v139, 1, v139
    v_cmpx_eq_u32 vcc, 1, v139
    s_cbranch_execz EPw0_2
    buffer_load_dwordx4 v[84:87], v110, s[40:43], 0 offen offset:2048 sc1
EPw0_2:
    s_mov_b64 exec, -1
    v_lshrrev_b32 v139, v137, s87
    v_and_b32 v139, 1, v139
    v_cmpx_eq_u32 vcc, 1, v139
    s_cbranch_execz EPw0_3
    buffer_load_dwordx4 v[88:91], v111, s[40:43], 0 offen offset:3072 sc1
EPw0_3:
    s_mov_b64 exec, -1
    v_lshrrev_b32 v139, v138, s87
    v_and_b32 v139, 1, v139
    v_cmpx_eq_u32 vcc, 1, v139
    s_cbranch_execz EPw0_4
    buffer_load_dwordx4 v[92:95], v112, s[40:43], s22 offen offset:0 sc1
EPw0_4:
    s_mov_b64 exec, -1
    s_not_b32 exec_lo, s86
    buffer_load_dword v113, v74, s[44:47], s97 offen sc1
    s_mov_b64 exec, -1
    s_branch E_Jw0
R5_e2:
    s_movk_i32 s22, 4096
    buffer_load_dwordx4 v[92:95], v112, s[40:43], s22 offen sc1
    s_mov_b64 exec, -1
    s_branch R5J_e2
E_NOTYET0:
    s_mov_b32 s86, vcc_lo
    s_mov_b32 s87, vcc_lo
    s_mov_b32 s22, 171197
    v_add_u32 v134, 0, v108
    v_mul_hi_u32 v134, v134, s22
    v_add_u32 v135, 1024, v109
    v_mul_hi_u32 v135, v135, s22
    v_add_u32 v136, 2048, v110
    v_mul_hi_u32 v136, v136, s22
    v_add_u32 v137, 3072, v111
    v_mul_hi_u32 v137, v137, s22
    v_add_u32 v138, 4096, v112
    v_mul_hi_u32 v138, v138, s22
    s_movk_i32 s22, 4096
    v_lshrrev_b32 v139, v134, s87
    v_and_b32 v139, 1, v139
    v_cmpx_eq_u32 vcc, 1, v139
    s_cbranch_execz EP0_0
    buffer_load_dwordx4 v[76:79], v108, s[40:43], 0 offen offset:0 sc1
EP0_0:
    s_mov_b64 exec, -1
    v_lshrrev_b32 v139, v135, s87
    v_and_b32 v139, 1, v139
    v_cmpx_eq_u32 vcc, 1, v139
    s_cbranch_execz EP0_1
    buffer_load_dwordx4 v[80:83], v109, s[40:43], 0 offen offset:1024 sc1
EP0_1:
    s_mov_b64 exec, -1
    v_lshrrev_b32 v139, v136, s87
    v_and_b32 v139, 1, v139
    v_cmpx_eq_u32 vcc, 1, v139
    s_cbranch_execz EP0_2
    buffer_load_dwordx4 v[84:87], v110, s[40:43], 0 offen offset:2048 sc1
EP0_2:
    s_mov_b64 exec, -1
    v_lshrrev_b32 v139, v137, s87
    v_and_b32 v139, 1, v139
    v_cmpx_eq_u32 vcc, 1, v139
    s_cbranch_execz EP0_3
    buffer_load_dwordx4 v[88:91], v111, s[40:43], 0 offen offset:3072 sc1
EP0_3:
    s_mov_b64 exec, -1
    v_lshrrev_b32 v139, v138, s87
    v_and_b32 v139, 1, v139
    v_cmpx_eq_u32 vcc, 1, v139
    s_cbranch_execz EP0_4
    buffer_load_dwordx4 v[92:95], v112, s[40:43], s22 offen offset:0 sc1
EP0_4:
    s_mov_b64 exec, -1
    s_not_b32 exec_lo, s86
    buffer_load_dword v113, v74, s[44:47], s97 offen sc1
    s_mov_b64 exec, -1
    s_branch E_J0
R5_s:
    s_mov_b64 exec, s[76:77]
    ds_read_b32 v132, v148 offset:1024
    s_mov_b64 exec, s[78:79]
    ds_read_b32 v133, v149 offset:1024
    s_waitcnt lgkmcnt(0)
    s_mov_b64 exec, s[76:77]
    v_mad_u32_u16 v104, v132, 1, v104
    v_bfi_b32 v122, s23, v122, v132
    ds_write_b32 v104, v122 offset:3328
    s_mov_b64 exec, s[78:79]
    v_mad_u32_u16 v105, v133, 1, v105
    v_bfi_b32 v123, s23, v123, v133
    ds_write_b32 v105, v123 offset:3328
    s_mov_b64 exec, -1
    s_branch R5J_s
R5_x:
    v_lshlrev_b32 v104, 1, v104
    v_lshlrev_b32 v105, 1, v105
    s_mov_b64 exec, s[76:77]
    ds_write_b64 v104, v[92:93] offset:19712
    s_mov_b64 exec, s[78:79]
    ds_write_b64 v105, v[94:95] offset:19712
    s_mov_b64 exec, -1
    s_branch R5J_x
M_FALLBACK:
    s_waitcnt vmcnt(0) lgkmcnt(0)
    s_barrier
    s_lshl_b32 s18, s3, 6
    v_add_u32 v0, s18, v1
    s_mov_b32 s12, -1
    s_mov_b32 s13, 0
    s_mov_b32 s14, 0
    s_mov_b32 s15, -1
    s_mov_b32 s16, 0x12800000
    s_mov_b32 s17, 0x12800000
    s_movk_i32 s11, 128
    s_lshl_b32 s9, s3, 12
    s_add_u32 s9, s9, 125440
    v_bfe_u32 v144, v1, 3, 2
    v_bfe_u32 v145, v1, 1, 1
    v_lshl_or_b32 v145, v144, 1, v145
    v_bfe_u32 v146, v1, 2, 1
    v_and_b32 v147, 1, v1
    v_lshl_or_b32 v146, v146, 1, v147
    v_lshrrev_b32 v149, 5, v1
    v_lshl_add_u32 v151, v145, 2, v146
    v_lshlrev_b32 v8, 2, v151
    v_lshlrev_b32 v6, 3, v151
    v_add_u32 v6, 19712, v6
    v_lshlrev_b32 v9, 6, v149
    v_bfe_u32 v151, v1, 4, 1
    v_and_b32 v152, 3, v1
    v_lshlrev_b32 v151, 5, v151
    v_lshl_add_u32 v151, v152, 3, v151
    v_add_u32 v20, 52480, v151
    v_bfe_u32 v151, v1, 2, 2
    v_mul_u32_u24 v152, 272, v151
    v_add_u32 v152, v152, v20
    v_add_u32 v21, 27200, v152
    v_add_u32 v22, 28288, v152
    v_lshlrev_b32 v23, 2, v151
    v_add_u32 v23, 2048, v23
    v_lshlrev_b32 v24, 3, v149
    v_add_u32 v24, 2048, v24
    v_and_b32 v151, 31, v1
    v_lshlrev_b32 v25, 3, v151
    v_add_u32 v25, 98240, v25
    s_lshl_b32 s22, s3, 11
    s_add_u32 s22, s22, 81856
    v_lshlrev_b32 v30, 5, v1
    v_add_u32 v30, s22, v30
    v_lshlrev_b32 v66, 4, v0
    v_mov_b64 v[68:69], 0
    v_mov_b64 v[70:71], 0
    ds_write_b128 v66, v[68:71] offset:512
    ds_write_b128 v66, v[68:71] offset:8704
    ds_write_b128 v66, v[68:71] offset:16896
    ds_write_b128 v66, v[68:71] offset:25088
    ds_write_b128 v66, v[68:71] offset:33280
    ds_write_b128 v66, v[68:71] offset:41472
    v_cmpx_gt_u32 vcc, 160, v0
    ds_write_b128 v66, v[68:71] offset:49664
    s_mov_b64 exec, -1
    ds_read_b64_tr_b16 v[176:177], v21 offset:0
    ds_read_b64_tr_b16 v[178:179], v22 offset:0
    ds_read_b64_tr_b16 v[180:181], v21 offset:64
    ds_read_b64_tr_b16 v[182:183], v22 offset:64
    ds_read_b64_tr_b16 v[184:185], v21 offset:128
    ds_read_b64_tr_b16 v[186:187], v22 offset:128
    ds_read_b64_tr_b16 v[188:189], v21 offset:192
    ds_read_b64_tr_b16 v[190:191], v22 offset:192
    v_and_b32 v7, 31, v1
    v_lshrrev_b32 v10, 5, v1
    v_lshlrev_b32 v10, 4, v10
    v_lshlrev_b32 v4, 1, v7
    v_add_u32 v4, 52480, v4
    v_lshlrev_b32 v5, 2, v7
    v_add_u32 v5, 1024, v5
    s_waitcnt lgkmcnt(0)
    s_barrier
    s_lshl_b32 s4, s3, 5
    s_add_u32 s5, s4, 32
F_SEG:
    s_mul_i32 s18, s4, 272
    s_add_u32 s18, s18, s27
    s_lshl_b32 s18, s18, 3
    buffer_load_dword v12, off, s[44:47], s18 sc1
    s_waitcnt vmcnt(0)
    v_readfirstlane_b32 s6, v12
    s_lshr_b32 s7, s6, 20
    s_and_b32 s6, s6, 0xfffff
    s_add_u32 s7, s7, s6
F_PIECE:
    s_cmp_ge_u32 s6, s7
    s_cbranch_scc1 F_SEGEND
    v_add_u32 v12, s6, v7
    v_cmp_gt_u32 s[60:61], s7, v12
    v_lshlrev_b32 v13, 2, v12
    v_lshlrev_b32 v12, 3, v12
F_RETRY:
    buffer_load_dword v14, v13, s[36:39], 0 offen sc1
    buffer_load_dwordx2 v[172:173], v12, s[40:43], 0 offen sc1
    s_waitcnt vmcnt(0)
F_OK:
    v_and_b32 v15, 0xffff, v14
    v_lshrrev_b32 v14, 16, v14
    v_subrev_u32 v14, s26, v14
    v_mov_b32 v26, 500
    v_mov_b32 v27, 0xffff
    v_cndmask_b32 v14, v26, v14, s[60:61]
    v_cndmask_b32 v15, v27, v15, s[60:61]
    v_lshl_add_u32 v15, v15, 7, v9
    buffer_load_dwordx4 v[156:159], v15, s[28:31], 0 offen offset:0
    buffer_load_dwordx4 v[160:163], v15, s[28:31], 0 offen offset:16
    buffer_load_dwordx4 v[164:167], v15, s[28:31], 0 offen offset:32
    buffer_load_dwordx4 v[168:171], v15, s[28:31], 0 offen offset:48
    s_and_b64 s[62:63], s[60:61], s[14:15]
    s_and_b64 s[64:65], s[60:61], s[12:13]
    v_cndmask_b32 v172, 0, v172, s[62:63]
    v_cndmask_b32 v173, 0, v173, s[62:63]
    v_mov_b64 v[174:175], v[172:173]
    v_lshlrev_b32 v26, 2, v14
    v_mov_b32 v27, 16
    s_mov_b64 exec, s[64:65]
    ds_add_u32 v26, v27 offset:512
    s_mov_b64 exec, -1
    ds_bpermute_b32 v76, v10, v14 offset:0
    ds_bpermute_b32 v77, v10, v14 offset:4
    ds_bpermute_b32 v78, v10, v14 offset:8
    ds_bpermute_b32 v79, v10, v14 offset:12
    ds_bpermute_b32 v80, v10, v14 offset:32
    ds_bpermute_b32 v81, v10, v14 offset:36
    ds_bpermute_b32 v82, v10, v14 offset:40
    ds_bpermute_b32 v83, v10, v14 offset:44
    ds_bpermute_b32 v84, v10, v14 offset:64
    ds_bpermute_b32 v85, v10, v14 offset:68
    ds_bpermute_b32 v86, v10, v14 offset:72
    ds_bpermute_b32 v87, v10, v14 offset:76
    ds_bpermute_b32 v88, v10, v14 offset:96
    ds_bpermute_b32 v89, v10, v14 offset:100
    ds_bpermute_b32 v90, v10, v14 offset:104
    ds_bpermute_b32 v91, v10, v14 offset:108
    s_waitcnt lgkmcnt(0)
    s_movk_i32 s18, 272
    v_lshl_add_u32 v92, v76, 9, v5
    v_mad_u32_u24 v76, v76, s18, v4
    v_lshl_add_u32 v93, v77, 9, v5
    v_mad_u32_u24 v77, v77, s18, v4
    v_lshl_add_u32 v94, v78, 9, v5
    v_mad_u32_u24 v78, v78, s18, v4
    v_lshl_add_u32 v95, v79, 9, v5
    v_mad_u32_u24 v79, v79, s18, v4
    v_lshl_add_u32 v96, v80, 9, v5
    v_mad_u32_u24 v80, v80, s18, v4
    v_lshl_add_u32 v97, v81, 9, v5
    v_mad_u32_u24 v81, v81, s18, v4
    v_lshl_add_u32 v98, v82, 9, v5
    v_mad_u32_u24 v82, v82, s18, v4
    v_lshl_add_u32 v99, v83, 9, v5
    v_mad_u32_u24 v83, v83, s18, v4
    v_lshl_add_u32 v100, v84, 9, v5
    v_mad_u32_u24 v84, v84, s18, v4
    v_lshl_add_u32 v101, v85, 9, v5
    v_mad_u32_u24 v85, v85, s18, v4
    v_lshl_add_u32 v102, v86, 9, v5
    v_mad_u32_u24 v86, v86, s18, v4
    v_lshl_add_u32 v103, v87, 9, v5
    v_mad_u32_u24 v87, v87, s18, v4
    v_lshl_add_u32 v104, v88, 9, v5
    v_mad_u32_u24 v88, v88, s18, v4
    v_lshl_add_u32 v105, v89, 9, v5
    v_mad_u32_u24 v89, v89, s18, v4
    v_lshl_add_u32 v106, v90, 9, v5
    v_mad_u32_u24 v90, v90, s18, v4
    v_lshl_add_u32 v107, v91, 9, v5
    v_mad_u32_u24 v91, v91, s18, v4
    s_waitcnt vmcnt(0)
    v_mfma_f32_32x32x16_bf16 v[124:139], v[156:159], v[192:195], 0
    v_mfma_f32_32x32x16_bf16 v[124:139], v[160:163], v[196:199], v[124:139]
    v_mfma_f32_32x32x16_bf16 v[124:139], v[164:167], v[200:203], v[124:139]
    v_mfma_f32_32x32x16_bf16 v[124:139], v[168:171], v[204:207], v[124:139]
    v_mfma_f32_32x32x16_bf16 v[124:139], v[172:175], v[176:179], v[124:139]
    ds_read_u16 v108, v76 offset:0
    ds_read_u16 v109, v77 offset:0
    ds_read_u16 v110, v78 offset:0
    ds_read_u16 v111, v79 offset:0
    ds_read_u16 v112, v80 offset:0
    ds_read_u16 v113, v81 offset:0
    ds_read_u16 v114, v82 offset:0
    ds_read_u16 v115, v83 offset:0
    ds_read_u16 v116, v84 offset:0
    ds_read_u16 v117, v85 offset:0
    ds_read_u16 v118, v86 offset:0
    ds_read_u16 v119, v87 offset:0
    ds_read_u16 v120, v88 offset:0
    ds_read_u16 v121, v89 offset:0
    ds_read_u16 v122, v90 offset:0
    ds_read_u16 v123, v91 offset:0
    s_waitcnt lgkmcnt(0)
    v_lshlrev_b32 v108, 16, v108
    v_add_f32 v140, v124, v108
    v_exp_f32 v108, v140
    v_lshlrev_b32 v109, 16, v109
    v_add_f32 v141, v125, v109
    v_exp_f32 v109, v141
    v_lshlrev_b32 v110, 16, v110
    v_add_f32 v142, v126, v110
    v_exp_f32 v110, v142
    v_lshlrev_b32 v111, 16, v111
    v_add_f32 v143, v127, v111
    v_exp_f32 v111, v143
    v_lshlrev_b32 v112, 16, v112
    v_add_f32 v144, v128, v112
    v_exp_f32 v112, v144
    v_lshlrev_b32 v113, 16, v113
    v_add_f32 v145, v129, v113
    v_exp_f32 v113, v145
    v_lshlrev_b32 v114, 16, v114
    v_add_f32 v146, v130, v114
    v_exp_f32 v114, v146
    v_lshlrev_b32 v115, 16, v115
    v_add_f32 v147, v131, v115
    v_exp_f32 v115, v147
    v_lshlrev_b32 v116, 16, v116
    v_add_f32 v148, v132, v116
    v_exp_f32 v116, v148
    v_lshlrev_b32 v117, 16, v117
    v_add_f32 v149, v133, v117
    v_exp_f32 v117, v149
    v_lshlrev_b32 v118, 16, v118
    v_add_f32 v150, v134, v118
    v_exp_f32 v118, v150
    v_lshlrev_b32 v119, 16, v119
    v_add_f32 v151, v135, v119
    v_exp_f32 v119, v151
    v_lshlrev_b32 v120, 16, v120
    v_add_f32 v152, v136, v120
    v_exp_f32 v120, v152
    v_lshlrev_b32 v121, 16, v121
    v_add_f32 v153, v137, v121
    v_exp_f32 v121, v153
    v_lshlrev_b32 v122, 16, v122
    v_add_f32 v154, v138, v122
    v_exp_f32 v122, v154
    v_lshlrev_b32 v123, 16, v123
    v_add_f32 v155, v139, v123
    v_exp_f32 v123, v155
    v_add_f32 v108, 1.0, v108
    v_add_f32 v109, 1.0, v109
    v_add_f32 v110, 1.0, v110
    v_add_f32 v111, 1.0, v111
    v_add_f32 v112, 1.0, v112
    v_add_f32 v113, 1.0, v113
    v_add_f32 v114, 1.0, v114
    v_add_f32 v115, 1.0, v115
    v_add_f32 v116, 1.0, v116
    v_add_f32 v117, 1.0, v117
    v_add_f32 v118, 1.0, v118
    v_add_f32 v119, 1.0, v119
    v_add_f32 v120, 1.0, v120
    v_add_f32 v121, 1.0, v121
    v_add_f32 v122, 1.0, v122
    v_add_f32 v123, 1.0, v123
    v_rcp_f32 v108, v108
    v_rcp_f32 v109, v109
    v_rcp_f32 v110, v110
    v_rcp_f32 v111, v111
    v_rcp_f32 v112, v112
    v_rcp_f32 v113, v113
    v_rcp_f32 v114, v114
    v_rcp_f32 v115, v115
    v_rcp_f32 v116, v116
    v_rcp_f32 v117, v117
    v_rcp_f32 v118, v118
    v_rcp_f32 v119, v119
    v_rcp_f32 v120, v120
    v_rcp_f32 v121, v121
    v_rcp_f32 v122, v122
    v_rcp_f32 v123, v123
    v_mul_f32 v140, v140, v108
    v_mul_f32 v141, v141, v109
    v_mul_f32 v142, v142, v110
    v_mul_f32 v143, v143, v111
    v_mul_f32 v144, v144, v112
    v_mul_f32 v145, v145, v113
    v_mul_f32 v146, v146, v114
    v_mul_f32 v147, v147, v115
    v_mul_f32 v148, v148, v116
    v_mul_f32 v149, v149, v117
    v_mul_f32 v150, v150, v118
    v_mul_f32 v151, v151, v119
    v_mul_f32 v152, v152, v120
    v_mul_f32 v153, v153, v121
    v_mul_f32 v154, v154, v122
    v_mul_f32 v155, v155, v123
    ds_add_f32 v92, v140 offset:0
    ds_add_f32 v93, v141 offset:0
    ds_add_f32 v94, v142 offset:0
    ds_add_f32 v95, v143 offset:0
    ds_add_f32 v96, v144 offset:0
    ds_add_f32 v97, v145 offset:0
    ds_add_f32 v98, v146 offset:0
    ds_add_f32 v99, v147 offset:0
    ds_add_f32 v100, v148 offset:0
    ds_add_f32 v101, v149 offset:0
    ds_add_f32 v102, v150 offset:0
    ds_add_f32 v103, v151 offset:0
    ds_add_f32 v104, v152 offset:0
    ds_add_f32 v105, v153 offset:0
    ds_add_f32 v106, v154 offset:0
    ds_add_f32 v107, v155 offset:0
    s_waitcnt lgkmcnt(0)
    v_mfma_f32_32x32x16_bf16 v[124:139], v[156:159], v[208:211], 0
    v_mfma_f32_32x32x16_bf16 v[124:139], v[160:163], v[212:215], v[124:139]
    v_mfma_f32_32x32x16_bf16 v[124:139], v[164:167], v[216:219], v[124:139]
    v_mfma_f32_32x32x16_bf16 v[124:139], v[168:171], v[220:223], v[124:139]
    v_mfma_f32_32x32x16_bf16 v[124:139], v[172:175], v[180:183], v[124:139]
    ds_read_u16 v108, v76 offset:64
    ds_read_u16 v109, v77 offset:64
    ds_read_u16 v110, v78 offset:64
    ds_read_u16 v111, v79 offset:64
    ds_read_u16 v112, v80 offset:64
    ds_read_u16 v113, v81 offset:64
    ds_read_u16 v114, v82 offset:64
    ds_read_u16 v115, v83 offset:64
    ds_read_u16 v116, v84 offset:64
    ds_read_u16 v117, v85 offset:64
    ds_read_u16 v118, v86 offset:64
    ds_read_u16 v119, v87 offset:64
    ds_read_u16 v120, v88 offset:64
    ds_read_u16 v121, v89 offset:64
    ds_read_u16 v122, v90 offset:64
    ds_read_u16 v123, v91 offset:64
    s_waitcnt lgkmcnt(0)
    v_lshlrev_b32 v108, 16, v108
    v_add_f32 v140, v124, v108
    v_exp_f32 v108, v140
    v_lshlrev_b32 v109, 16, v109
    v_add_f32 v141, v125, v109
    v_exp_f32 v109, v141
    v_lshlrev_b32 v110, 16, v110
    v_add_f32 v142, v126, v110
    v_exp_f32 v110, v142
    v_lshlrev_b32 v111, 16, v111
    v_add_f32 v143, v127, v111
    v_exp_f32 v111, v143
    v_lshlrev_b32 v112, 16, v112
    v_add_f32 v144, v128, v112
    v_exp_f32 v112, v144
    v_lshlrev_b32 v113, 16, v113
    v_add_f32 v145, v129, v113
    v_exp_f32 v113, v145
    v_lshlrev_b32 v114, 16, v114
    v_add_f32 v146, v130, v114
    v_exp_f32 v114, v146
    v_lshlrev_b32 v115, 16, v115
    v_add_f32 v147, v131, v115
    v_exp_f32 v115, v147
    v_lshlrev_b32 v116, 16, v116
    v_add_f32 v148, v132, v116
    v_exp_f32 v116, v148
    v_lshlrev_b32 v117, 16, v117
    v_add_f32 v149, v133, v117
    v_exp_f32 v117, v149
    v_lshlrev_b32 v118, 16, v118
    v_add_f32 v150, v134, v118
    v_exp_f32 v118, v150
    v_lshlrev_b32 v119, 16, v119
    v_add_f32 v151, v135, v119
    v_exp_f32 v119, v151
    v_lshlrev_b32 v120, 16, v120
    v_add_f32 v152, v136, v120
    v_exp_f32 v120, v152
    v_lshlrev_b32 v121, 16, v121
    v_add_f32 v153, v137, v121
    v_exp_f32 v121, v153
    v_lshlrev_b32 v122, 16, v122
    v_add_f32 v154, v138, v122
    v_exp_f32 v122, v154
    v_lshlrev_b32 v123, 16, v123
    v_add_f32 v155, v139, v123
    v_exp_f32 v123, v155
    v_add_f32 v108, 1.0, v108
    v_add_f32 v109, 1.0, v109
    v_add_f32 v110, 1.0, v110
    v_add_f32 v111, 1.0, v111
    v_add_f32 v112, 1.0, v112
    v_add_f32 v113, 1.0, v113
    v_add_f32 v114, 1.0, v114
    v_add_f32 v115, 1.0, v115
    v_add_f32 v116, 1.0, v116
    v_add_f32 v117, 1.0, v117
    v_add_f32 v118, 1.0, v118
    v_add_f32 v119, 1.0, v119
    v_add_f32 v120, 1.0, v120
    v_add_f32 v121, 1.0, v121
    v_add_f32 v122, 1.0, v122
    v_add_f32 v123, 1.0, v123
    v_rcp_f32 v108, v108
    v_rcp_f32 v109, v109
    v_rcp_f32 v110, v110
    v_rcp_f32 v111, v111
    v_rcp_f32 v112, v112
    v_rcp_f32 v113, v113
    v_rcp_f32 v114, v114
    v_rcp_f32 v115, v115
    v_rcp_f32 v116, v116
    v_rcp_f32 v117, v117
    v_rcp_f32 v118, v118
    v_rcp_f32 v119, v119
    v_rcp_f32 v120, v120
    v_rcp_f32 v121, v121
    v_rcp_f32 v122, v122
    v_rcp_f32 v123, v123
    v_mul_f32 v140, v140, v108
    v_mul_f32 v141, v141, v109
    v_mul_f32 v142, v142, v110
    v_mul_f32 v143, v143, v111
    v_mul_f32 v144, v144, v112
    v_mul_f32 v145, v145, v113
    v_mul_f32 v146, v146, v114
    v_mul_f32 v147, v147, v115
    v_mul_f32 v148, v148, v116
    v_mul_f32 v149, v149, v117
    v_mul_f32 v150, v150, v118
    v_mul_f32 v151, v151, v119
    v_mul_f32 v152, v152, v120
    v_mul_f32 v153, v153, v121
    v_mul_f32 v154, v154, v122
    v_mul_f32 v155, v155, v123
    ds_add_f32 v92, v140 offset:128
    ds_add_f32 v93, v141 offset:128
    ds_add_f32 v94, v142 offset:128
    ds_add_f32 v95, v143 offset:128
    ds_add_f32 v96, v144 offset:128
    ds_add_f32 v97, v145 offset:128
    ds_add_f32 v98, v146 offset:128
    ds_add_f32 v99, v147 offset:128
    ds_add_f32 v100, v148 offset:128
    ds_add_f32 v101, v149 offset:128
    ds_add_f32 v102, v150 offset:128
    ds_add_f32 v103, v151 offset:128
    ds_add_f32 v104, v152 offset:128
    ds_add_f32 v105, v153 offset:128
    ds_add_f32 v106, v154 offset:128
    ds_add_f32 v107, v155 offset:128
    s_waitcnt lgkmcnt(0)
    v_mfma_f32_32x32x16_bf16 v[124:139], v[156:159], v[224:227], 0
    v_mfma_f32_32x32x16_bf16 v[124:139], v[160:163], v[228:231], v[124:139]
    v_mfma_f32_32x32x16_bf16 v[124:139], v[164:167], v[232:235], v[124:139]
    v_mfma_f32_32x32x16_bf16 v[124:139], v[168:171], v[236:239], v[124:139]
    v_mfma_f32_32x32x16_bf16 v[124:139], v[172:175], v[184:187], v[124:139]
    ds_read_u16 v108, v76 offset:128
    ds_read_u16 v109, v77 offset:128
    ds_read_u16 v110, v78 offset:128
    ds_read_u16 v111, v79 offset:128
    ds_read_u16 v112, v80 offset:128
    ds_read_u16 v113, v81 offset:128
    ds_read_u16 v114, v82 offset:128
    ds_read_u16 v115, v83 offset:128
    ds_read_u16 v116, v84 offset:128
    ds_read_u16 v117, v85 offset:128
    ds_read_u16 v118, v86 offset:128
    ds_read_u16 v119, v87 offset:128
    ds_read_u16 v120, v88 offset:128
    ds_read_u16 v121, v89 offset:128
    ds_read_u16 v122, v90 offset:128
    ds_read_u16 v123, v91 offset:128
    s_waitcnt lgkmcnt(0)
    v_lshlrev_b32 v108, 16, v108
    v_add_f32 v140, v124, v108
    v_exp_f32 v108, v140
    v_lshlrev_b32 v109, 16, v109
    v_add_f32 v141, v125, v109
    v_exp_f32 v109, v141
    v_lshlrev_b32 v110, 16, v110
    v_add_f32 v142, v126, v110
    v_exp_f32 v110, v142
    v_lshlrev_b32 v111, 16, v111
    v_add_f32 v143, v127, v111
    v_exp_f32 v111, v143
    v_lshlrev_b32 v112, 16, v112
    v_add_f32 v144, v128, v112
    v_exp_f32 v112, v144
    v_lshlrev_b32 v113, 16, v113
    v_add_f32 v145, v129, v113
    v_exp_f32 v113, v145
    v_lshlrev_b32 v114, 16, v114
    v_add_f32 v146, v130, v114
    v_exp_f32 v114, v146
    v_lshlrev_b32 v115, 16, v115
    v_add_f32 v147, v131, v115
    v_exp_f32 v115, v147
    v_lshlrev_b32 v116, 16, v116
    v_add_f32 v148, v132, v116
    v_exp_f32 v116, v148
    v_lshlrev_b32 v117, 16, v117
    v_add_f32 v149, v133, v117
    v_exp_f32 v117, v149
    v_lshlrev_b32 v118, 16, v118
    v_add_f32 v150, v134, v118
    v_exp_f32 v118, v150
    v_lshlrev_b32 v119, 16, v119
    v_add_f32 v151, v135, v119
    v_exp_f32 v119, v151
    v_lshlrev_b32 v120, 16, v120
    v_add_f32 v152, v136, v120
    v_exp_f32 v120, v152
    v_lshlrev_b32 v121, 16, v121
    v_add_f32 v153, v137, v121
    v_exp_f32 v121, v153
    v_lshlrev_b32 v122, 16, v122
    v_add_f32 v154, v138, v122
    v_exp_f32 v122, v154
    v_lshlrev_b32 v123, 16, v123
    v_add_f32 v155, v139, v123
    v_exp_f32 v123, v155
    v_add_f32 v108, 1.0, v108
    v_add_f32 v109, 1.0, v109
    v_add_f32 v110, 1.0, v110
    v_add_f32 v111, 1.0, v111
    v_add_f32 v112, 1.0, v112
    v_add_f32 v113, 1.0, v113
    v_add_f32 v114, 1.0, v114
    v_add_f32 v115, 1.0, v115
    v_add_f32 v116, 1.0, v116
    v_add_f32 v117, 1.0, v117
    v_add_f32 v118, 1.0, v118
    v_add_f32 v119, 1.0, v119
    v_add_f32 v120, 1.0, v120
    v_add_f32 v121, 1.0, v121
    v_add_f32 v122, 1.0, v122
    v_add_f32 v123, 1.0, v123
    v_rcp_f32 v108, v108
    v_rcp_f32 v109, v109
    v_rcp_f32 v110, v110
    v_rcp_f32 v111, v111
    v_rcp_f32 v112, v112
    v_rcp_f32 v113, v113
    v_rcp_f32 v114, v114
    v_rcp_f32 v115, v115
    v_rcp_f32 v116, v116
    v_rcp_f32 v117, v117
    v_rcp_f32 v118, v118
    v_rcp_f32 v119, v119
    v_rcp_f32 v120, v120
    v_rcp_f32 v121, v121
    v_rcp_f32 v122, v122
    v_rcp_f32 v123, v123
    v_mul_f32 v140, v140, v108
    v_mul_f32 v141, v141, v109
    v_mul_f32 v142, v142, v110
    v_mul_f32 v143, v143, v111
    v_mul_f32 v144, v144, v112
    v_mul_f32 v145, v145, v113
    v_mul_f32 v146, v146, v114
    v_mul_f32 v147, v147, v115
    v_mul_f32 v148, v148, v116
    v_mul_f32 v149, v149, v117
    v_mul_f32 v150, v150, v118
    v_mul_f32 v151, v151, v119
    v_mul_f32 v152, v152, v120
    v_mul_f32 v153, v153, v121
    v_mul_f32 v154, v154, v122
    v_mul_f32 v155, v155, v123
    ds_add_f32 v92, v140 offset:256
    ds_add_f32 v93, v141 offset:256
    ds_add_f32 v94, v142 offset:256
    ds_add_f32 v95, v143 offset:256
    ds_add_f32 v96, v144 offset:256
    ds_add_f32 v97, v145 offset:256
    ds_add_f32 v98, v146 offset:256
    ds_add_f32 v99, v147 offset:256
    ds_add_f32 v100, v148 offset:256
    ds_add_f32 v101, v149 offset:256
    ds_add_f32 v102, v150 offset:256
    ds_add_f32 v103, v151 offset:256
    ds_add_f32 v104, v152 offset:256
    ds_add_f32 v105, v153 offset:256
    ds_add_f32 v106, v154 offset:256
    ds_add_f32 v107, v155 offset:256
    s_waitcnt lgkmcnt(0)
    v_mfma_f32_32x32x16_bf16 v[124:139], v[156:159], v[240:243], 0
    v_mfma_f32_32x32x16_bf16 v[124:139], v[160:163], v[244:247], v[124:139]
    v_mfma_f32_32x32x16_bf16 v[124:139], v[164:167], v[248:251], v[124:139]
    v_mfma_f32_32x32x16_bf16 v[124:139], v[168:171], v[252:255], v[124:139]
    v_mfma_f32_32x32x16_bf16 v[124:139], v[172:175], v[188:191], v[124:139]
    ds_read_u16 v108, v76 offset:192
    ds_read_u16 v109, v77 offset:192
    ds_read_u16 v110, v78 offset:192
    ds_read_u16 v111, v79 offset:192
    ds_read_u16 v112, v80 offset:192
    ds_read_u16 v113, v81 offset:192
    ds_read_u16 v114, v82 offset:192
    ds_read_u16 v115, v83 offset:192
    ds_read_u16 v116, v84 offset:192
    ds_read_u16 v117, v85 offset:192
    ds_read_u16 v118, v86 offset:192
    ds_read_u16 v119, v87 offset:192
    ds_read_u16 v120, v88 offset:192
    ds_read_u16 v121, v89 offset:192
    ds_read_u16 v122, v90 offset:192
    ds_read_u16 v123, v91 offset:192
    s_waitcnt lgkmcnt(0)
    v_lshlrev_b32 v108, 16, v108
    v_add_f32 v140, v124, v108
    v_exp_f32 v108, v140
    v_lshlrev_b32 v109, 16, v109
    v_add_f32 v141, v125, v109
    v_exp_f32 v109, v141
    v_lshlrev_b32 v110, 16, v110
    v_add_f32 v142, v126, v110
    v_exp_f32 v110, v142
    v_lshlrev_b32 v111, 16, v111
    v_add_f32 v143, v127, v111
    v_exp_f32 v111, v143
    v_lshlrev_b32 v112, 16, v112
    v_add_f32 v144, v128, v112
    v_exp_f32 v112, v144
    v_lshlrev_b32 v113, 16, v113
    v_add_f32 v145, v129, v113
    v_exp_f32 v113, v145
    v_lshlrev_b32 v114, 16, v114
    v_add_f32 v146, v130, v114
    v_exp_f32 v114, v146
    v_lshlrev_b32 v115, 16, v115
    v_add_f32 v147, v131, v115
    v_exp_f32 v115, v147
    v_lshlrev_b32 v116, 16, v116
    v_add_f32 v148, v132, v116
    v_exp_f32 v116, v148
    v_lshlrev_b32 v117, 16, v117
    v_add_f32 v149, v133, v117
    v_exp_f32 v117, v149
    v_lshlrev_b32 v118, 16, v118
    v_add_f32 v150, v134, v118
    v_exp_f32 v118, v150
    v_lshlrev_b32 v119, 16, v119
    v_add_f32 v151, v135, v119
    v_exp_f32 v119, v151
    v_lshlrev_b32 v120, 16, v120
    v_add_f32 v152, v136, v120
    v_exp_f32 v120, v152
    v_lshlrev_b32 v121, 16, v121
    v_add_f32 v153, v137, v121
    v_exp_f32 v121, v153
    v_lshlrev_b32 v122, 16, v122
    v_add_f32 v154, v138, v122
    v_exp_f32 v122, v154
    v_lshlrev_b32 v123, 16, v123
    v_add_f32 v155, v139, v123
    v_exp_f32 v123, v155
    v_add_f32 v108, 1.0, v108
    v_add_f32 v109, 1.0, v109
    v_add_f32 v110, 1.0, v110
    v_add_f32 v111, 1.0, v111
    v_add_f32 v112, 1.0, v112
    v_add_f32 v113, 1.0, v113
    v_add_f32 v114, 1.0, v114
    v_add_f32 v115, 1.0, v115
    v_add_f32 v116, 1.0, v116
    v_add_f32 v117, 1.0, v117
    v_add_f32 v118, 1.0, v118
    v_add_f32 v119, 1.0, v119
    v_add_f32 v120, 1.0, v120
    v_add_f32 v121, 1.0, v121
    v_add_f32 v122, 1.0, v122
    v_add_f32 v123, 1.0, v123
    v_rcp_f32 v108, v108
    v_rcp_f32 v109, v109
    v_rcp_f32 v110, v110
    v_rcp_f32 v111, v111
    v_rcp_f32 v112, v112
    v_rcp_f32 v113, v113
    v_rcp_f32 v114, v114
    v_rcp_f32 v115, v115
    v_rcp_f32 v116, v116
    v_rcp_f32 v117, v117
    v_rcp_f32 v118, v118
    v_rcp_f32 v119, v119
    v_rcp_f32 v120, v120
    v_rcp_f32 v121, v121
    v_rcp_f32 v122, v122
    v_rcp_f32 v123, v123
    v_mul_f32 v140, v140, v108
    v_mul_f32 v141, v141, v109
    v_mul_f32 v142, v142, v110
    v_mul_f32 v143, v143, v111
    v_mul_f32 v144, v144, v112
    v_mul_f32 v145, v145, v113
    v_mul_f32 v146, v146, v114
    v_mul_f32 v147, v147, v115
    v_mul_f32 v148, v148, v116
    v_mul_f32 v149, v149, v117
    v_mul_f32 v150, v150, v118
    v_mul_f32 v151, v151, v119
    v_mul_f32 v152, v152, v120
    v_mul_f32 v153, v153, v121
    v_mul_f32 v154, v154, v122
    v_mul_f32 v155, v155, v123
    ds_add_f32 v92, v140 offset:384
    ds_add_f32 v93, v141 offset:384
    ds_add_f32 v94, v142 offset:384
    ds_add_f32 v95, v143 offset:384
    ds_add_f32 v96, v144 offset:384
    ds_add_f32 v97, v145 offset:384
    ds_add_f32 v98, v146 offset:384
    ds_add_f32 v99, v147 offset:384
    ds_add_f32 v100, v148 offset:384
    ds_add_f32 v101, v149 offset:384
    ds_add_f32 v102, v150 offset:384
    ds_add_f32 v103, v151 offset:384
    ds_add_f32 v104, v152 offset:384
    ds_add_f32 v105, v153 offset:384
    ds_add_f32 v106, v154 offset:384
    ds_add_f32 v107, v155 offset:384
    s_waitcnt lgkmcnt(0)
    s_add_u32 s6, s6, 32
    s_branch F_PIECE
F_SEGEND:
    s_add_u32 s4, s4, 1
    s_cmp_lt_u32 s4, s5
    s_cbranch_scc1 F_SEG
    s_waitcnt vmcnt(0) lgkmcnt(0)
    s_barrier
    v_lshrrev_b32 v12, 5, v0
    v_add_u32 v12, 0, v12
    v_min_u32 v12, 99, v12
    v_lshl_add_u32 v13, v12, 9, v5
    v_mul_u32_u24 v12, 272, v12
    v_add_u32 v12, v12, v25
    ds_read2_b32 v[76:77], v13 offset0:0 offset1:32
    ds_read2_b32 v[78:79], v13 offset0:64 offset1:96
    s_waitcnt lgkmcnt(0)
    v_cvt_pk_bf16_f32 v76, v76, v77
    v_cvt_pk_bf16_f32 v77, v78, v79
    ds_write_b64 v12, v[76:77]
    s_waitcnt lgkmcnt(0)
    v_lshrrev_b32 v12, 5, v0
    v_add_u32 v12, 16, v12
    v_min_u32 v12, 99, v12
    v_lshl_add_u32 v13, v12, 9, v5
    v_mul_u32_u24 v12, 272, v12
    v_add_u32 v12, v12, v25
    ds_read2_b32 v[76:77], v13 offset0:0 offset1:32
    ds_read2_b32 v[78:79], v13 offset0:64 offset1:96
    s_waitcnt lgkmcnt(0)
    v_cvt_pk_bf16_f32 v76, v76, v77
    v_cvt_pk_bf16_f32 v77, v78, v79
    ds_write_b64 v12, v[76:77]
    s_waitcnt lgkmcnt(0)
    v_lshrrev_b32 v12, 5, v0
    v_add_u32 v12, 32, v12
    v_min_u32 v12, 99, v12
    v_lshl_add_u32 v13, v12, 9, v5
    v_mul_u32_u24 v12, 272, v12
    v_add_u32 v12, v12, v25
    ds_read2_b32 v[76:77], v13 offset0:0 offset1:32
    ds_read2_b32 v[78:79], v13 offset0:64 offset1:96
    s_waitcnt lgkmcnt(0)
    v_cvt_pk_bf16_f32 v76, v76, v77
    v_cvt_pk_bf16_f32 v77, v78, v79
    ds_write_b64 v12, v[76:77]
    s_waitcnt lgkmcnt(0)
    v_lshrrev_b32 v12, 5, v0
    v_add_u32 v12, 48, v12
    v_min_u32 v12, 99, v12
    v_lshl_add_u32 v13, v12, 9, v5
    v_mul_u32_u24 v12, 272, v12
    v_add_u32 v12, v12, v25
    ds_read2_b32 v[76:77], v13 offset0:0 offset1:32
    ds_read2_b32 v[78:79], v13 offset0:64 offset1:96
    s_waitcnt lgkmcnt(0)
    v_cvt_pk_bf16_f32 v76, v76, v77
    v_cvt_pk_bf16_f32 v77, v78, v79
    ds_write_b64 v12, v[76:77]
    s_waitcnt lgkmcnt(0)
    v_lshrrev_b32 v12, 5, v0
    v_add_u32 v12, 64, v12
    v_min_u32 v12, 99, v12
    v_lshl_add_u32 v13, v12, 9, v5
    v_mul_u32_u24 v12, 272, v12
    v_add_u32 v12, v12, v25
    ds_read2_b32 v[76:77], v13 offset0:0 offset1:32
    ds_read2_b32 v[78:79], v13 offset0:64 offset1:96
    s_waitcnt lgkmcnt(0)
    v_cvt_pk_bf16_f32 v76, v76, v77
    v_cvt_pk_bf16_f32 v77, v78, v79
    ds_write_b64 v12, v[76:77]
    s_waitcnt lgkmcnt(0)
    v_lshrrev_b32 v12, 5, v0
    v_add_u32 v12, 80, v12
    v_min_u32 v12, 99, v12
    v_lshl_add_u32 v13, v12, 9, v5
    v_mul_u32_u24 v12, 272, v12
    v_add_u32 v12, v12, v25
    ds_read2_b32 v[76:77], v13 offset0:0 offset1:32
    ds_read2_b32 v[78:79], v13 offset0:64 offset1:96
    s_waitcnt lgkmcnt(0)
    v_cvt_pk_bf16_f32 v76, v76, v77
    v_cvt_pk_bf16_f32 v77, v78, v79
    ds_write_b64 v12, v[76:77]
    s_waitcnt lgkmcnt(0)
    v_lshrrev_b32 v12, 5, v0
    v_add_u32 v12, 96, v12
    v_min_u32 v12, 99, v12
    v_lshl_add_u32 v13, v12, 9, v5
    v_mul_u32_u24 v12, 272, v12
    v_add_u32 v12, v12, v25
    ds_read2_b32 v[76:77], v13 offset0:0 offset1:32
    ds_read2_b32 v[78:79], v13 offset0:64 offset1:96
    s_waitcnt lgkmcnt(0)
    v_cvt_pk_bf16_f32 v76, v76, v77
    v_cvt_pk_bf16_f32 v77, v78, v79
    ds_write_b64 v12, v[76:77]
    s_waitcnt lgkmcnt(0)
    v_lshrrev_b32 v70, 5, v1
    v_and_b32 v66, 31, v1
    s_lshr_b32 s20, s3, 1
    s_lshl_b32 s20, s20, 5
    v_add_u32 v67, s20, v66
    v_min_u32 v67, 99, v67
    v_lshlrev_b32 v68, 2, v67
    v_mul_u32_u24 v67, 272, v67
    v_lshl_add_u32 v67, v70, 4, v67
    v_add_u32 v67, 98240, v67
    v_mul_u32_u24 v66, 80, v66
    v_lshl_add_u32 v66, v70, 5, v66
    v_add_u32 v66, s9, v66
    s_and_b32 s22, s3, 1
    s_lshl_b32 s21, s22, 7
    v_lshl_add_u32 v71, v70, 6, s21
    s_add_u32 s21, s26, s20
    s_lshl_b32 s21, s21, 7
    s_lshl_b32 s22, s22, 6
    s_add_u32 s21, s21, s22
    v_lshrrev_b32 v70, 2, v1
    v_and_b32 v69, 3, v1
    v_lshlrev_b32 v69, 4, v69
    v_lshl_add_u32 v69, v70, 7, v69
    v_add_u32 v69, s21, v69
    ds_read_b64_tr_b16 v[34:35], v2 offset:0
    ds_read_b64_tr_b16 v[36:37], v3 offset:0
    ds_read_b64_tr_b16 v[38:39], v2 offset:512
    ds_read_b64_tr_b16 v[40:41], v3 offset:512
    ds_read_b64_tr_b16 v[42:43], v2 offset:1024
    ds_read_b64_tr_b16 v[44:45], v3 offset:1024
    ds_read_b64_tr_b16 v[46:47], v2 offset:1536
    ds_read_b64_tr_b16 v[48:49], v3 offset:1536
    ds_read_b64_tr_b16 v[176:177], v2 offset:2048
    ds_read_b64_tr_b16 v[178:179], v3 offset:2048
    ds_read_b64_tr_b16 v[180:181], v2 offset:2560
    ds_read_b64_tr_b16 v[182:183], v3 offset:2560
    ds_read_b64_tr_b16 v[184:185], v2 offset:3072
    ds_read_b64_tr_b16 v[186:187], v3 offset:3072
    ds_read_b64_tr_b16 v[188:189], v2 offset:3584
    ds_read_b64_tr_b16 v[190:191], v3 offset:3584
    ds_read_b32 v70, v68 offset:512
    ds_read_b128 v[108:111], v71 offset:256
    ds_read_b128 v[112:115], v71 offset:272
    ds_read_b128 v[116:119], v71 offset:288
    ds_read_b128 v[120:123], v71 offset:304
    s_waitcnt lgkmcnt(0)
    s_barrier
    ds_read_b128 v[124:127], v67 offset:0
    ds_read_b128 v[128:131], v67 offset:32
    ds_read_b128 v[132:135], v67 offset:64
    ds_read_b128 v[136:139], v67 offset:96
    ds_read_b128 v[140:143], v67 offset:128
    ds_read_b128 v[144:147], v67 offset:160
    ds_read_b128 v[148:151], v67 offset:192
    ds_read_b128 v[152:155], v67 offset:224
    s_branch M_EPI
M_END:
    s_endpgm
.section .rodata,"a"
.p2align 6
.amdhsa_kernel standalone__edge_featured_mpnn_mpnn__graph_kernel
  .amdhsa_next_free_vgpr 256
  .amdhsa_next_free_sgpr 102
  .amdhsa_accum_offset 256
  .amdhsa_group_segment_fixed_size 0
  .amdhsa_kernarg_size 88
  .amdhsa_user_sgpr_count 2
  .amdhsa_user_sgpr_kernarg_segment_ptr 1
  .amdhsa_system_sgpr_workgroup_id_x 1
  .amdhsa_float_denorm_mode_32 3
.end_amdhsa_kernel
```
